```python
import torch

def _softmax(x, axis=-1):
    return torch.softmax(x, dim=axis)

def _gelu(x):
    return torch.nn.functional.gelu(x, approximate='tanh')

def _silu(x):
    return torch.nn.functional.silu(x)

def _sigmoid(x):
    return torch.sigmoid(x)

def _layernorm(x, axis=-1, eps=1e-05):
    m = x.mean(dim=axis, keepdim=True)
    v = x.var(dim=axis, keepdim=True, unbiased=False)
    return (x - m) / torch.sqrt(v + eps)

def _scatter_add(tgt, idx, src, axis=0):
    return tgt.clone().index_add_(axis, idx, src)

def _segment_sum(src, seg, n):
    out = torch.zeros((n,) + src.shape[1:], dtype=src.dtype)
    return out.index_add_(0, seg, src)

def _pad(x, pw):
    flat = tuple((v for pair in reversed(pw) for v in pair))
    return torch.nn.functional.pad(x, flat)
kernel_name = 'standalone__autoregressive_conv_wavernn__speech'

def setup_inputs():

    _w = lambda a: (lambda t: t.to(torch.bfloat16) if t.is_floating_point() else t)(torch.as_tensor(a))
    B, T, D, K = (2, 4000, 144, 31)
    return {'x': _w((lambda *s: torch.randn(*s, dtype=torch.bfloat16) * 0.1)(B, T, D)), 'w': _w((lambda *s: torch.randn(*s, dtype=torch.bfloat16) * 0.1)(K, D, 2 * D))}

def reference(x, w):
    B, T, D = x.shape
    K = w.shape[0]
    dil = 2
    pad = (K - 1) * dil
    xp = _pad(x, ((0, 0), (pad, 0), (0, 0)))
    h = torch.einsum('btd,de->bte', xp[:, 0:T, :], w[0])
    for i in range(1, K):
        h = h + torch.einsum('btd,de->bte', xp[:, i * dil:i * dil + T, :], w[i])
    f, g = (h[..., :D].clone(), h[..., D:].clone())
    return torch.tanh(f) * _sigmoid(g)
```

```asm
; @launch grid=(252,1,1) block=(512,1,1) lds=156736
.amdgcn_target "amdgcn-amd-amdhsa--gfx950"
.text
.globl standalone__autoregressive_conv_wavernn__speech_kernel
.p2align 8
.type standalone__autoregressive_conv_wavernn__speech_kernel,@function
standalone__autoregressive_conv_wavernn__speech_kernel:
s_cmp_ge_u32 s2, 252
s_cbranch_scc1 L_end
s_load_dwordx4 s[4:7], s[0:1], 0
s_load_dwordx4 s[8:11], s[0:1], 16
s_load_dwordx2 s[12:13], s[0:1], 32
v_lshrrev_b32 v2, 6, v0
v_and_b32 v1, 63, v0
v_readfirstlane_b32 s14, v2
s_cmp_ge_u32 s14, 4
s_cbranch_scc1 L_helper
s_lshr_b32 s44, s2, 3
s_lshl_b32 s45, s14, 5
s_add_u32 s44, s44, s45
s_sub_u32 s44, s44, 26
s_cmp_ge_u32 s44, 5
s_cbranch_scc1 L_main
s_getpc_b64 s[46:47]
L_pc:
s_lshl_b32 s44, s44, 13
v_lshl_add_u32 v2, v1, 7, s44
v_min_u32 v2, L_codeend-L_pc-4, v2
global_load_dword v63, v2, s[46:47]
s_branch L_main
L_helper:
s_setprio 3
s_sub_u32 s44, s14, 4
s_mov_b32 s45, s14
s_sub_u32 s55, s2, 144
s_cselect_b32 s55, s2, s55
s_mov_b32 s57, 0
s_mov_b32 s94, s2
s_mov_b32 s56, s44
s_lshl_b32 s58, s44, 12
s_add_u32 s58, s58, 138304
L_prod:
v_mov_b32 v19, 4320
v_and_b32 v23, 3, v1
v_lshrrev_b32 v24, 2, v1
v_mul_u32_u24 v24, 288, v24
v_lshl_add_u32 v8, s44, 2, v23
v_cmp_le_u32 vcc, 18, v8
v_lshl_add_u32 v2, v8, 4, v24
v_add_u32 v9, v2, v19
v_cndmask_b32 v2, v2, v9, vcc
v_lshl_add_u32 v8, s45, 2, v23
v_cmp_le_u32 vcc, 18, v8
v_lshl_add_u32 v4, v8, 4, v24
v_add_u32 v9, v4, v19
v_cndmask_b32 v4, v4, v9, vcc
v_add_u32 v8, 32, v23
v_cmp_le_u32 vcc, 18, v8
v_lshl_add_u32 v6, v8, 4, v24
v_add_u32 v9, v6, v19
v_cndmask_b32 v6, v6, v9, vcc
s_and_b32 s46, s55, 15
s_lshr_b32 s47, s55, 4
s_mul_i32 s62, s46, 165888
s_mul_i32 s51, s47, 9216
s_add_u32 s62, s62, s51
s_add_u32 s63, s62, 82944
s_mov_b32 s26, 2571264
s_mov_b32 s27, 0x20000
s_mov_b32 s31, s27
s_cmp_lg_u32 s46, 15
s_cselect_b32 s30, s26, 0
s_mov_b32 m0, s58
s_waitcnt lgkmcnt(0)
s_mov_b32 s24, s6
s_and_b32 s25, s7, 0xffff
s_mov_b32 s28, s6
s_and_b32 s29, s7, 0xffff
s_cmp_ge_u32 s94, 240
s_cbranch_scc1 L_a3
buffer_load_dwordx4 v2, s[24:27], s62 offen lds
s_addk_i32 m0, 1024
s_nop 0
buffer_load_dwordx4 v2, s[28:31], s63 offen lds
s_addk_i32 m0, 1024
s_nop 0
buffer_load_dwordx4 v4, s[24:27], s62 offen lds
s_addk_i32 m0, 1024
s_nop 0
buffer_load_dwordx4 v4, s[28:31], s63 offen lds
s_addk_i32 m0, 13312
s_cmp_lg_u32 s56, 0
s_cbranch_scc1 L_a3
buffer_load_dwordx4 v6, s[24:27], s62 offen lds
s_addk_i32 m0, 1024
s_nop 0
buffer_load_dwordx4 v6, s[28:31], s63 offen lds
L_a3:
s_cmp_lg_u32 s57, 0
s_cbranch_scc1 L_a4
s_load_dword s59, s[12:13], 65536
s_lshr_b32 s90, 0x33, s47
s_and_b32 s90, s90, 1
s_sub_u32 s91, 2, s90
s_lshl_b32 s51, s47, 1
s_lshr_b32 s92, 258048, s51
s_and_b32 s92, s92, 3
s_lshr_b32 s51, s47, 1
s_cmp_ge_u32 s2, 144
s_cselect_b32 s90, 0, s90
s_cselect_b32 s91, 3, s91
s_cselect_b32 s92, s51, s92
s_cmp_ge_u32 s2, 176
s_cselect_b32 s91, 0, s91
s_cmp_ge_u32 s2, 240
s_cselect_b32 s92, 0, s92
s_cmp_lg_u32 s90, 0
s_cbranch_scc1 L_a4
s_barrier
L_a4:
s_mov_b32 s53, 0xffff0000
s_mov_b32 s61, 0
s_mov_b32 s32, s12
s_and_b32 s33, s13, 0xffff
s_mov_b32 s34, 16777216
s_mov_b32 s35, 0x20000
s_mov_b32 s40, s10
s_and_b32 s41, s11, 0xffff
s_mov_b32 s42, 256
s_mov_b32 s43, 0x20000
v_mov_b32 v10, 138240
v_mov_b32 v20, 4289880320
v_mov_b32 v26, 282624
v_bfe_u32 v21, v1, 2, 2
v_lshlrev_b32 v21, 7, v21
v_and_b32 v22, 1, v1
v_lshl_add_u32 v21, v22, 6, v21
v_bfe_u32 v22, v1, 1, 1
v_lshl_add_u32 v21, v22, 3, v21
v_lshrrev_b32 v22, 4, v1
v_lshl_add_u32 v21, v22, 4, v21
v_add_u32 v21, s58, v21
v_and_b32 v25, 15, v1
v_lshlrev_b32 v25, 4, v25
v_lshl_add_u32 v8, s44, 2, v22
v_cmp_le_u32 vcc, 18, v8
v_mad_u32_u24 v52, v8, v26, v25
v_add_u32 v9, v52, v20
v_cndmask_b32 v52, v52, v9, vcc
v_lshl_add_u32 v8, s45, 2, v22
v_cmp_le_u32 vcc, 18, v8
v_mad_u32_u24 v53, v8, v26, v25
v_add_u32 v9, v53, v20
v_cndmask_b32 v53, v53, v9, vcc
v_add_u32 v8, 32, v22
v_cmp_le_u32 vcc, 18, v8
v_mad_u32_u24 v54, v8, v26, v25
v_add_u32 v9, v54, v20
v_cndmask_b32 v54, v54, v9, vcc
s_lshr_b32 s97, 0x33, s47
s_and_b32 s97, s97, 1
s_cmp_eq_u32 s14, 4
s_cselect_b32 s51, 1, s90
s_cmp_lg_u32 s51, 0
s_cselect_b32 s51, 4, -16
v_mov_b32 v9, s51
s_waitcnt lgkmcnt(0)
s_mov_b64 exec, 1
buffer_load_dword v27, v9, s[40:43], 0 offen sc1
s_mov_b64 exec, -1
s_lshr_b32 s96, s47, 2
s_lshl_b32 s96, s96, 4
s_add_u32 s96, s96, s46
s_lshl_b32 s96, s96, 2
s_and_b32 s51, s47, 1
s_add_u32 s96, s96, s51
s_lshl_b32 s96, s96, 9
s_add_u32 s96, s96, 1265664
s_lshr_b32 s48, s47, 1
s_and_b32 s49, s46, 7
s_lshr_b32 s50, s46, 3
s_and_b32 s51, s47, 1
s_cmp_eq_u32 s47, 8
s_cselect_b32 s49, s49, s46
s_cselect_b32 s50, s50, s51
s_lshl_b32 s50, s50, 9
s_add_u32 s50, s50, 1048576
s_lshl_b32 s51, s48, 4
s_add_u32 s64, s51, s49
s_sub_u32 s65, s64, s48
s_cmp_ge_u32 s48, 2
s_cselect_b32 s66, 74, 0
s_add_u32 s66, s66, s64
s_cmp_lt_u32 s49, 2
s_cselect_b32 s51, 32, 136
s_add_u32 s51, s51, s49
s_cmp_eq_u32 s47, 8
s_cselect_b32 s66, s51, s66
s_add_u32 s64, s64, 34
s_add_u32 s65, s65, 144
s_lshl_b32 s64, s64, 10
s_add_u32 s64, s64, s50
s_lshl_b32 s65, s65, 10
s_add_u32 s65, s65, s50
s_lshl_b32 s66, s66, 10
s_add_u32 s66, s66, s50
s_cmp_eq_u32 s47, 8
s_cselect_b32 s51, 1, 2
s_cmp_eq_u32 s46, 15
s_cselect_b32 s67, s51, 0
s_lshl_b32 s46, s14, 2
s_add_u32 s46, s46, 138256
v_mov_b32 v55, s46
s_waitcnt vmcnt(1)
s_cmp_ge_u32 s94, 240
s_cbranch_scc1 L_x9
ds_read_b64_tr_b16 v[28:29], v21 offset:0
ds_read_b64_tr_b16 v[30:31], v21 offset:512
ds_read_b64_tr_b16 v[32:33], v21 offset:1024
ds_read_b64_tr_b16 v[34:35], v21 offset:1536
ds_read_b64_tr_b16 v[36:37], v21 offset:2048
ds_read_b64_tr_b16 v[38:39], v21 offset:2560
ds_read_b64_tr_b16 v[40:41], v21 offset:3072
ds_read_b64_tr_b16 v[42:43], v21 offset:3584
ds_read_b64_tr_b16 v[44:45], v21 offset:16384
ds_read_b64_tr_b16 v[46:47], v21 offset:16896
ds_read_b64_tr_b16 v[48:49], v21 offset:17408
ds_read_b64_tr_b16 v[50:51], v21 offset:17920
s_or_b32 s46, s90, s57
s_cmp_eq_u32 s91, 2
s_cselect_b32 s47, 1, s46
s_mov_b32 s46, s47
s_cmp_eq_u32 s47, 0
s_cbranch_scc1 L_x9
s_cmp_eq_u32 s97, 0
s_cbranch_scc1 L_x7
s_waitcnt vmcnt(0)
v_readfirstlane_b32 s48, v27
s_add_u32 s49, s59, 2654435769
s_not_b32 s47, s49
s_or_b32 s48, s48, s57
s_cselect_b32 s49, s47, s49
v_mov_b32 v209, s49
v_mov_b32 v214, s49
v_mov_b32 v217, s49
v_mov_b32 v222, s49
v_mov_b32 v225, s49
v_mov_b32 v230, s49
L_x7:
s_cmp_lg_u32 s91, 2
s_cbranch_scc1 L_x8
L_xs:
ds_read_b32 v11, v10 offset:8
s_waitcnt lgkmcnt(0)
v_cmp_le_u32 vcc, 262144, v11
s_nop 4
s_cbranch_vccnz L_x8
s_sleep 1
s_branch L_xs
L_x8:
s_waitcnt lgkmcnt(8)
v_lshlrev_b32 v64, 16, v28
v_and_b32 v65, s53, v28
v_lshlrev_b32 v66, 16, v29
v_and_b32 v67, s53, v29
v_lshlrev_b32 v68, 16, v30
v_and_b32 v69, s53, v30
v_lshlrev_b32 v70, 16, v31
v_and_b32 v71, s53, v31
v_lshlrev_b32 v72, 16, v32
v_and_b32 v73, s53, v32
v_lshlrev_b32 v74, 16, v33
v_and_b32 v75, s53, v33
v_lshlrev_b32 v76, 16, v34
v_and_b32 v77, s53, v34
v_lshlrev_b32 v78, 16, v35
v_and_b32 v79, s53, v35
v_pk_add_f32 v[64:65], v[64:65], v[72:73]
v_pk_add_f32 v[66:67], v[66:67], v[74:75]
v_pk_add_f32 v[68:69], v[68:69], v[76:77]
v_pk_add_f32 v[70:71], v[70:71], v[78:79]
v_cvt_pk_bf16_f32 v210, v64, v65
v_cvt_pk_bf16_f32 v211, v66, v67
v_cvt_pk_bf16_f32 v212, v68, v69
v_cvt_pk_bf16_f32 v213, v70, v71
s_cmp_eq_u32 s46, 0
s_cbranch_scc1 L_x50
s_cmp_eq_u32 s97, 0
s_cbranch_scc1 L_x60
buffer_store_dwordx4 v[208:211], v52, s[32:35], s96 offen sc1
buffer_store_dwordx4 v[212:215], v52, s[32:35], s96 offen offset:1024 sc1
s_branch L_x50
L_x60:
buffer_store_dwordx4 v[210:213], v52, s[32:35], s66 offen sc1
L_x50:
s_waitcnt lgkmcnt(4)
v_lshlrev_b32 v80, 16, v36
v_and_b32 v81, s53, v36
v_lshlrev_b32 v82, 16, v37
v_and_b32 v83, s53, v37
v_lshlrev_b32 v84, 16, v38
v_and_b32 v85, s53, v38
v_lshlrev_b32 v86, 16, v39
v_and_b32 v87, s53, v39
v_lshlrev_b32 v88, 16, v40
v_and_b32 v89, s53, v40
v_lshlrev_b32 v90, 16, v41
v_and_b32 v91, s53, v41
v_lshlrev_b32 v92, 16, v42
v_and_b32 v93, s53, v42
v_lshlrev_b32 v94, 16, v43
v_and_b32 v95, s53, v43
v_pk_add_f32 v[80:81], v[80:81], v[88:89]
v_pk_add_f32 v[82:83], v[82:83], v[90:91]
v_pk_add_f32 v[84:85], v[84:85], v[92:93]
v_pk_add_f32 v[86:87], v[86:87], v[94:95]
v_cvt_pk_bf16_f32 v218, v80, v81
v_cvt_pk_bf16_f32 v219, v82, v83
v_cvt_pk_bf16_f32 v220, v84, v85
v_cvt_pk_bf16_f32 v221, v86, v87
s_cmp_eq_u32 s46, 0
s_cbranch_scc1 L_x51
s_cmp_eq_u32 s97, 0
s_cbranch_scc1 L_x61
buffer_store_dwordx4 v[216:219], v53, s[32:35], s96 offen sc1
buffer_store_dwordx4 v[220:223], v53, s[32:35], s96 offen offset:1024 sc1
s_branch L_x51
L_x61:
buffer_store_dwordx4 v[218:221], v53, s[32:35], s66 offen sc1
L_x51:
s_cmp_lg_u32 s56, 0
s_cbranch_scc1 L_x3
s_waitcnt lgkmcnt(0)
v_lshlrev_b32 v96, 16, v44
v_and_b32 v97, s53, v44
v_lshlrev_b32 v98, 16, v45
v_and_b32 v99, s53, v45
v_lshlrev_b32 v100, 16, v46
v_and_b32 v101, s53, v46
v_lshlrev_b32 v102, 16, v47
v_and_b32 v103, s53, v47
v_lshlrev_b32 v104, 16, v48
v_and_b32 v105, s53, v48
v_lshlrev_b32 v106, 16, v49
v_and_b32 v107, s53, v49
v_lshlrev_b32 v108, 16, v50
v_and_b32 v109, s53, v50
v_lshlrev_b32 v110, 16, v51
v_and_b32 v111, s53, v51
v_pk_add_f32 v[96:97], v[96:97], v[104:105]
v_pk_add_f32 v[98:99], v[98:99], v[106:107]
v_pk_add_f32 v[100:101], v[100:101], v[108:109]
v_pk_add_f32 v[102:103], v[102:103], v[110:111]
v_cvt_pk_bf16_f32 v226, v96, v97
v_cvt_pk_bf16_f32 v227, v98, v99
v_cvt_pk_bf16_f32 v228, v100, v101
v_cvt_pk_bf16_f32 v229, v102, v103
s_cmp_eq_u32 s46, 0
s_cbranch_scc1 L_x52
s_cmp_eq_u32 s97, 0
s_cbranch_scc1 L_x62
buffer_store_dwordx4 v[224:227], v54, s[32:35], s96 offen sc1
buffer_store_dwordx4 v[228:231], v54, s[32:35], s96 offen offset:1024 sc1
s_branch L_x52
L_x62:
buffer_store_dwordx4 v[226:229], v54, s[32:35], s66 offen sc1
L_x52:
L_x3:
s_cmp_eq_u32 s57, 0
s_cbranch_scc1 L_x9
L_x2:
s_waitcnt lgkmcnt(0)
buffer_store_dwordx4 v[28:31], v52, s[32:35], s64 offen sc1
s_cmp_eq_u32 s67, 2
s_cbranch_scc1 L_skip1
buffer_store_dwordx4 v[32:35], v52, s[32:35], s65 offen sc1
L_skip1:
buffer_store_dwordx4 v[36:39], v53, s[32:35], s64 offen sc1
s_cmp_eq_u32 s67, 2
s_cbranch_scc1 L_skip2
buffer_store_dwordx4 v[40:43], v53, s[32:35], s65 offen sc1
L_skip2:
s_cmp_lg_u32 s56, 0
s_cbranch_scc1 L_x4
buffer_store_dwordx4 v[44:47], v54, s[32:35], s64 offen sc1
s_cmp_eq_u32 s67, 2
s_cbranch_scc1 L_skip3
buffer_store_dwordx4 v[48:51], v54, s[32:35], s65 offen sc1
L_skip3:
L_x4:
s_cmp_eq_u32 s57, 0
s_cbranch_scc1 L_x9
s_waitcnt vmcnt(0)
s_add_u32 s55, s55, 1
s_cmp_lt_u32 s55, 144
s_cbranch_scc1 L_prod
v_mov_b32 v11, 1
ds_write_b32 v10, v11 offset:12
s_endpgm
L_x9:
s_cmp_eq_u32 s90, 0
s_cbranch_scc1 L_x10
s_barrier
L_x10:
s_and_b32 s44, s2, 7
s_lshr_b32 s45, s2, 3
s_mul_i32 s46, s44, 31
s_min_u32 s44, s44, 4
s_add_u32 s46, s46, s44
s_add_u32 s46, s46, s45
s_mul_hi_u32 s47, s46, 477218589
s_mul_i32 s48, s47, 9
s_sub_u32 s15, s46, s48
s_and_b32 s17, s47, 1
s_lshr_b32 s47, s47, 1
s_cmp_ge_u32 s47, 7
s_cselect_b32 s19, 1152000, 0
s_cselect_b32 s48, 7, 0
s_sub_u32 s18, s47, s48
s_mul_i32 s52, s18, 576
s_add_u32 s52, s52, s17
s_sub_u32 s52, s52, 60
s_mul_i32 s52, s52, 288
v_subrev_u32 v4, 256, v0
v_min_u32 v4, 251, v4
v_mul_u32_u24 v3, 3641, v4
v_lshrrev_b32 v3, 16, v3
v_mul_u32_u24 v2, 18, v3
v_sub_u32 v2, v4, v2
v_mul_u32_u24 v3, 12, v3
v_min_u32 v3, 148, v3
v_mul_u32_u24 v4, 1152, v3
v_lshl_add_u32 v4, v2, 4, v4
v_add_u32 v12, s52, v4
v_mul_u32_u24 v18, 288, v3
v_lshl_add_u32 v18, v2, 4, v18
v_add_u32 v19, 92160, v18
s_add_u32 s20, s4, s19
s_addc_u32 s21, s5, 0
s_and_b32 s21, s21, 0xffff
s_mov_b32 s22, 1152000
s_mov_b32 s23, 0x20000
s_add_u32 s46, s59, 2654435769
v_mov_b32 v56, s46
s_lshl_b32 s46, s2, 7
v_mov_b32 v58, s46
s_add_u32 s46, s55, 144
s_lshl_b32 s46, s46, 7
v_mov_b32 v59, s46
s_cmp_lg_u32 s91, 2
s_cbranch_scc1 L_noflag
s_mov_b64 exec, 1
s_waitcnt vmcnt(0)
v_cmp_ne_u32 vcc, 0, v27
v_not_b32 v57, v56
s_nop 0
v_cndmask_b32 v57, v56, v57, vcc
ds_write_b32 v55, v57 offset:0
ds_read_b128 v[20:23], v10 offset:32
s_waitcnt lgkmcnt(0)
v_xor_b32 v20, v20, v56
v_xor_b32 v21, v21, v56
v_xor_b32 v22, v22, v56
v_xor_b32 v23, v23, v56
v_or3_b32 v20, v20, v21, v22
v_or_b32 v20, v20, v23
v_cmp_eq_u32 vcc, 0, v20
s_and_b64 exec, exec, vcc
s_cbranch_execz L_nlx
buffer_store_dword v56, v58, s[32:35], 0 offen sc1
L_nlx:
s_mov_b64 exec, -1
s_mov_b32 s91, 0
L_noflag:
s_setprio 0
s_cmp_eq_u32 s67, 2
s_cselect_b32 s46, 0x80000000, 0
s_cmp_lg_u32 s56, 0
s_cselect_b32 s47, 0x80000000, 0
s_or_b32 s48, s46, s47
v_mov_b32 v232, v52
v_or_b32 v233, s46, v52
v_mov_b32 v234, v53
v_or_b32 v235, s46, v53
v_or_b32 v236, s47, v54
v_or_b32 v237, s48, v54
L_lwo:
ds_read_b32 v11, v10 offset:8
s_waitcnt lgkmcnt(0)
v_and_b32 v11, 0xff, v11
v_cmp_eq_u32 vcc, 4, v11
s_nop 4
s_cbranch_vccnz L_lxo
s_sleep 1
s_branch L_lwo
L_lxo:
s_cmp_lg_u32 s91, 2
s_cbranch_scc1 L_nox
s_cmp_eq_u32 s91, 3
s_cbranch_scc1 L_xd
buffer_store_dwordx4 v[210:213], v232, s[32:35], s66 offen sc1
buffer_store_dwordx4 v[218:221], v234, s[32:35], s66 offen sc1
buffer_store_dwordx4 v[226:229], v236, s[32:35], s66 offen sc1
s_branch L_xe
L_xd:
buffer_store_dwordx4 v[28:31], v232, s[32:35], s64 offen sc1
buffer_store_dwordx4 v[32:35], v233, s[32:35], s65 offen sc1
buffer_store_dwordx4 v[36:39], v234, s[32:35], s64 offen sc1
buffer_store_dwordx4 v[40:43], v235, s[32:35], s65 offen sc1
buffer_store_dwordx4 v[44:47], v236, s[32:35], s64 offen sc1
buffer_store_dwordx4 v[48:51], v237, s[32:35], s65 offen sc1
L_xe:
v_mov_b32 v11, 0x100
s_mov_b64 exec, 1
ds_add_u32 v10, v11 offset:8
s_mov_b64 exec, -1
s_mov_b64 exec, 1
s_waitcnt vmcnt(0)
v_cmp_ne_u32 vcc, 0, v27
v_not_b32 v57, v56
s_nop 0
v_cndmask_b32 v57, v56, v57, vcc
ds_write_b32 v55, v57 offset:0
ds_read_b128 v[20:23], v10 offset:32
s_waitcnt lgkmcnt(0)
v_xor_b32 v20, v20, v56
v_xor_b32 v21, v21, v56
v_xor_b32 v22, v22, v56
v_xor_b32 v23, v23, v56
v_or3_b32 v20, v20, v21, v22
v_or_b32 v20, v20, v23
v_cmp_eq_u32 vcc, 0, v20
s_and_b64 exec, exec, vcc
s_cbranch_execz L_nlx2
buffer_store_dword v56, v58, s[32:35], 0 offen sc1
L_nlx2:
s_mov_b64 exec, -1
s_branch L_nox2
L_nox:
v_mov_b32 v11, 0x100
s_mov_b64 exec, 1
ds_add_u32 v10, v11 offset:8
s_mov_b64 exec, -1
L_nox2:
buffer_load_dwordx4 v[64:67], v12, s[20:23], 0 offen
v_add_u32 v14, 1152, v12
buffer_load_dwordx4 v[68:71], v14, s[20:23], 0 offen
v_add_u32 v15, 2304, v12
buffer_load_dwordx4 v[72:75], v15, s[20:23], 0 offen
v_add_u32 v16, 3456, v12
buffer_load_dwordx4 v[76:79], v16, s[20:23], 0 offen
ds_read_b128 v[120:123], v18 offset:46080
ds_read_b128 v[124:127], v18 offset:46368
ds_read_b128 v[128:131], v18 offset:46656
ds_read_b128 v[132:135], v18 offset:46944
ds_read_b128 v[136:139], v18 offset:47232
ds_read_b128 v[140:143], v18 offset:47520
ds_read_b128 v[144:147], v18 offset:47808
ds_read_b128 v[148:151], v18 offset:48096
ds_read_b128 v[152:155], v18 offset:48384
ds_read_b128 v[156:159], v18 offset:48672
ds_read_b128 v[160:163], v18 offset:48960
ds_read_b128 v[164:167], v18 offset:49248
s_waitcnt vmcnt(3)
v_lshlrev_b32 v184, 16, v64
v_and_b32 v185, s53, v64
v_lshlrev_b32 v186, 16, v65
v_and_b32 v187, s53, v65
v_lshlrev_b32 v188, 16, v66
v_and_b32 v189, s53, v66
v_lshlrev_b32 v190, 16, v67
v_and_b32 v191, s53, v67
v_add_u32 v13, 4608, v12
buffer_load_dwordx4 v[80:83], v13, s[20:23], 0 offen
s_waitcnt lgkmcnt(0)
v_lshlrev_b32 v200, 16, v120
v_and_b32 v201, s53, v120
v_lshlrev_b32 v202, 16, v121
v_and_b32 v203, s53, v121
v_lshlrev_b32 v204, 16, v122
v_and_b32 v205, s53, v122
v_lshlrev_b32 v206, 16, v123
v_and_b32 v207, s53, v123
v_sub_f32 v208, v184, v200
v_sub_f32 v209, v185, v201
v_sub_f32 v210, v186, v202
v_sub_f32 v211, v187, v203
v_sub_f32 v212, v188, v204
v_sub_f32 v213, v189, v205
v_sub_f32 v214, v190, v206
v_sub_f32 v215, v191, v207
v_cvt_pk_bf16_f32 v216, v208, v209
v_cvt_pk_bf16_f32 v217, v210, v211
v_cvt_pk_bf16_f32 v218, v212, v213
v_cvt_pk_bf16_f32 v219, v214, v215
ds_write_b128 v18, v[216:219] offset:0
s_waitcnt vmcnt(3)
v_lshlrev_b32 v192, 16, v68
v_and_b32 v193, s53, v68
v_lshlrev_b32 v194, 16, v69
v_and_b32 v195, s53, v69
v_lshlrev_b32 v196, 16, v70
v_and_b32 v197, s53, v70
v_lshlrev_b32 v198, 16, v71
v_and_b32 v199, s53, v71
v_add_u32 v14, 5760, v12
buffer_load_dwordx4 v[84:87], v14, s[20:23], 0 offen
v_sub_f32 v208, v192, v200
v_sub_f32 v209, v193, v201
v_sub_f32 v210, v194, v202
v_sub_f32 v211, v195, v203
v_sub_f32 v212, v196, v204
v_sub_f32 v213, v197, v205
v_sub_f32 v214, v198, v206
v_sub_f32 v215, v199, v207
v_cvt_pk_bf16_f32 v220, v208, v209
v_cvt_pk_bf16_f32 v221, v210, v211
v_cvt_pk_bf16_f32 v222, v212, v213
v_cvt_pk_bf16_f32 v223, v214, v215
ds_write_b128 v19, v[220:223] offset:0
v_lshlrev_b32 v200, 16, v124
v_and_b32 v201, s53, v124
v_lshlrev_b32 v202, 16, v125
v_and_b32 v203, s53, v125
v_lshlrev_b32 v204, 16, v126
v_and_b32 v205, s53, v126
v_lshlrev_b32 v206, 16, v127
v_and_b32 v207, s53, v127
v_sub_f32 v208, v192, v200
v_sub_f32 v209, v193, v201
v_sub_f32 v210, v194, v202
v_sub_f32 v211, v195, v203
v_sub_f32 v212, v196, v204
v_sub_f32 v213, v197, v205
v_sub_f32 v214, v198, v206
v_sub_f32 v215, v199, v207
v_cvt_pk_bf16_f32 v224, v208, v209
v_cvt_pk_bf16_f32 v225, v210, v211
v_cvt_pk_bf16_f32 v226, v212, v213
v_cvt_pk_bf16_f32 v227, v214, v215
ds_write_b128 v18, v[224:227] offset:288
s_waitcnt vmcnt(3)
v_lshlrev_b32 v184, 16, v72
v_and_b32 v185, s53, v72
v_lshlrev_b32 v186, 16, v73
v_and_b32 v187, s53, v73
v_lshlrev_b32 v188, 16, v74
v_and_b32 v189, s53, v74
v_lshlrev_b32 v190, 16, v75
v_and_b32 v191, s53, v75
v_add_u32 v15, 6912, v12
buffer_load_dwordx4 v[88:91], v15, s[20:23], 0 offen
v_sub_f32 v208, v184, v200
v_sub_f32 v209, v185, v201
v_sub_f32 v210, v186, v202
v_sub_f32 v211, v187, v203
v_sub_f32 v212, v188, v204
v_sub_f32 v213, v189, v205
v_sub_f32 v214, v190, v206
v_sub_f32 v215, v191, v207
v_cvt_pk_bf16_f32 v228, v208, v209
v_cvt_pk_bf16_f32 v229, v210, v211
v_cvt_pk_bf16_f32 v230, v212, v213
v_cvt_pk_bf16_f32 v231, v214, v215
ds_write_b128 v19, v[228:231] offset:288
s_cmp_lg_u32 s91, 3
s_cbranch_scc1 L_yn1
buffer_store_dwordx4 v[28:31], v232, s[32:35], s64 offen sc1
buffer_store_dwordx4 v[32:35], v233, s[32:35], s65 offen sc1
buffer_store_dwordx4 v[36:39], v234, s[32:35], s64 offen sc1
buffer_store_dwordx4 v[40:43], v235, s[32:35], s65 offen sc1
buffer_store_dwordx4 v[44:47], v236, s[32:35], s64 offen sc1
buffer_store_dwordx4 v[48:51], v237, s[32:35], s65 offen sc1
L_yn1:
v_lshlrev_b32 v200, 16, v128
v_and_b32 v201, s53, v128
v_lshlrev_b32 v202, 16, v129
v_and_b32 v203, s53, v129
v_lshlrev_b32 v204, 16, v130
v_and_b32 v205, s53, v130
v_lshlrev_b32 v206, 16, v131
v_and_b32 v207, s53, v131
v_sub_f32 v208, v184, v200
v_sub_f32 v209, v185, v201
v_sub_f32 v210, v186, v202
v_sub_f32 v211, v187, v203
v_sub_f32 v212, v188, v204
v_sub_f32 v213, v189, v205
v_sub_f32 v214, v190, v206
v_sub_f32 v215, v191, v207
v_cvt_pk_bf16_f32 v216, v208, v209
v_cvt_pk_bf16_f32 v217, v210, v211
v_cvt_pk_bf16_f32 v218, v212, v213
v_cvt_pk_bf16_f32 v219, v214, v215
ds_write_b128 v18, v[216:219] offset:576
s_waitcnt vmcnt(3)
v_lshlrev_b32 v192, 16, v76
v_and_b32 v193, s53, v76
v_lshlrev_b32 v194, 16, v77
v_and_b32 v195, s53, v77
v_lshlrev_b32 v196, 16, v78
v_and_b32 v197, s53, v78
v_lshlrev_b32 v198, 16, v79
v_and_b32 v199, s53, v79
v_add_u32 v16, 8064, v12
buffer_load_dwordx4 v[92:95], v16, s[20:23], 0 offen
v_sub_f32 v208, v192, v200
v_sub_f32 v209, v193, v201
v_sub_f32 v210, v194, v202
v_sub_f32 v211, v195, v203
v_sub_f32 v212, v196, v204
v_sub_f32 v213, v197, v205
v_sub_f32 v214, v198, v206
v_sub_f32 v215, v199, v207
v_cvt_pk_bf16_f32 v220, v208, v209
v_cvt_pk_bf16_f32 v221, v210, v211
v_cvt_pk_bf16_f32 v222, v212, v213
v_cvt_pk_bf16_f32 v223, v214, v215
ds_write_b128 v19, v[220:223] offset:576
s_cmp_lg_u32 s91, 3
s_cbranch_scc1 L_yn2
s_mov_b64 exec, 1
s_waitcnt vmcnt(0)
v_cmp_ne_u32 vcc, 0, v27
v_not_b32 v57, v56
s_nop 0
v_cndmask_b32 v57, v56, v57, vcc
ds_write_b32 v55, v57 offset:0
ds_read_b128 v[20:23], v10 offset:32
s_waitcnt lgkmcnt(0)
v_xor_b32 v20, v20, v56
v_xor_b32 v21, v21, v56
v_xor_b32 v22, v22, v56
v_xor_b32 v23, v23, v56
v_or3_b32 v20, v20, v21, v22
v_or_b32 v20, v20, v23
v_cmp_eq_u32 vcc, 0, v20
s_and_b64 exec, exec, vcc
s_cbranch_execz L_nlyn
buffer_store_dword v56, v58, s[32:35], 0 offen sc1
L_nlyn:
s_mov_b64 exec, -1
L_yn2:
v_lshlrev_b32 v200, 16, v132
v_and_b32 v201, s53, v132
v_lshlrev_b32 v202, 16, v133
v_and_b32 v203, s53, v133
v_lshlrev_b32 v204, 16, v134
v_and_b32 v205, s53, v134
v_lshlrev_b32 v206, 16, v135
v_and_b32 v207, s53, v135
v_sub_f32 v208, v192, v200
v_sub_f32 v209, v193, v201
v_sub_f32 v210, v194, v202
v_sub_f32 v211, v195, v203
v_sub_f32 v212, v196, v204
v_sub_f32 v213, v197, v205
v_sub_f32 v214, v198, v206
v_sub_f32 v215, v199, v207
v_cvt_pk_bf16_f32 v224, v208, v209
v_cvt_pk_bf16_f32 v225, v210, v211
v_cvt_pk_bf16_f32 v226, v212, v213
v_cvt_pk_bf16_f32 v227, v214, v215
ds_write_b128 v18, v[224:227] offset:864
s_waitcnt vmcnt(3)
v_lshlrev_b32 v184, 16, v80
v_and_b32 v185, s53, v80
v_lshlrev_b32 v186, 16, v81
v_and_b32 v187, s53, v81
v_lshlrev_b32 v188, 16, v82
v_and_b32 v189, s53, v82
v_lshlrev_b32 v190, 16, v83
v_and_b32 v191, s53, v83
v_add_u32 v13, 9216, v12
buffer_load_dwordx4 v[96:99], v13, s[20:23], 0 offen
v_sub_f32 v208, v184, v200
v_sub_f32 v209, v185, v201
v_sub_f32 v210, v186, v202
v_sub_f32 v211, v187, v203
v_sub_f32 v212, v188, v204
v_sub_f32 v213, v189, v205
v_sub_f32 v214, v190, v206
v_sub_f32 v215, v191, v207
v_cvt_pk_bf16_f32 v228, v208, v209
v_cvt_pk_bf16_f32 v229, v210, v211
v_cvt_pk_bf16_f32 v230, v212, v213
v_cvt_pk_bf16_f32 v231, v214, v215
ds_write_b128 v19, v[228:231] offset:864
v_lshlrev_b32 v200, 16, v136
v_and_b32 v201, s53, v136
v_lshlrev_b32 v202, 16, v137
v_and_b32 v203, s53, v137
v_lshlrev_b32 v204, 16, v138
v_and_b32 v205, s53, v138
v_lshlrev_b32 v206, 16, v139
v_and_b32 v207, s53, v139
v_sub_f32 v208, v184, v200
v_sub_f32 v209, v185, v201
v_sub_f32 v210, v186, v202
v_sub_f32 v211, v187, v203
v_sub_f32 v212, v188, v204
v_sub_f32 v213, v189, v205
v_sub_f32 v214, v190, v206
v_sub_f32 v215, v191, v207
v_cvt_pk_bf16_f32 v216, v208, v209
v_cvt_pk_bf16_f32 v217, v210, v211
v_cvt_pk_bf16_f32 v218, v212, v213
v_cvt_pk_bf16_f32 v219, v214, v215
ds_write_b128 v18, v[216:219] offset:1152
s_waitcnt vmcnt(3)
v_lshlrev_b32 v192, 16, v84
v_and_b32 v193, s53, v84
v_lshlrev_b32 v194, 16, v85
v_and_b32 v195, s53, v85
v_lshlrev_b32 v196, 16, v86
v_and_b32 v197, s53, v86
v_lshlrev_b32 v198, 16, v87
v_and_b32 v199, s53, v87
v_add_u32 v14, 10368, v12
buffer_load_dwordx4 v[100:103], v14, s[20:23], 0 offen
v_sub_f32 v208, v192, v200
v_sub_f32 v209, v193, v201
v_sub_f32 v210, v194, v202
v_sub_f32 v211, v195, v203
v_sub_f32 v212, v196, v204
v_sub_f32 v213, v197, v205
v_sub_f32 v214, v198, v206
v_sub_f32 v215, v199, v207
v_cvt_pk_bf16_f32 v220, v208, v209
v_cvt_pk_bf16_f32 v221, v210, v211
v_cvt_pk_bf16_f32 v222, v212, v213
v_cvt_pk_bf16_f32 v223, v214, v215
ds_write_b128 v19, v[220:223] offset:1152
s_cmp_lg_u32 s92, 1
s_cbranch_scc1 L_ym1
buffer_store_dwordx4 v[28:31], v232, s[32:35], s64 offen sc1
buffer_store_dwordx4 v[32:35], v233, s[32:35], s65 offen sc1
buffer_store_dwordx4 v[36:39], v234, s[32:35], s64 offen sc1
buffer_store_dwordx4 v[40:43], v235, s[32:35], s65 offen sc1
buffer_store_dwordx4 v[44:47], v236, s[32:35], s64 offen sc1
buffer_store_dwordx4 v[48:51], v237, s[32:35], s65 offen sc1
L_ym1:
v_lshlrev_b32 v200, 16, v140
v_and_b32 v201, s53, v140
v_lshlrev_b32 v202, 16, v141
v_and_b32 v203, s53, v141
v_lshlrev_b32 v204, 16, v142
v_and_b32 v205, s53, v142
v_lshlrev_b32 v206, 16, v143
v_and_b32 v207, s53, v143
v_sub_f32 v208, v192, v200
v_sub_f32 v209, v193, v201
v_sub_f32 v210, v194, v202
v_sub_f32 v211, v195, v203
v_sub_f32 v212, v196, v204
v_sub_f32 v213, v197, v205
v_sub_f32 v214, v198, v206
v_sub_f32 v215, v199, v207
v_cvt_pk_bf16_f32 v224, v208, v209
v_cvt_pk_bf16_f32 v225, v210, v211
v_cvt_pk_bf16_f32 v226, v212, v213
v_cvt_pk_bf16_f32 v227, v214, v215
ds_write_b128 v18, v[224:227] offset:1440
s_waitcnt vmcnt(3)
v_lshlrev_b32 v184, 16, v88
v_and_b32 v185, s53, v88
v_lshlrev_b32 v186, 16, v89
v_and_b32 v187, s53, v89
v_lshlrev_b32 v188, 16, v90
v_and_b32 v189, s53, v90
v_lshlrev_b32 v190, 16, v91
v_and_b32 v191, s53, v91
v_add_u32 v15, 11520, v12
buffer_load_dwordx4 v[104:107], v15, s[20:23], 0 offen
v_sub_f32 v208, v184, v200
v_sub_f32 v209, v185, v201
v_sub_f32 v210, v186, v202
v_sub_f32 v211, v187, v203
v_sub_f32 v212, v188, v204
v_sub_f32 v213, v189, v205
v_sub_f32 v214, v190, v206
v_sub_f32 v215, v191, v207
v_cvt_pk_bf16_f32 v228, v208, v209
v_cvt_pk_bf16_f32 v229, v210, v211
v_cvt_pk_bf16_f32 v230, v212, v213
v_cvt_pk_bf16_f32 v231, v214, v215
ds_write_b128 v19, v[228:231] offset:1440
v_lshlrev_b32 v200, 16, v144
v_and_b32 v201, s53, v144
v_lshlrev_b32 v202, 16, v145
v_and_b32 v203, s53, v145
v_lshlrev_b32 v204, 16, v146
v_and_b32 v205, s53, v146
v_lshlrev_b32 v206, 16, v147
v_and_b32 v207, s53, v147
v_sub_f32 v208, v184, v200
v_sub_f32 v209, v185, v201
v_sub_f32 v210, v186, v202
v_sub_f32 v211, v187, v203
v_sub_f32 v212, v188, v204
v_sub_f32 v213, v189, v205
v_sub_f32 v214, v190, v206
v_sub_f32 v215, v191, v207
v_cvt_pk_bf16_f32 v216, v208, v209
v_cvt_pk_bf16_f32 v217, v210, v211
v_cvt_pk_bf16_f32 v218, v212, v213
v_cvt_pk_bf16_f32 v219, v214, v215
ds_write_b128 v18, v[216:219] offset:1728
s_waitcnt vmcnt(3)
v_lshlrev_b32 v192, 16, v92
v_and_b32 v193, s53, v92
v_lshlrev_b32 v194, 16, v93
v_and_b32 v195, s53, v93
v_lshlrev_b32 v196, 16, v94
v_and_b32 v197, s53, v94
v_lshlrev_b32 v198, 16, v95
v_and_b32 v199, s53, v95
v_add_u32 v16, 12672, v12
buffer_load_dwordx4 v[108:111], v16, s[20:23], 0 offen
v_sub_f32 v208, v192, v200
v_sub_f32 v209, v193, v201
v_sub_f32 v210, v194, v202
v_sub_f32 v211, v195, v203
v_sub_f32 v212, v196, v204
v_sub_f32 v213, v197, v205
v_sub_f32 v214, v198, v206
v_sub_f32 v215, v199, v207
v_cvt_pk_bf16_f32 v220, v208, v209
v_cvt_pk_bf16_f32 v221, v210, v211
v_cvt_pk_bf16_f32 v222, v212, v213
v_cvt_pk_bf16_f32 v223, v214, v215
ds_write_b128 v19, v[220:223] offset:1728
s_cmp_lg_u32 s92, 1
s_cbranch_scc1 L_ym2
s_mov_b64 exec, 1
s_waitcnt vmcnt(0)
v_cmp_ne_u32 vcc, 0, v27
v_not_b32 v57, v56
s_nop 0
v_cndmask_b32 v57, v56, v57, vcc
ds_write_b32 v55, v57 offset:16
ds_read_b128 v[20:23], v10 offset:48
s_waitcnt lgkmcnt(0)
v_xor_b32 v20, v20, v56
v_xor_b32 v21, v21, v56
v_xor_b32 v22, v22, v56
v_xor_b32 v23, v23, v56
v_or3_b32 v20, v20, v21, v22
v_or_b32 v20, v20, v23
v_cmp_eq_u32 vcc, 0, v20
s_and_b64 exec, exec, vcc
s_cbranch_execz L_nlym
buffer_store_dword v56, v59, s[32:35], 0 offen sc1
L_nlym:
s_mov_b64 exec, -1
s_mov_b32 s92, 0
L_ym2:
v_lshlrev_b32 v200, 16, v148
v_and_b32 v201, s53, v148
v_lshlrev_b32 v202, 16, v149
v_and_b32 v203, s53, v149
v_lshlrev_b32 v204, 16, v150
v_and_b32 v205, s53, v150
v_lshlrev_b32 v206, 16, v151
v_and_b32 v207, s53, v151
v_sub_f32 v208, v192, v200
v_sub_f32 v209, v193, v201
v_sub_f32 v210, v194, v202
v_sub_f32 v211, v195, v203
v_sub_f32 v212, v196, v204
v_sub_f32 v213, v197, v205
v_sub_f32 v214, v198, v206
v_sub_f32 v215, v199, v207
v_cvt_pk_bf16_f32 v224, v208, v209
v_cvt_pk_bf16_f32 v225, v210, v211
v_cvt_pk_bf16_f32 v226, v212, v213
v_cvt_pk_bf16_f32 v227, v214, v215
ds_write_b128 v18, v[224:227] offset:2016
s_waitcnt vmcnt(3)
v_lshlrev_b32 v184, 16, v96
v_and_b32 v185, s53, v96
v_lshlrev_b32 v186, 16, v97
v_and_b32 v187, s53, v97
v_lshlrev_b32 v188, 16, v98
v_and_b32 v189, s53, v98
v_lshlrev_b32 v190, 16, v99
v_and_b32 v191, s53, v99
v_add_u32 v13, 13824, v12
buffer_load_dwordx4 v[112:115], v13, s[20:23], 0 offen
v_sub_f32 v208, v184, v200
v_sub_f32 v209, v185, v201
v_sub_f32 v210, v186, v202
v_sub_f32 v211, v187, v203
v_sub_f32 v212, v188, v204
v_sub_f32 v213, v189, v205
v_sub_f32 v214, v190, v206
v_sub_f32 v215, v191, v207
v_cvt_pk_bf16_f32 v228, v208, v209
v_cvt_pk_bf16_f32 v229, v210, v211
v_cvt_pk_bf16_f32 v230, v212, v213
v_cvt_pk_bf16_f32 v231, v214, v215
ds_write_b128 v19, v[228:231] offset:2016
v_lshlrev_b32 v200, 16, v152
v_and_b32 v201, s53, v152
v_lshlrev_b32 v202, 16, v153
v_and_b32 v203, s53, v153
v_lshlrev_b32 v204, 16, v154
v_and_b32 v205, s53, v154
v_lshlrev_b32 v206, 16, v155
v_and_b32 v207, s53, v155
v_sub_f32 v208, v184, v200
v_sub_f32 v209, v185, v201
v_sub_f32 v210, v186, v202
v_sub_f32 v211, v187, v203
v_sub_f32 v212, v188, v204
v_sub_f32 v213, v189, v205
v_sub_f32 v214, v190, v206
v_sub_f32 v215, v191, v207
v_cvt_pk_bf16_f32 v216, v208, v209
v_cvt_pk_bf16_f32 v217, v210, v211
v_cvt_pk_bf16_f32 v218, v212, v213
v_cvt_pk_bf16_f32 v219, v214, v215
ds_write_b128 v18, v[216:219] offset:2304
s_waitcnt vmcnt(3)
v_lshlrev_b32 v192, 16, v100
v_and_b32 v193, s53, v100
v_lshlrev_b32 v194, 16, v101
v_and_b32 v195, s53, v101
v_lshlrev_b32 v196, 16, v102
v_and_b32 v197, s53, v102
v_lshlrev_b32 v198, 16, v103
v_and_b32 v199, s53, v103
v_sub_f32 v208, v192, v200
v_sub_f32 v209, v193, v201
v_sub_f32 v210, v194, v202
v_sub_f32 v211, v195, v203
v_sub_f32 v212, v196, v204
v_sub_f32 v213, v197, v205
v_sub_f32 v214, v198, v206
v_sub_f32 v215, v199, v207
v_cvt_pk_bf16_f32 v220, v208, v209
v_cvt_pk_bf16_f32 v221, v210, v211
v_cvt_pk_bf16_f32 v222, v212, v213
v_cvt_pk_bf16_f32 v223, v214, v215
ds_write_b128 v19, v[220:223] offset:2304
v_lshlrev_b32 v200, 16, v156
v_and_b32 v201, s53, v156
v_lshlrev_b32 v202, 16, v157
v_and_b32 v203, s53, v157
v_lshlrev_b32 v204, 16, v158
v_and_b32 v205, s53, v158
v_lshlrev_b32 v206, 16, v159
v_and_b32 v207, s53, v159
v_sub_f32 v208, v192, v200
v_sub_f32 v209, v193, v201
v_sub_f32 v210, v194, v202
v_sub_f32 v211, v195, v203
v_sub_f32 v212, v196, v204
v_sub_f32 v213, v197, v205
v_sub_f32 v214, v198, v206
v_sub_f32 v215, v199, v207
v_cvt_pk_bf16_f32 v224, v208, v209
v_cvt_pk_bf16_f32 v225, v210, v211
v_cvt_pk_bf16_f32 v226, v212, v213
v_cvt_pk_bf16_f32 v227, v214, v215
ds_write_b128 v18, v[224:227] offset:2592
s_waitcnt vmcnt(2)
v_lshlrev_b32 v184, 16, v104
v_and_b32 v185, s53, v104
v_lshlrev_b32 v186, 16, v105
v_and_b32 v187, s53, v105
v_lshlrev_b32 v188, 16, v106
v_and_b32 v189, s53, v106
v_lshlrev_b32 v190, 16, v107
v_and_b32 v191, s53, v107
v_sub_f32 v208, v184, v200
v_sub_f32 v209, v185, v201
v_sub_f32 v210, v186, v202
v_sub_f32 v211, v187, v203
v_sub_f32 v212, v188, v204
v_sub_f32 v213, v189, v205
v_sub_f32 v214, v190, v206
v_sub_f32 v215, v191, v207
v_cvt_pk_bf16_f32 v228, v208, v209
v_cvt_pk_bf16_f32 v229, v210, v211
v_cvt_pk_bf16_f32 v230, v212, v213
v_cvt_pk_bf16_f32 v231, v214, v215
ds_write_b128 v19, v[228:231] offset:2592
v_lshlrev_b32 v200, 16, v160
v_and_b32 v201, s53, v160
v_lshlrev_b32 v202, 16, v161
v_and_b32 v203, s53, v161
v_lshlrev_b32 v204, 16, v162
v_and_b32 v205, s53, v162
v_lshlrev_b32 v206, 16, v163
v_and_b32 v207, s53, v163
v_sub_f32 v208, v184, v200
v_sub_f32 v209, v185, v201
v_sub_f32 v210, v186, v202
v_sub_f32 v211, v187, v203
v_sub_f32 v212, v188, v204
v_sub_f32 v213, v189, v205
v_sub_f32 v214, v190, v206
v_sub_f32 v215, v191, v207
v_cvt_pk_bf16_f32 v216, v208, v209
v_cvt_pk_bf16_f32 v217, v210, v211
v_cvt_pk_bf16_f32 v218, v212, v213
v_cvt_pk_bf16_f32 v219, v214, v215
ds_write_b128 v18, v[216:219] offset:2880
s_waitcnt vmcnt(1)
v_lshlrev_b32 v192, 16, v108
v_and_b32 v193, s53, v108
v_lshlrev_b32 v194, 16, v109
v_and_b32 v195, s53, v109
v_lshlrev_b32 v196, 16, v110
v_and_b32 v197, s53, v110
v_lshlrev_b32 v198, 16, v111
v_and_b32 v199, s53, v111
v_sub_f32 v208, v192, v200
v_sub_f32 v209, v193, v201
v_sub_f32 v210, v194, v202
v_sub_f32 v211, v195, v203
v_sub_f32 v212, v196, v204
v_sub_f32 v213, v197, v205
v_sub_f32 v214, v198, v206
v_sub_f32 v215, v199, v207
v_cvt_pk_bf16_f32 v220, v208, v209
v_cvt_pk_bf16_f32 v221, v210, v211
v_cvt_pk_bf16_f32 v222, v212, v213
v_cvt_pk_bf16_f32 v223, v214, v215
ds_write_b128 v19, v[220:223] offset:2880
v_lshlrev_b32 v200, 16, v164
v_and_b32 v201, s53, v164
v_lshlrev_b32 v202, 16, v165
v_and_b32 v203, s53, v165
v_lshlrev_b32 v204, 16, v166
v_and_b32 v205, s53, v166
v_lshlrev_b32 v206, 16, v167
v_and_b32 v207, s53, v167
v_sub_f32 v208, v192, v200
v_sub_f32 v209, v193, v201
v_sub_f32 v210, v194, v202
v_sub_f32 v211, v195, v203
v_sub_f32 v212, v196, v204
v_sub_f32 v213, v197, v205
v_sub_f32 v214, v198, v206
v_sub_f32 v215, v199, v207
v_cvt_pk_bf16_f32 v224, v208, v209
v_cvt_pk_bf16_f32 v225, v210, v211
v_cvt_pk_bf16_f32 v226, v212, v213
v_cvt_pk_bf16_f32 v227, v214, v215
ds_write_b128 v18, v[224:227] offset:3168
s_waitcnt vmcnt(0)
v_lshlrev_b32 v184, 16, v112
v_and_b32 v185, s53, v112
v_lshlrev_b32 v186, 16, v113
v_and_b32 v187, s53, v113
v_lshlrev_b32 v188, 16, v114
v_and_b32 v189, s53, v114
v_lshlrev_b32 v190, 16, v115
v_and_b32 v191, s53, v115
v_sub_f32 v208, v184, v200
v_sub_f32 v209, v185, v201
v_sub_f32 v210, v186, v202
v_sub_f32 v211, v187, v203
v_sub_f32 v212, v188, v204
v_sub_f32 v213, v189, v205
v_sub_f32 v214, v190, v206
v_sub_f32 v215, v191, v207
v_cvt_pk_bf16_f32 v228, v208, v209
v_cvt_pk_bf16_f32 v229, v210, v211
v_cvt_pk_bf16_f32 v230, v212, v213
v_cvt_pk_bf16_f32 v231, v214, v215
ds_write_b128 v19, v[228:231] offset:3168
L_rowsdone:
s_waitcnt lgkmcnt(0)
v_mov_b32 v11, 1
s_mov_b64 exec, 1
ds_add_u32 v10, v11 offset:16
s_mov_b64 exec, -1
s_cmp_eq_u32 s92, 0
s_cbranch_scc1 L_noy
s_setprio 3
L_yw:
ds_read_b64 v[20:21], v10
s_waitcnt lgkmcnt(0)
v_lshrrev_b32 v21, 14, v21
v_and_b32 v21, -4, v21
v_or_b32 v20, v20, v21
v_cmp_le_u32 vcc, s92, v20
s_nop 4
s_cbranch_vccnz L_yx
s_sleep 4
s_branch L_yw
L_yx:
buffer_store_dwordx4 v[28:31], v232, s[32:35], s64 offen sc1
s_waitcnt vmcnt(6)
buffer_store_dwordx4 v[32:35], v233, s[32:35], s65 offen sc1
s_waitcnt vmcnt(6)
buffer_store_dwordx4 v[36:39], v234, s[32:35], s64 offen sc1
s_waitcnt vmcnt(6)
buffer_store_dwordx4 v[40:43], v235, s[32:35], s65 offen sc1
s_waitcnt vmcnt(6)
buffer_store_dwordx4 v[44:47], v236, s[32:35], s64 offen sc1
s_waitcnt vmcnt(6)
buffer_store_dwordx4 v[48:51], v237, s[32:35], s65 offen sc1
s_waitcnt vmcnt(6)
s_mov_b64 exec, 1
s_waitcnt vmcnt(0)
v_cmp_ne_u32 vcc, 0, v27
v_not_b32 v57, v56
s_nop 0
v_cndmask_b32 v57, v56, v57, vcc
ds_write_b32 v55, v57 offset:16
ds_read_b128 v[20:23], v10 offset:48
s_waitcnt lgkmcnt(0)
v_xor_b32 v20, v20, v56
v_xor_b32 v21, v21, v56
v_xor_b32 v22, v22, v56
v_xor_b32 v23, v23, v56
v_or3_b32 v20, v20, v21, v22
v_or_b32 v20, v20, v23
v_cmp_eq_u32 vcc, 0, v20
s_and_b64 exec, exec, vcc
s_cbranch_execz L_nly
buffer_store_dword v56, v59, s[32:35], 0 offen sc1
L_nly:
s_mov_b64 exec, -1
L_noy:
s_cmp_lg_u32 s14, 4
s_cbranch_scc1 L_hend
L_guard:
ds_read_b32 v11, v10 offset:4
s_waitcnt lgkmcnt(0)
v_readfirstlane_b32 s46, v11
s_nop 3
s_cmp_eq_u32 s46, 4
s_cbranch_scc1 L_hend
s_cmp_lt_u32 s46, 0x10000
s_cbranch_scc0 L_rescue
s_sleep 16
s_branch L_guard
L_rescue:
s_mov_b32 s57, 1
s_mov_b32 s56, 1
s_mov_b32 s94, 0
s_lshr_b32 s44, s15, 1
s_add_u32 s45, s15, 9
s_lshr_b32 s45, s45, 1
s_mov_b32 s55, 0
s_branch L_prod
L_hend:
L_end:
s_endpgm
.p2align 6
L_main:
s_mov_b32 s53, 0xffff0000
s_mov_b32 s61, 0
s_and_b32 s44, s2, 7
s_lshr_b32 s45, s2, 3
s_mul_i32 s46, s44, 31
s_min_u32 s44, s44, 4
s_add_u32 s46, s46, s44
s_add_u32 s46, s46, s45
s_mul_hi_u32 s47, s46, 477218589
s_mul_i32 s48, s47, 9
s_sub_u32 s15, s46, s48
s_and_b32 s17, s47, 1
s_lshr_b32 s47, s47, 1
s_cmp_ge_u32 s47, 7
s_cselect_b32 s19, 1152000, 0
s_cselect_b32 s48, 7, 0
s_sub_u32 s18, s47, s48
s_mul_i32 s52, s18, 576
s_add_u32 s52, s52, s17
s_sub_u32 s52, s52, 60
s_mul_i32 s52, s52, 288
v_mul_u32_u24 v3, 3641, v0
v_lshrrev_b32 v3, 16, v3
v_mul_u32_u24 v2, 18, v3
v_sub_u32 v2, v0, v2
v_mul_u32_u24 v3, 1152, v3
v_lshl_add_u32 v3, v2, 4, v3
s_add_u32 s46, s52, 576
v_add_u32 v48, s46, v3
v_mov_b32 v5, 16192
v_mov_b32 v6, 17056
v_cmp_le_u32 vcc, 14, v2
v_add_u32 v3, 4, v2
v_subrev_u32 v4, 14, v2
v_cndmask_b32 v7, v5, v6, vcc
v_cndmask_b32 v2, v3, v4, vcc
v_add_u32 v49, v48, v7
v_cmp_le_u32 vcc, 14, v2
v_add_u32 v3, 4, v2
v_subrev_u32 v4, 14, v2
v_cndmask_b32 v7, v5, v6, vcc
v_cndmask_b32 v2, v3, v4, vcc
v_add_u32 v50, v49, v7
v_cmp_le_u32 vcc, 14, v2
v_add_u32 v3, 4, v2
v_subrev_u32 v4, 14, v2
v_cndmask_b32 v7, v5, v6, vcc
v_cndmask_b32 v2, v3, v4, vcc
v_add_u32 v51, v50, v7
v_cmp_le_u32 vcc, 14, v2
v_add_u32 v3, 4, v2
v_subrev_u32 v4, 14, v2
v_cndmask_b32 v7, v5, v6, vcc
v_cndmask_b32 v2, v3, v4, vcc
v_add_u32 v52, v51, v7
v_cmp_le_u32 vcc, 14, v2
v_add_u32 v3, 4, v2
v_subrev_u32 v4, 14, v2
v_cndmask_b32 v7, v5, v6, vcc
v_cndmask_b32 v2, v3, v4, vcc
v_add_u32 v53, v52, v7
v_cmp_le_u32 vcc, 14, v2
v_add_u32 v3, 4, v2
v_subrev_u32 v4, 14, v2
v_cndmask_b32 v7, v5, v6, vcc
v_cndmask_b32 v2, v3, v4, vcc
v_add_u32 v54, v53, v7
v_cmp_le_u32 vcc, 14, v2
v_add_u32 v3, 4, v2
v_subrev_u32 v4, 14, v2
v_cndmask_b32 v7, v5, v6, vcc
v_cndmask_b32 v2, v3, v4, vcc
v_add_u32 v55, v54, v7
v_cmp_le_u32 vcc, 14, v2
v_add_u32 v3, 4, v2
v_subrev_u32 v4, 14, v2
v_cndmask_b32 v7, v5, v6, vcc
v_cndmask_b32 v2, v3, v4, vcc
v_add_u32 v56, v55, v7
v_cmp_le_u32 vcc, 14, v2
v_add_u32 v3, 4, v2
v_subrev_u32 v4, 14, v2
v_cndmask_b32 v7, v5, v6, vcc
v_cndmask_b32 v2, v3, v4, vcc
v_add_u32 v57, v56, v7
v_cmp_le_u32 vcc, 14, v2
v_add_u32 v3, 4, v2
v_subrev_u32 v4, 14, v2
v_cndmask_b32 v7, v5, v6, vcc
v_cndmask_b32 v2, v3, v4, vcc
v_add_u32 v58, v57, v7
v_cmp_le_u32 vcc, 14, v2
v_add_u32 v3, 4, v2
v_subrev_u32 v4, 14, v2
v_cndmask_b32 v7, v5, v6, vcc
v_cndmask_b32 v2, v3, v4, vcc
v_add_u32 v59, v58, v7
s_lshl_b32 s50, s14, 10
s_add_u32 s50, s50, 46080
s_add_u32 s51, s50, 45056
s_movk_i32 s49, 4096
s_bitcmp0_b32 s15, 0
s_cbranch_scc1 L_fwd
v_swap_b32 v48, v58
v_swap_b32 v49, v57
v_swap_b32 v50, v56
v_swap_b32 v51, v55
v_swap_b32 v52, v54
s_add_u32 s50, s50, 40960
s_movk_i32 s49, -4096
L_fwd:
v_mov_b32 v41, 138240
v_mov_b32 v4, 0
v_mov_b32 v5, 0
v_mov_b32 v6, 0
v_mov_b32 v7, 0
ds_write_b128 v41, v[4:7]
ds_write_b128 v41, v[4:7] offset:16
s_waitcnt lgkmcnt(0)
s_load_dword s59, s[12:13], 65536
s_add_u32 s20, s4, s19
s_addc_u32 s21, s5, 0
s_and_b32 s21, s21, 0xffff
s_mov_b32 s22, 1152000
s_mov_b32 s23, 0x20000
s_lshr_b32 s47, s2, 4
s_lshr_b32 s47, 0x33, s47
s_lshl_b32 s47, s47, 31
v_min_u32 v8, 39, v1
v_lshrrev_b32 v9, 2, v8
s_mul_i32 s46, s14, 10
v_add_u32 v9, s46, v9
v_mul_u32_u24 v9, 4608, v9
v_and_b32 v8, 3, v8
v_mul_u32_u24 v8, 92, v8
s_and_b32 s46, s15, 7
s_mul_i32 s46, s46, 576
s_add_u32 s46, s46, s52
v_add3_u32 v9, v9, v8, s46
s_cmp_eq_u32 s47, 0
s_cbranch_scc1 L_tn
s_waitcnt lgkmcnt(0)
L_tn:
buffer_load_dword v62, v9, s[20:23], 0 offen
s_mov_b32 m0, s50
s_add_u32 s50, s50, s49
buffer_load_dwordx4 v48, s[20:23], 0 offen lds
s_mov_b32 m0, s50
s_add_u32 s50, s50, s49
buffer_load_dwordx4 v49, s[20:23], 0 offen lds
s_mov_b32 m0, s50
s_add_u32 s50, s50, s49
buffer_load_dwordx4 v50, s[20:23], 0 offen lds
s_mov_b32 m0, s50
s_add_u32 s50, s50, s49
buffer_load_dwordx4 v51, s[20:23], 0 offen lds
s_barrier
s_mov_b32 m0, s50
s_add_u32 s50, s50, s49
buffer_load_dwordx4 v52, s[20:23], 0 offen lds
s_mov_b32 m0, s50
s_add_u32 s50, s50, s49
buffer_load_dwordx4 v53, s[20:23], 0 offen lds
s_mov_b32 m0, s50
s_add_u32 s50, s50, s49
buffer_load_dwordx4 v54, s[20:23], 0 offen lds
s_mov_b32 m0, s50
s_add_u32 s50, s50, s49
buffer_load_dwordx4 v55, s[20:23], 0 offen lds
s_mov_b32 m0, s50
s_add_u32 s50, s50, s49
buffer_load_dwordx4 v56, s[20:23], 0 offen lds
s_mov_b32 m0, s50
s_add_u32 s50, s50, s49
buffer_load_dwordx4 v57, s[20:23], 0 offen lds
s_mov_b32 m0, s50
s_add_u32 s50, s50, s49
buffer_load_dwordx4 v58, s[20:23], 0 offen lds
s_cmp_lg_u32 s14, 0
s_cbranch_scc1 L_o11
s_mov_b32 m0, s51
s_add_u32 s50, s50, s49
buffer_load_dwordx4 v59, s[20:23], 0 offen lds
L_o11:
s_mov_b32 s32, s12
s_and_b32 s33, s13, 0xffff
s_mov_b32 s34, 16777216
s_mov_b32 s35, 0x20000
s_add_u32 s36, s8, s19
s_addc_u32 s37, s9, 0
s_and_b32 s37, s37, 0xffff
s_mov_b32 s38, 1152000
s_mov_b32 s39, 0x20000
s_mov_b32 s40, s10
s_and_b32 s41, s11, 0xffff
s_mov_b32 s42, 256
s_mov_b32 s43, 0x20000
v_and_b32 v2, 15, v1
v_lshrrev_b32 v3, 4, v1
v_subrev_u32 v5, 4, v2
v_add_u32 v6, 8, v2
v_cmp_gt_u32 vcc, 4, v2
v_cmp_le_u32 s[46:47], 12, v2
s_and_b32 s68, s14, 1
s_lshr_b32 s48, s14, 1
v_cndmask_b32 v5, v5, v6, vcc
v_cndmask_b32 v5, v5, v2, s[46:47]
v_mul_u32_u24 v5, 9, v5
v_mul_u32_u24 v4, 288, v5
v_lshl_add_u32 v6, v3, 4, v4
v_and_b32 v7, 1, v3
v_lshl_add_u32 v7, v7, 4, v4
v_lshrrev_b32 v8, 1, v3
v_mul_u32_u24 v8, 2304, v8
v_add_u32 v7, v7, v8
v_add_u32 v7, 256, v7
s_mul_i32 s49, s68, 92160
v_add_u32 v30, 46080, v6
v_add_u32 v31, 46080, v7
v_add_u32 v32, s49, v6
v_add_u32 v33, s49, v7
v_lshlrev_b32 v6, 4, v1
s_mul_i32 s49, s14, 9216
s_add_u32 s49, s49, 46080
v_add_u32 v35, s49, v6
s_xor_b32 s49, s14, 1
s_mul_i32 s49, s49, 9216
s_add_u32 s49, s49, 46080
v_add_u32 v36, s49, v6
v_and_b32 v8, 0x39, v1
v_bfe_u32 v9, v1, 1, 1
v_lshl_add_u32 v8, v9, 2, v8
v_bfe_u32 v9, v1, 2, 1
v_lshl_add_u32 v8, v9, 1, v8
v_lshlrev_b32 v34, 4, v8
s_mul_i32 s49, s68, 576
s_add_u32 s49, s49, s52
s_add_u32 s49, s49, 17280
s_lshl_b32 s50, s15, 5
s_add_u32 s49, s49, s50
s_lshl_b32 s50, s48, 4
s_add_u32 s49, s49, s50
v_mul_u32_u24 v8, 1152, v5
v_lshl_add_u32 v8, v3, 2, v8
v_add_u32 v37, s49, v8
v_add_u32 v38, 3456, v37
v_add_u32 v39, 6912, v37
s_lshl_b32 s49, s15, 1
s_add_u32 s49, s49, s48
s_mul_i32 s49, s49, 282624
s_mul_i32 s69, s68, 108544
s_add_u32 s69, s69, s49
s_add_u32 s69, s69, 1064960
s_lshl_b32 s96, s68, 15
s_add_u32 s96, s96, s49
s_add_u32 s96, s96, 1265664
s_mov_b32 s90, 0x4038aa3b
s_mov_b32 s91, 0x4038aa3b
s_mov_b32 s92, 0xbfb8aa3b
s_mov_b32 s93, 0xbfb8aa3b
s_mov_b32 s94, 0x42700000
v_min_u32 v40, 31, v1
v_lshlrev_b32 v40, 7, v40
v_min_u32 v46, 47, v1
v_lshlrev_b32 v46, 7, v46
v_mov_b32 v42, 1
s_lshl_b32 s46, s48, 2
v_add_u32 v45, s46, v41
s_or_b32 s46, s2, s14
v_or_b32 v2, s46, v1
v_cmp_eq_u32 vcc, 0, v2
v_mov_b32 v60, -16
v_mov_b32 v61, -16
v_mov_b32 v3, 65536
v_cndmask_b32 v60, v60, 4, vcc
v_cndmask_b32 v61, v61, v3, vcc
s_lshl_b32 s97, s68, 13
s_cmp_eq_u32 s68, 1
s_cbranch_scc1 L_warmB
L_warmret:
s_waitcnt vmcnt(11)
v_mov_b32 v47, 0x10000
s_mov_b64 exec, 1
ds_add_u32 v41, v47 offset:8
s_mov_b64 exec, -1
s_waitcnt vmcnt(0) lgkmcnt(0)
s_mov_b64 exec, 1
ds_add_u32 v41, v42 offset:8
s_mov_b64 exec, -1
s_add_u32 s59, s59, 2654435769
v_mov_b32 v43, s59
L_gate:
ds_read_b32 v44, v41 offset:8
s_waitcnt lgkmcnt(0)
v_and_b32 v44, 0xffff, v44
v_cmp_gt_u32 vcc, 0x400, v44
s_nop 4
s_cbranch_vccz L_gate2
s_sleep 1
s_branch L_gate
L_gate2:
L_go:
s_mov_b32 s50, s96
L_gw:
ds_read_b32 v47, v41 offset:8
s_waitcnt lgkmcnt(0)
v_and_b32 v47, 0xff, v47
v_cmp_ne_u32 vcc, 4, v47
s_nop 4
s_cbranch_vccnz L_gw
s_setprio 2
s_cmp_eq_u32 s68, 1
s_cbranch_scc1 L_typeB
buffer_load_dwordx4 v[100:103], v34, s[32:35], s50 offen offset:0
buffer_load_dwordx4 v[104:107], v34, s[32:35], s50 offen offset:1024
buffer_load_dwordx4 v[116:119], v34, s[32:35], s50 offen offset:2048
buffer_load_dwordx4 v[120:123], v34, s[32:35], s50 offen offset:3072
s_add_u32 s50, s50, 4096
buffer_load_dwordx4 v[108:111], v34, s[32:35], s50 offen offset:0
buffer_load_dwordx4 v[112:115], v34, s[32:35], s50 offen offset:1024
buffer_load_dwordx4 v[124:127], v34, s[32:35], s50 offen offset:2048
buffer_load_dwordx4 v[128:131], v34, s[32:35], s50 offen offset:3072
s_add_u32 s50, s50, 4096
ds_read_b128 v[132:135], v30 offset:0
ds_read_b128 v[136:139], v30 offset:288
ds_read_b128 v[140:143], v30 offset:576
ds_read_b128 v[144:147], v30 offset:864
ds_read_b128 v[148:151], v30 offset:1152
ds_read_b128 v[152:155], v30 offset:1440
ds_read_b128 v[156:159], v30 offset:1728
ds_read_b128 v[160:163], v30 offset:2016
ds_read_b128 v[164:167], v30 offset:2304
s_waitcnt vmcnt(4)
buffer_load_dwordx4 v[4:7], v34, s[32:35], s50 offen offset:0
buffer_load_dwordx4 v[8:11], v34, s[32:35], s50 offen offset:1024
buffer_load_dwordx4 v[12:15], v34, s[32:35], s50 offen offset:2048
buffer_load_dwordx4 v[16:19], v34, s[32:35], s50 offen offset:3072
s_add_u32 s50, s50, 4096
v_bitop3_b32 v28, v101, v106, v43 bitop3:0x7e
v_bitop3_b32 v29, v117, v122, v43 bitop3:0x7e
v_or_b32 v28, v28, v29
v_cmp_ne_u32 s[48:49], 0, v28
s_nop 2
s_cmp_lg_u64 s[48:49], 0
s_cbranch_scc1 L_ks00
L_kb00:
s_waitcnt vmcnt(4)
buffer_load_dwordx4 v[20:23], v34, s[32:35], s50 offen offset:0
buffer_load_dwordx4 v[24:27], v34, s[32:35], s50 offen offset:1024
buffer_load_dwordx4 v[48:51], v34, s[32:35], s50 offen offset:2048
buffer_load_dwordx4 v[52:55], v34, s[32:35], s50 offen offset:3072
s_add_u32 s50, s50, 4096
v_bitop3_b32 v28, v109, v114, v43 bitop3:0x7e
v_bitop3_b32 v29, v125, v130, v43 bitop3:0x7e
v_or_b32 v28, v28, v29
v_cmp_ne_u32 s[48:49], 0, v28
s_nop 2
s_cmp_lg_u64 s[48:49], 0
s_cbranch_scc1 L_ks02
L_kb02:
s_waitcnt lgkmcnt(8)
v_mfma_f32_16x16x32_bf16 v[64:67], v[102:105], v[132:135], 0
s_waitcnt lgkmcnt(7)
v_mfma_f32_16x16x32_bf16 v[68:71], v[102:105], v[136:139], 0
s_waitcnt lgkmcnt(6)
v_mfma_f32_16x16x32_bf16 v[72:75], v[102:105], v[140:143], 0
s_waitcnt lgkmcnt(5)
v_mfma_f32_16x16x32_bf16 v[76:79], v[102:105], v[144:147], 0
s_waitcnt lgkmcnt(4)
v_mfma_f32_16x16x32_bf16 v[80:83], v[102:105], v[148:151], 0
s_waitcnt lgkmcnt(3)
v_mfma_f32_16x16x32_bf16 v[84:87], v[102:105], v[152:155], 0
s_waitcnt lgkmcnt(2)
v_mfma_f32_16x16x32_bf16 v[88:91], v[102:105], v[156:159], 0
s_waitcnt lgkmcnt(1)
v_mfma_f32_16x16x32_bf16 v[92:95], v[102:105], v[160:163], 0
s_waitcnt lgkmcnt(0)
v_mfma_f32_16x16x32_bf16 v[96:99], v[102:105], v[164:167], 0
ds_read_b128 v[104:107], v30 offset:2592
v_mfma_f32_16x16x32_bf16 v[64:67], v[118:121], v[136:139], v[64:67]
v_mfma_f32_16x16x32_bf16 v[68:71], v[118:121], v[140:143], v[68:71]
v_mfma_f32_16x16x32_bf16 v[72:75], v[118:121], v[144:147], v[72:75]
v_mfma_f32_16x16x32_bf16 v[76:79], v[118:121], v[148:151], v[76:79]
v_mfma_f32_16x16x32_bf16 v[80:83], v[118:121], v[152:155], v[80:83]
v_mfma_f32_16x16x32_bf16 v[84:87], v[118:121], v[156:159], v[84:87]
v_mfma_f32_16x16x32_bf16 v[88:91], v[118:121], v[160:163], v[88:91]
v_mfma_f32_16x16x32_bf16 v[92:95], v[118:121], v[164:167], v[92:95]
s_waitcnt lgkmcnt(0)
v_mfma_f32_16x16x32_bf16 v[96:99], v[118:121], v[104:107], v[96:99]
ds_read_b128 v[100:103], v30 offset:2880
v_mfma_f32_16x16x32_bf16 v[64:67], v[110:113], v[140:143], v[64:67]
v_mfma_f32_16x16x32_bf16 v[68:71], v[110:113], v[144:147], v[68:71]
v_mfma_f32_16x16x32_bf16 v[72:75], v[110:113], v[148:151], v[72:75]
v_mfma_f32_16x16x32_bf16 v[76:79], v[110:113], v[152:155], v[76:79]
v_mfma_f32_16x16x32_bf16 v[80:83], v[110:113], v[156:159], v[80:83]
v_mfma_f32_16x16x32_bf16 v[84:87], v[110:113], v[160:163], v[84:87]
v_mfma_f32_16x16x32_bf16 v[88:91], v[110:113], v[164:167], v[88:91]
v_mfma_f32_16x16x32_bf16 v[92:95], v[110:113], v[104:107], v[92:95]
s_waitcnt lgkmcnt(0)
v_mfma_f32_16x16x32_bf16 v[96:99], v[110:113], v[100:103], v[96:99]
ds_read_b128 v[120:123], v30 offset:3168
v_mfma_f32_16x16x32_bf16 v[64:67], v[126:129], v[144:147], v[64:67]
buffer_load_dwordx4 v[108:111], v34, s[32:35], s50 offen offset:0
buffer_load_dwordx4 v[112:115], v34, s[32:35], s50 offen offset:1024
v_mfma_f32_16x16x32_bf16 v[68:71], v[126:129], v[148:151], v[68:71]
s_waitcnt vmcnt(6)
v_bitop3_b32 v28, v5, v10, v43 bitop3:0x7e
v_bitop3_b32 v29, v13, v18, v43 bitop3:0x7e
v_or_b32 v28, v28, v29
v_cmp_ne_u32 s[48:49], 0, v28
v_mfma_f32_16x16x32_bf16 v[72:75], v[126:129], v[152:155], v[72:75]
v_mfma_f32_16x16x32_bf16 v[76:79], v[126:129], v[156:159], v[76:79]
v_mfma_f32_16x16x32_bf16 v[80:83], v[126:129], v[160:163], v[80:83]
v_mfma_f32_16x16x32_bf16 v[84:87], v[126:129], v[164:167], v[84:87]
v_mfma_f32_16x16x32_bf16 v[88:91], v[126:129], v[104:107], v[88:91]
v_mfma_f32_16x16x32_bf16 v[92:95], v[126:129], v[100:103], v[92:95]
s_cmp_lg_u64 s[48:49], 0
s_cbranch_scc1 L_ks04
L_kb04:
s_waitcnt lgkmcnt(0)
v_mfma_f32_16x16x32_bf16 v[96:99], v[126:129], v[120:123], v[96:99]
ds_read_b128 v[116:119], v30 offset:3456
v_mfma_f32_16x16x32_bf16 v[64:67], v[6:9], v[148:151], v[64:67]
buffer_load_dwordx4 v[124:127], v34, s[32:35], s50 offen offset:2048
buffer_load_dwordx4 v[128:131], v34, s[32:35], s50 offen offset:3072
v_mfma_f32_16x16x32_bf16 v[68:71], v[6:9], v[152:155], v[68:71]
s_add_u32 s50, s50, 4096
v_mfma_f32_16x16x32_bf16 v[72:75], v[6:9], v[156:159], v[72:75]
v_mfma_f32_16x16x32_bf16 v[76:79], v[6:9], v[160:163], v[76:79]
v_mfma_f32_16x16x32_bf16 v[80:83], v[6:9], v[164:167], v[80:83]
v_mfma_f32_16x16x32_bf16 v[84:87], v[6:9], v[104:107], v[84:87]
v_mfma_f32_16x16x32_bf16 v[88:91], v[6:9], v[100:103], v[88:91]
v_mfma_f32_16x16x32_bf16 v[92:95], v[6:9], v[120:123], v[92:95]
s_waitcnt lgkmcnt(0)
v_mfma_f32_16x16x32_bf16 v[96:99], v[6:9], v[116:119], v[96:99]
ds_read_b128 v[132:135], v30 offset:3744
v_mfma_f32_16x16x32_bf16 v[64:67], v[14:17], v[152:155], v[64:67]
buffer_load_dwordx4 v[168:171], v34, s[32:35], s50 offen offset:0
buffer_load_dwordx4 v[172:175], v34, s[32:35], s50 offen offset:1024
v_mfma_f32_16x16x32_bf16 v[68:71], v[14:17], v[156:159], v[68:71]
s_waitcnt vmcnt(6)
v_bitop3_b32 v28, v21, v26, v43 bitop3:0x7e
v_bitop3_b32 v29, v49, v54, v43 bitop3:0x7e
v_or_b32 v28, v28, v29
v_cmp_ne_u32 s[48:49], 0, v28
v_mfma_f32_16x16x32_bf16 v[72:75], v[14:17], v[160:163], v[72:75]
v_mfma_f32_16x16x32_bf16 v[76:79], v[14:17], v[164:167], v[76:79]
v_mfma_f32_16x16x32_bf16 v[80:83], v[14:17], v[104:107], v[80:83]
s_mov_b32 s97, 4096
buffer_load_dword v44, v40, s[32:35], s97 offen
v_mfma_f32_16x16x32_bf16 v[84:87], v[14:17], v[100:103], v[84:87]
v_mfma_f32_16x16x32_bf16 v[88:91], v[14:17], v[120:123], v[88:91]
v_mfma_f32_16x16x32_bf16 v[92:95], v[14:17], v[116:119], v[92:95]
s_cmp_lg_u64 s[48:49], 0
s_cbranch_scc1 L_ks06
L_kb06:
s_waitcnt lgkmcnt(0)
v_mfma_f32_16x16x32_bf16 v[96:99], v[14:17], v[132:135], v[96:99]
ds_read_b128 v[176:179], v30 offset:4032
v_mfma_f32_16x16x32_bf16 v[64:67], v[22:25], v[156:159], v[64:67]
buffer_load_dwordx4 v[184:187], v34, s[32:35], s50 offen offset:2048
buffer_load_dwordx4 v[188:191], v34, s[32:35], s50 offen offset:3072
v_mfma_f32_16x16x32_bf16 v[68:71], v[22:25], v[160:163], v[68:71]
s_add_u32 s50, s50, 4096
v_mfma_f32_16x16x32_bf16 v[72:75], v[22:25], v[164:167], v[72:75]
v_mfma_f32_16x16x32_bf16 v[76:79], v[22:25], v[104:107], v[76:79]
v_mfma_f32_16x16x32_bf16 v[80:83], v[22:25], v[100:103], v[80:83]
v_mfma_f32_16x16x32_bf16 v[84:87], v[22:25], v[120:123], v[84:87]
v_mfma_f32_16x16x32_bf16 v[88:91], v[22:25], v[116:119], v[88:91]
v_mfma_f32_16x16x32_bf16 v[92:95], v[22:25], v[132:135], v[92:95]
s_waitcnt lgkmcnt(0)
v_mfma_f32_16x16x32_bf16 v[96:99], v[22:25], v[176:179], v[96:99]
ds_read_b128 v[180:183], v30 offset:4320
v_mfma_f32_16x16x32_bf16 v[64:67], v[50:53], v[160:163], v[64:67]
buffer_load_dwordx4 v[192:195], v34, s[32:35], s50 offen offset:0
buffer_load_dwordx4 v[196:199], v34, s[32:35], s50 offen offset:1024
v_mfma_f32_16x16x32_bf16 v[68:71], v[50:53], v[164:167], v[68:71]
s_waitcnt vmcnt(7)
v_bitop3_b32 v28, v109, v114, v43 bitop3:0x7e
v_bitop3_b32 v29, v125, v130, v43 bitop3:0x7e
v_or_b32 v28, v28, v29
v_cmp_ne_u32 s[48:49], 0, v28
v_mfma_f32_16x16x32_bf16 v[72:75], v[50:53], v[104:107], v[72:75]
v_mfma_f32_16x16x32_bf16 v[76:79], v[50:53], v[100:103], v[76:79]
v_mfma_f32_16x16x32_bf16 v[80:83], v[50:53], v[120:123], v[80:83]
v_mfma_f32_16x16x32_bf16 v[84:87], v[50:53], v[116:119], v[84:87]
v_mfma_f32_16x16x32_bf16 v[88:91], v[50:53], v[132:135], v[88:91]
v_mfma_f32_16x16x32_bf16 v[92:95], v[50:53], v[176:179], v[92:95]
s_cmp_lg_u64 s[48:49], 0
s_cbranch_scc1 L_ks08
L_kb08:
s_waitcnt lgkmcnt(0)
v_mfma_f32_16x16x32_bf16 v[96:99], v[50:53], v[180:183], v[96:99]
ds_read_b128 v[240:243], v30 offset:4608
v_mfma_f32_16x16x32_bf16 v[64:67], v[110:113], v[164:167], v[64:67]
buffer_load_dwordx4 v[200:203], v34, s[32:35], s50 offen offset:2048
buffer_load_dwordx4 v[204:207], v34, s[32:35], s50 offen offset:3072
v_mfma_f32_16x16x32_bf16 v[68:71], v[110:113], v[104:107], v[68:71]
s_add_u32 s50, s50, 4096
v_mfma_f32_16x16x32_bf16 v[72:75], v[110:113], v[100:103], v[72:75]
v_mfma_f32_16x16x32_bf16 v[76:79], v[110:113], v[120:123], v[76:79]
v_mfma_f32_16x16x32_bf16 v[80:83], v[110:113], v[116:119], v[80:83]
v_mfma_f32_16x16x32_bf16 v[84:87], v[110:113], v[132:135], v[84:87]
v_mfma_f32_16x16x32_bf16 v[88:91], v[110:113], v[176:179], v[88:91]
v_mfma_f32_16x16x32_bf16 v[92:95], v[110:113], v[180:183], v[92:95]
s_waitcnt lgkmcnt(0)
v_mfma_f32_16x16x32_bf16 v[96:99], v[110:113], v[240:243], v[96:99]
ds_read_b128 v[112:115], v30 offset:4896
v_mfma_f32_16x16x32_bf16 v[64:67], v[126:129], v[104:107], v[64:67]
buffer_load_dwordx4 v[208:211], v34, s[32:35], s50 offen offset:0
buffer_load_dwordx4 v[212:215], v34, s[32:35], s50 offen offset:1024
v_mfma_f32_16x16x32_bf16 v[68:71], v[126:129], v[100:103], v[68:71]
s_waitcnt vmcnt(6)
v_bitop3_b32 v28, v169, v174, v43 bitop3:0x7e
v_bitop3_b32 v29, v185, v190, v43 bitop3:0x7e
v_or_b32 v28, v28, v29
v_cmp_ne_u32 s[48:49], 0, v28
v_mfma_f32_16x16x32_bf16 v[72:75], v[126:129], v[120:123], v[72:75]
v_mfma_f32_16x16x32_bf16 v[76:79], v[126:129], v[116:119], v[76:79]
v_mfma_f32_16x16x32_bf16 v[80:83], v[126:129], v[132:135], v[80:83]
v_mfma_f32_16x16x32_bf16 v[84:87], v[126:129], v[176:179], v[84:87]
v_mfma_f32_16x16x32_bf16 v[88:91], v[126:129], v[180:183], v[88:91]
v_mfma_f32_16x16x32_bf16 v[92:95], v[126:129], v[240:243], v[92:95]
s_cmp_lg_u64 s[48:49], 0
s_cbranch_scc1 L_ks010
L_kb010:
s_waitcnt lgkmcnt(0)
v_mfma_f32_16x16x32_bf16 v[96:99], v[126:129], v[112:115], v[96:99]
ds_read_b128 v[104:107], v30 offset:5184
v_mfma_f32_16x16x32_bf16 v[64:67], v[170:173], v[100:103], v[64:67]
buffer_load_dwordx4 v[124:127], v34, s[32:35], s50 offen offset:2048
buffer_load_dwordx4 v[128:131], v34, s[32:35], s50 offen offset:3072
v_mfma_f32_16x16x32_bf16 v[68:71], v[170:173], v[120:123], v[68:71]
s_add_u32 s50, s50, 4096
v_mfma_f32_16x16x32_bf16 v[72:75], v[170:173], v[116:119], v[72:75]
v_mov_b32 v47, 1
s_mov_b64 exec, 1
ds_max_u32 v41, v47
s_mov_b64 exec, -1
v_mfma_f32_16x16x32_bf16 v[76:79], v[170:173], v[132:135], v[76:79]
v_mfma_f32_16x16x32_bf16 v[80:83], v[170:173], v[176:179], v[80:83]
v_mfma_f32_16x16x32_bf16 v[84:87], v[170:173], v[180:183], v[84:87]
v_mfma_f32_16x16x32_bf16 v[88:91], v[170:173], v[240:243], v[88:91]
v_mfma_f32_16x16x32_bf16 v[92:95], v[170:173], v[112:115], v[92:95]
s_waitcnt lgkmcnt(1)
v_mfma_f32_16x16x32_bf16 v[96:99], v[170:173], v[104:107], v[96:99]
ds_read_b128 v[100:103], v30 offset:5472
v_mfma_f32_16x16x32_bf16 v[64:67], v[186:189], v[120:123], v[64:67]
v_cmp_ne_u32 vcc, v43, v44
v_mfma_f32_16x16x32_bf16 v[68:71], v[186:189], v[116:119], v[68:71]
s_waitcnt vmcnt(4)
v_bitop3_b32 v28, v193, v198, v43 bitop3:0x7e
v_bitop3_b32 v29, v201, v206, v43 bitop3:0x7e
v_or_b32 v28, v28, v29
v_cmp_ne_u32 s[48:49], 0, v28
v_mfma_f32_16x16x32_bf16 v[72:75], v[186:189], v[132:135], v[72:75]
v_mfma_f32_16x16x32_bf16 v[76:79], v[186:189], v[176:179], v[76:79]
v_mfma_f32_16x16x32_bf16 v[80:83], v[186:189], v[180:183], v[80:83]
v_mfma_f32_16x16x32_bf16 v[84:87], v[186:189], v[240:243], v[84:87]
v_mfma_f32_16x16x32_bf16 v[88:91], v[186:189], v[112:115], v[88:91]
s_cbranch_vccnz L_fw00
L_fb00:
v_mfma_f32_16x16x32_bf16 v[92:95], v[186:189], v[104:107], v[92:95]
s_cmp_lg_u64 s[48:49], 0
s_cbranch_scc1 L_ks012
L_kb012:
s_waitcnt lgkmcnt(0)
v_mfma_f32_16x16x32_bf16 v[96:99], v[186:189], v[100:103], v[96:99]
ds_read_b128 v[120:123], v30 offset:5760
v_mfma_f32_16x16x32_bf16 v[64:67], v[194:197], v[116:119], v[64:67]
buffer_load_dwordx4 v[116:119], v34, s[32:35], s69 offen offset:0
v_mfma_f32_16x16x32_bf16 v[68:71], v[194:197], v[132:135], v[68:71]
v_mfma_f32_16x16x32_bf16 v[72:75], v[194:197], v[176:179], v[72:75]
v_mfma_f32_16x16x32_bf16 v[76:79], v[194:197], v[180:183], v[76:79]
v_mfma_f32_16x16x32_bf16 v[80:83], v[194:197], v[240:243], v[80:83]
buffer_load_dwordx4 v[108:111], v34, s[32:35], s69 offen offset:1024
v_mfma_f32_16x16x32_bf16 v[84:87], v[194:197], v[112:115], v[84:87]
v_mfma_f32_16x16x32_bf16 v[88:91], v[194:197], v[104:107], v[88:91]
v_mfma_f32_16x16x32_bf16 v[92:95], v[194:197], v[100:103], v[92:95]
s_waitcnt lgkmcnt(0)
v_mfma_f32_16x16x32_bf16 v[96:99], v[194:197], v[120:123], v[96:99]
ds_read_b128 v[244:247], v30 offset:6048
v_mfma_f32_16x16x32_bf16 v[64:67], v[202:205], v[132:135], v[64:67]
buffer_load_dwordx4 v[132:135], v34, s[32:35], s69 offen offset:2048
v_mfma_f32_16x16x32_bf16 v[68:71], v[202:205], v[176:179], v[68:71]
s_waitcnt vmcnt(3)
v_bitop3_b32 v28, v209, v214, v43 bitop3:0x7e
v_bitop3_b32 v29, v125, v130, v43 bitop3:0x7e
v_or_b32 v28, v28, v29
v_cmp_ne_u32 s[48:49], 0, v28
v_mfma_f32_16x16x32_bf16 v[72:75], v[202:205], v[180:183], v[72:75]
v_mfma_f32_16x16x32_bf16 v[76:79], v[202:205], v[240:243], v[76:79]
v_mfma_f32_16x16x32_bf16 v[80:83], v[202:205], v[112:115], v[80:83]
s_mov_b32 s97, 14336
buffer_load_dword v44, v40, s[32:35], s97 offen
v_mfma_f32_16x16x32_bf16 v[84:87], v[202:205], v[104:107], v[84:87]
buffer_load_dwordx4 v[248:251], v34, s[32:35], s69 offen offset:3072
v_mfma_f32_16x16x32_bf16 v[88:91], v[202:205], v[100:103], v[88:91]
s_add_u32 s69, s69, 4096
v_mfma_f32_16x16x32_bf16 v[92:95], v[202:205], v[120:123], v[92:95]
s_cmp_lg_u64 s[48:49], 0
s_cbranch_scc1 L_ks014
L_kb014:
s_waitcnt lgkmcnt(0)
v_mfma_f32_16x16x32_bf16 v[96:99], v[202:205], v[244:247], v[96:99]
ds_read_b128 v[252:255], v30 offset:6336
v_mfma_f32_16x16x32_bf16 v[64:67], v[210:213], v[176:179], v[64:67]
buffer_load_dwordx4 v[216:219], v34, s[32:35], s69 offen offset:0
v_mfma_f32_16x16x32_bf16 v[68:71], v[210:213], v[180:183], v[68:71]
v_mfma_f32_16x16x32_bf16 v[72:75], v[210:213], v[240:243], v[72:75]
v_mfma_f32_16x16x32_bf16 v[76:79], v[210:213], v[112:115], v[76:79]
v_mfma_f32_16x16x32_bf16 v[80:83], v[210:213], v[104:107], v[80:83]
buffer_load_dwordx4 v[220:223], v34, s[32:35], s69 offen offset:1024
v_mfma_f32_16x16x32_bf16 v[84:87], v[210:213], v[100:103], v[84:87]
v_mfma_f32_16x16x32_bf16 v[88:91], v[210:213], v[120:123], v[88:91]
v_mfma_f32_16x16x32_bf16 v[92:95], v[210:213], v[244:247], v[92:95]
s_waitcnt lgkmcnt(0)
v_mfma_f32_16x16x32_bf16 v[96:99], v[210:213], v[252:255], v[96:99]
ds_read_b128 v[56:59], v30 offset:6624
v_mfma_f32_16x16x32_bf16 v[64:67], v[126:129], v[180:183], v[64:67]
ds_read_b128 v[136:139], v30 offset:64
v_mfma_f32_16x16x32_bf16 v[68:71], v[126:129], v[240:243], v[68:71]
ds_read_b128 v[140:143], v30 offset:352
v_mfma_f32_16x16x32_bf16 v[72:75], v[126:129], v[112:115], v[72:75]
buffer_load_dwordx4 v[112:115], v34, s[32:35], s69 offen offset:2048
v_mfma_f32_16x16x32_bf16 v[76:79], v[126:129], v[104:107], v[76:79]
ds_read_b128 v[104:107], v30 offset:640
v_mfma_f32_16x16x32_bf16 v[80:83], v[126:129], v[100:103], v[80:83]
v_mfma_f32_16x16x32_bf16 v[84:87], v[126:129], v[120:123], v[84:87]
v_mfma_f32_16x16x32_bf16 v[88:91], v[126:129], v[244:247], v[88:91]
ds_read_b128 v[100:103], v30 offset:928
v_mfma_f32_16x16x32_bf16 v[92:95], v[126:129], v[252:255], v[92:95]
buffer_load_dwordx4 v[120:123], v34, s[32:35], s69 offen offset:3072
s_waitcnt lgkmcnt(4)
v_mfma_f32_16x16x32_bf16 v[96:99], v[126:129], v[56:59], v[96:99]
s_add_u32 s69, s69, 4096
s_waitcnt lgkmcnt(3)
s_waitcnt vmcnt(8)
v_mfma_f32_16x16x32_bf16 v[64:67], v[116:119], v[136:139], v[64:67]
s_waitcnt lgkmcnt(2)
v_mfma_f32_16x16x32_bf16 v[68:71], v[116:119], v[140:143], v[68:71]
ds_read_b128 v[128:131], v30 offset:1216
s_waitcnt vmcnt(7)
v_mfma_f32_16x16x32_bf16 v[64:67], v[108:111], v[140:143], v[64:67]
buffer_load_dwordx4 v[124:127], v34, s[32:35], s69 offen offset:0
s_waitcnt lgkmcnt(2)
v_mfma_f32_16x16x32_bf16 v[72:75], v[116:119], v[104:107], v[72:75]
v_mfma_f32_16x16x32_bf16 v[68:71], v[108:111], v[104:107], v[68:71]
s_waitcnt vmcnt(7)
v_mfma_f32_16x16x32_bf16 v[64:67], v[132:135], v[104:107], v[64:67]
s_waitcnt lgkmcnt(1)
v_mfma_f32_16x16x32_bf16 v[76:79], v[116:119], v[100:103], v[76:79]
ds_read_b128 v[104:107], v30 offset:1504
v_mfma_f32_16x16x32_bf16 v[72:75], v[108:111], v[100:103], v[72:75]
buffer_load_dwordx4 v[144:147], v34, s[32:35], s69 offen offset:1024
v_mfma_f32_16x16x32_bf16 v[68:71], v[132:135], v[100:103], v[68:71]
s_waitcnt vmcnt(6)
v_mfma_f32_16x16x32_bf16 v[64:67], v[248:251], v[100:103], v[64:67]
s_waitcnt lgkmcnt(1)
v_mfma_f32_16x16x32_bf16 v[80:83], v[116:119], v[128:131], v[80:83]
v_mfma_f32_16x16x32_bf16 v[76:79], v[108:111], v[128:131], v[76:79]
buffer_load_dwordx4 v[100:103], v34, s[32:35], s69 offen offset:2048
v_mfma_f32_16x16x32_bf16 v[72:75], v[132:135], v[128:131], v[72:75]
ds_read_b128 v[148:151], v30 offset:1792
v_mfma_f32_16x16x32_bf16 v[68:71], v[248:251], v[128:131], v[68:71]
s_waitcnt vmcnt(6)
v_mfma_f32_16x16x32_bf16 v[64:67], v[216:219], v[128:131], v[64:67]
s_waitcnt lgkmcnt(1)
v_mfma_f32_16x16x32_bf16 v[84:87], v[116:119], v[104:107], v[84:87]
v_cmp_ne_u32 vcc, v43, v44
v_mfma_f32_16x16x32_bf16 v[80:83], v[108:111], v[104:107], v[80:83]
buffer_load_dwordx4 v[128:131], v34, s[32:35], s69 offen offset:3072
v_mfma_f32_16x16x32_bf16 v[76:79], v[132:135], v[104:107], v[76:79]
s_add_u32 s69, s69, 4096
v_mfma_f32_16x16x32_bf16 v[72:75], v[248:251], v[104:107], v[72:75]
v_mfma_f32_16x16x32_bf16 v[68:71], v[216:219], v[104:107], v[68:71]
ds_read_b128 v[4:7], v30 offset:2080
s_waitcnt vmcnt(6)
v_mfma_f32_16x16x32_bf16 v[64:67], v[220:223], v[104:107], v[64:67]
buffer_load_dwordx4 v[8:11], v34, s[32:35], s69 offen offset:0
s_waitcnt lgkmcnt(1)
v_mfma_f32_16x16x32_bf16 v[88:91], v[116:119], v[148:151], v[88:91]
s_cbranch_vccnz L_fw01
L_fb01:
v_mfma_f32_16x16x32_bf16 v[84:87], v[108:111], v[148:151], v[84:87]
v_mfma_f32_16x16x32_bf16 v[80:83], v[132:135], v[148:151], v[80:83]
v_mfma_f32_16x16x32_bf16 v[76:79], v[248:251], v[148:151], v[76:79]
buffer_load_dwordx4 v[152:155], v34, s[32:35], s69 offen offset:1024
v_mfma_f32_16x16x32_bf16 v[72:75], v[216:219], v[148:151], v[72:75]
v_mfma_f32_16x16x32_bf16 v[68:71], v[220:223], v[148:151], v[68:71]
s_waitcnt vmcnt(7)
v_mfma_f32_16x16x32_bf16 v[64:67], v[112:115], v[148:151], v[64:67]
ds_read_b128 v[104:107], v30 offset:2368
s_waitcnt lgkmcnt(1)
v_mfma_f32_16x16x32_bf16 v[92:95], v[116:119], v[4:7], v[92:95]
ds_read_b128 v[12:15], v30 offset:2656
v_mfma_f32_16x16x32_bf16 v[88:91], v[108:111], v[4:7], v[88:91]
ds_read_b128 v[16:19], v30 offset:2944
v_mfma_f32_16x16x32_bf16 v[84:87], v[132:135], v[4:7], v[84:87]
ds_read_b128 v[156:159], v30 offset:3232
v_mfma_f32_16x16x32_bf16 v[80:83], v[248:251], v[4:7], v[80:83]
buffer_load_dwordx4 v[20:23], v34, s[32:35], s69 offen offset:2048
v_mfma_f32_16x16x32_bf16 v[76:79], v[216:219], v[4:7], v[76:79]
v_mfma_f32_16x16x32_bf16 v[72:75], v[220:223], v[4:7], v[72:75]
v_mfma_f32_16x16x32_bf16 v[68:71], v[112:115], v[4:7], v[68:71]
s_waitcnt vmcnt(7)
v_mfma_f32_16x16x32_bf16 v[64:67], v[120:123], v[4:7], v[64:67]
buffer_load_dwordx4 v[24:27], v34, s[32:35], s69 offen offset:3072
s_waitcnt lgkmcnt(3)
v_mfma_f32_16x16x32_bf16 v[96:99], v[116:119], v[104:107], v[96:99]
s_add_u32 s69, s69, 4096
s_waitcnt lgkmcnt(2)
v_mfma_f32_16x16x32_bf16 v[96:99], v[108:111], v[12:15], v[96:99]
s_waitcnt lgkmcnt(1)
v_mfma_f32_16x16x32_bf16 v[96:99], v[132:135], v[16:19], v[96:99]
s_waitcnt lgkmcnt(0)
v_mfma_f32_16x16x32_bf16 v[96:99], v[248:251], v[156:159], v[96:99]
buffer_load_dwordx4 v[160:163], v34, s[32:35], s69 offen offset:0
v_mfma_f32_16x16x32_bf16 v[92:95], v[216:219], v[156:159], v[92:95]
v_mfma_f32_16x16x32_bf16 v[92:95], v[248:251], v[16:19], v[92:95]
v_mfma_f32_16x16x32_bf16 v[92:95], v[132:135], v[12:15], v[92:95]
v_mfma_f32_16x16x32_bf16 v[92:95], v[108:111], v[104:107], v[92:95]
buffer_load_dwordx4 v[48:51], v34, s[32:35], s69 offen offset:1024
v_mfma_f32_16x16x32_bf16 v[88:91], v[132:135], v[104:107], v[88:91]
v_mfma_f32_16x16x32_bf16 v[88:91], v[248:251], v[12:15], v[88:91]
v_mfma_f32_16x16x32_bf16 v[88:91], v[216:219], v[16:19], v[88:91]
v_mfma_f32_16x16x32_bf16 v[88:91], v[220:223], v[156:159], v[88:91]
v_mov_b32 v47, 2
s_mov_b64 exec, 1
ds_max_u32 v41, v47
s_mov_b64 exec, -1
v_mfma_f32_16x16x32_bf16 v[84:87], v[112:115], v[156:159], v[84:87]
v_mfma_f32_16x16x32_bf16 v[84:87], v[220:223], v[16:19], v[84:87]
s_mov_b32 s97, 18432
buffer_load_dword v44, v40, s[32:35], s97 offen
v_mfma_f32_16x16x32_bf16 v[84:87], v[216:219], v[12:15], v[84:87]
v_mfma_f32_16x16x32_bf16 v[84:87], v[248:251], v[104:107], v[84:87]
v_mfma_f32_16x16x32_bf16 v[80:83], v[216:219], v[104:107], v[80:83]
v_mfma_f32_16x16x32_bf16 v[80:83], v[220:223], v[12:15], v[80:83]
v_mfma_f32_16x16x32_bf16 v[80:83], v[112:115], v[16:19], v[80:83]
v_mfma_f32_16x16x32_bf16 v[80:83], v[120:123], v[156:159], v[80:83]
s_waitcnt vmcnt(10)
v_mfma_f32_16x16x32_bf16 v[76:79], v[124:127], v[156:159], v[76:79]
v_mfma_f32_16x16x32_bf16 v[76:79], v[120:123], v[16:19], v[76:79]
v_mfma_f32_16x16x32_bf16 v[76:79], v[112:115], v[12:15], v[76:79]
v_mfma_f32_16x16x32_bf16 v[76:79], v[220:223], v[104:107], v[76:79]
v_mfma_f32_16x16x32_bf16 v[72:75], v[112:115], v[104:107], v[72:75]
v_mfma_f32_16x16x32_bf16 v[72:75], v[120:123], v[12:15], v[72:75]
v_mfma_f32_16x16x32_bf16 v[72:75], v[124:127], v[16:19], v[72:75]
s_waitcnt vmcnt(9)
v_mfma_f32_16x16x32_bf16 v[72:75], v[144:147], v[156:159], v[72:75]
ds_read_b128 v[116:119], v30 offset:3520
s_waitcnt vmcnt(8)
v_mfma_f32_16x16x32_bf16 v[68:71], v[100:103], v[156:159], v[68:71]
ds_read_b128 v[108:111], v30 offset:3808
v_mfma_f32_16x16x32_bf16 v[68:71], v[144:147], v[16:19], v[68:71]
ds_read_b128 v[132:135], v30 offset:4096
v_mfma_f32_16x16x32_bf16 v[68:71], v[124:127], v[12:15], v[68:71]
ds_read_b128 v[52:55], v30 offset:4384
v_mfma_f32_16x16x32_bf16 v[68:71], v[120:123], v[104:107], v[68:71]
v_mfma_f32_16x16x32_bf16 v[64:67], v[124:127], v[104:107], v[64:67]
v_mfma_f32_16x16x32_bf16 v[64:67], v[144:147], v[12:15], v[64:67]
v_mfma_f32_16x16x32_bf16 v[64:67], v[100:103], v[16:19], v[64:67]
s_waitcnt vmcnt(7)
v_mfma_f32_16x16x32_bf16 v[64:67], v[128:131], v[156:159], v[64:67]
s_waitcnt lgkmcnt(3)
v_mfma_f32_16x16x32_bf16 v[96:99], v[216:219], v[116:119], v[96:99]
s_waitcnt lgkmcnt(2)
v_mfma_f32_16x16x32_bf16 v[96:99], v[220:223], v[108:111], v[96:99]
s_waitcnt lgkmcnt(1)
v_mfma_f32_16x16x32_bf16 v[96:99], v[112:115], v[132:135], v[96:99]
s_waitcnt lgkmcnt(0)
v_mfma_f32_16x16x32_bf16 v[96:99], v[120:123], v[52:55], v[96:99]
v_mfma_f32_16x16x32_bf16 v[92:95], v[124:127], v[52:55], v[92:95]
v_mfma_f32_16x16x32_bf16 v[92:95], v[120:123], v[132:135], v[92:95]
v_mfma_f32_16x16x32_bf16 v[92:95], v[112:115], v[108:111], v[92:95]
v_mfma_f32_16x16x32_bf16 v[92:95], v[220:223], v[116:119], v[92:95]
v_mfma_f32_16x16x32_bf16 v[88:91], v[112:115], v[116:119], v[88:91]
v_mfma_f32_16x16x32_bf16 v[88:91], v[120:123], v[108:111], v[88:91]
v_mfma_f32_16x16x32_bf16 v[88:91], v[124:127], v[132:135], v[88:91]
v_mfma_f32_16x16x32_bf16 v[88:91], v[144:147], v[52:55], v[88:91]
v_mfma_f32_16x16x32_bf16 v[84:87], v[100:103], v[52:55], v[84:87]
v_mfma_f32_16x16x32_bf16 v[84:87], v[144:147], v[132:135], v[84:87]
v_mfma_f32_16x16x32_bf16 v[84:87], v[124:127], v[108:111], v[84:87]
v_mfma_f32_16x16x32_bf16 v[84:87], v[120:123], v[116:119], v[84:87]
v_mfma_f32_16x16x32_bf16 v[80:83], v[124:127], v[116:119], v[80:83]
v_mfma_f32_16x16x32_bf16 v[80:83], v[144:147], v[108:111], v[80:83]
v_mfma_f32_16x16x32_bf16 v[80:83], v[100:103], v[132:135], v[80:83]
s_waitcnt vmcnt(0)
v_cmp_ne_u32 vcc, v43, v44
v_mfma_f32_16x16x32_bf16 v[80:83], v[128:131], v[52:55], v[80:83]
v_mfma_f32_16x16x32_bf16 v[76:79], v[8:11], v[52:55], v[76:79]
v_mfma_f32_16x16x32_bf16 v[76:79], v[128:131], v[132:135], v[76:79]
v_mfma_f32_16x16x32_bf16 v[76:79], v[100:103], v[108:111], v[76:79]
v_mfma_f32_16x16x32_bf16 v[76:79], v[144:147], v[116:119], v[76:79]
v_mfma_f32_16x16x32_bf16 v[72:75], v[100:103], v[116:119], v[72:75]
s_cbranch_vccnz L_fw02
L_fb02:
v_mfma_f32_16x16x32_bf16 v[72:75], v[128:131], v[108:111], v[72:75]
v_mfma_f32_16x16x32_bf16 v[72:75], v[8:11], v[132:135], v[72:75]
buffer_load_dwordx4 v[164:167], v34, s[32:35], s69 offen offset:2048
v_mfma_f32_16x16x32_bf16 v[72:75], v[152:155], v[52:55], v[72:75]
ds_read_b128 v[120:123], v30 offset:4672
v_mfma_f32_16x16x32_bf16 v[68:71], v[20:23], v[52:55], v[68:71]
ds_read_b128 v[104:107], v30 offset:4960
v_mfma_f32_16x16x32_bf16 v[68:71], v[152:155], v[132:135], v[68:71]
ds_read_b128 v[112:115], v30 offset:5248
v_mfma_f32_16x16x32_bf16 v[68:71], v[8:11], v[108:111], v[68:71]
ds_read_b128 v[168:171], v30 offset:5536
v_mfma_f32_16x16x32_bf16 v[68:71], v[128:131], v[116:119], v[68:71]
buffer_load_dwordx4 v[172:175], v34, s[32:35], s69 offen offset:3072
v_mfma_f32_16x16x32_bf16 v[64:67], v[8:11], v[116:119], v[64:67]
s_add_u32 s69, s69, 4096
v_mfma_f32_16x16x32_bf16 v[64:67], v[152:155], v[108:111], v[64:67]
v_mfma_f32_16x16x32_bf16 v[64:67], v[20:23], v[132:135], v[64:67]
v_mfma_f32_16x16x32_bf16 v[64:67], v[24:27], v[52:55], v[64:67]
buffer_load_dwordx4 v[184:187], v34, s[32:35], s69 offen offset:0
s_waitcnt lgkmcnt(3)
v_mfma_f32_16x16x32_bf16 v[96:99], v[124:127], v[120:123], v[96:99]
s_waitcnt lgkmcnt(2)
v_mfma_f32_16x16x32_bf16 v[96:99], v[144:147], v[104:107], v[96:99]
s_waitcnt lgkmcnt(1)
v_mfma_f32_16x16x32_bf16 v[96:99], v[100:103], v[112:115], v[96:99]
s_waitcnt lgkmcnt(0)
v_mfma_f32_16x16x32_bf16 v[96:99], v[128:131], v[168:171], v[96:99]
ds_read_b32 v28, v41 offset:16
v_mfma_f32_16x16x32_bf16 v[92:95], v[8:11], v[168:171], v[92:95]
buffer_load_dwordx4 v[188:191], v34, s[32:35], s69 offen offset:1024
v_mfma_f32_16x16x32_bf16 v[92:95], v[128:131], v[112:115], v[92:95]
v_mfma_f32_16x16x32_bf16 v[92:95], v[100:103], v[104:107], v[92:95]
v_mfma_f32_16x16x32_bf16 v[92:95], v[144:147], v[120:123], v[92:95]
v_mfma_f32_16x16x32_bf16 v[88:91], v[100:103], v[120:123], v[88:91]
buffer_load_dwordx4 v[192:195], v34, s[32:35], s69 offen offset:2048
v_mfma_f32_16x16x32_bf16 v[88:91], v[128:131], v[104:107], v[88:91]
s_waitcnt lgkmcnt(0)
v_cmp_ne_u32 vcc, 4, v28
v_mfma_f32_16x16x32_bf16 v[88:91], v[8:11], v[112:115], v[88:91]
v_mfma_f32_16x16x32_bf16 v[88:91], v[152:155], v[168:171], v[88:91]
ds_read_b128 v[100:103], v31 offset:864
v_mfma_f32_16x16x32_bf16 v[84:87], v[20:23], v[168:171], v[84:87]
buffer_load_dwordx4 v[196:199], v34, s[32:35], s69 offen offset:3072
v_mfma_f32_16x16x32_bf16 v[84:87], v[152:155], v[112:115], v[84:87]
s_add_u32 s69, s69, 4096
v_mfma_f32_16x16x32_bf16 v[84:87], v[8:11], v[104:107], v[84:87]
v_mfma_f32_16x16x32_bf16 v[84:87], v[128:131], v[120:123], v[84:87]
s_cbranch_vccnz L_slow0D
L_back0D:
v_mfma_f32_16x16x32_bf16 v[80:83], v[8:11], v[120:123], v[80:83]
buffer_load_dwordx4 v[200:203], v34, s[32:35], s69 offen offset:0
v_mfma_f32_16x16x32_bf16 v[80:83], v[152:155], v[104:107], v[80:83]
ds_read_b128 v[116:119], v31 offset:576
v_mfma_f32_16x16x32_bf16 v[80:83], v[20:23], v[112:115], v[80:83]
v_mfma_f32_16x16x32_bf16 v[80:83], v[24:27], v[168:171], v[80:83]
s_waitcnt lgkmcnt(1)
v_mfma_f32_16x16x32_bf16 v[76:79], v[160:163], v[100:103], v[76:79]
ds_read_b128 v[108:111], v31 offset:288
v_mfma_f32_16x16x32_bf16 v[76:79], v[24:27], v[112:115], v[76:79]
buffer_load_dwordx4 v[204:207], v34, s[32:35], s69 offen offset:1024
v_mfma_f32_16x16x32_bf16 v[76:79], v[20:23], v[104:107], v[76:79]
ds_read_b128 v[112:115], v32 offset:288
v_mfma_f32_16x16x32_bf16 v[76:79], v[152:155], v[120:123], v[76:79]
ds_read_b128 v[132:135], v31 offset:0
v_mfma_f32_16x16x32_bf16 v[72:75], v[20:23], v[120:123], v[72:75]
v_mfma_f32_16x16x32_bf16 v[72:75], v[24:27], v[104:107], v[72:75]
ds_read_b128 v[128:131], v32 offset:0
s_waitcnt lgkmcnt(4)
v_mfma_f32_16x16x32_bf16 v[72:75], v[160:163], v[116:119], v[72:75]
buffer_load_dwordx4 v[176:179], v34, s[32:35], s69 offen offset:2048
v_mfma_f32_16x16x32_bf16 v[72:75], v[48:51], v[100:103], v[72:75]
ds_read_b128 v[124:127], v30 offset:5824
v_mfma_f32_16x16x32_bf16 v[68:71], v[24:27], v[120:123], v[68:71]
ds_read_b128 v[120:123], v30 offset:6112
s_waitcnt lgkmcnt(5)
v_mfma_f32_16x16x32_bf16 v[68:71], v[160:163], v[108:111], v[68:71]
ds_read_b128 v[208:211], v30 offset:6400
v_mfma_f32_16x16x32_bf16 v[68:71], v[48:51], v[116:119], v[68:71]
ds_read_b128 v[116:119], v30 offset:6688
s_waitcnt lgkmcnt(6)
s_waitcnt vmcnt(8)
v_mfma_f32_16x16x32_bf16 v[104:107], v[164:167], v[112:115], v[68:71]
ds_read_b128 v[212:215], v31 offset:2016
s_waitcnt lgkmcnt(6)
v_mfma_f32_16x16x32_bf16 v[64:67], v[160:163], v[132:135], v[64:67]
buffer_load_dwordx4 v[180:183], v34, s[32:35], s69 offen offset:3072
v_mfma_f32_16x16x32_bf16 v[64:67], v[48:51], v[108:111], v[64:67]
s_add_u32 s69, s69, 4096
s_waitcnt lgkmcnt(5)
v_mfma_f32_16x16x32_bf16 v[100:103], v[164:167], v[128:131], v[64:67]
s_waitcnt vmcnt(8)
v_mfma_f32_16x16x32_bf16 v[100:103], v[172:175], v[112:115], v[100:103]
s_waitcnt lgkmcnt(4)
v_mfma_f32_16x16x32_bf16 v[96:99], v[8:11], v[124:127], v[96:99]
buffer_load_dwordx4 v[240:243], v34, s[32:35], s69 offen offset:0
s_waitcnt lgkmcnt(3)
v_mfma_f32_16x16x32_bf16 v[96:99], v[152:155], v[120:123], v[96:99]
ds_read_b128 v[112:115], v31 offset:1728
s_waitcnt lgkmcnt(3)
v_mfma_f32_16x16x32_bf16 v[96:99], v[20:23], v[208:211], v[96:99]
s_waitcnt lgkmcnt(2)
v_mfma_f32_16x16x32_bf16 v[96:99], v[24:27], v[116:119], v[96:99]
s_waitcnt lgkmcnt(1)
v_mfma_f32_16x16x32_bf16 v[92:95], v[160:163], v[212:215], v[92:95]
ds_read_b128 v[108:111], v31 offset:1440
v_mfma_f32_16x16x32_bf16 v[92:95], v[24:27], v[208:211], v[92:95]
buffer_load_dwordx4 v[244:247], v34, s[32:35], s69 offen offset:1024
v_mfma_f32_16x16x32_bf16 v[92:95], v[20:23], v[120:123], v[92:95]
ds_read_b128 v[128:131], v32 offset:1440
v_mfma_f32_16x16x32_bf16 v[92:95], v[152:155], v[124:127], v[92:95]
ds_read_b128 v[132:135], v31 offset:1152
v_mfma_f32_16x16x32_bf16 v[88:91], v[20:23], v[124:127], v[88:91]
v_mfma_f32_16x16x32_bf16 v[88:91], v[24:27], v[120:123], v[88:91]
ds_read_b128 v[252:255], v32 offset:1152
s_waitcnt lgkmcnt(4)
v_mfma_f32_16x16x32_bf16 v[88:91], v[160:163], v[112:115], v[88:91]
buffer_load_dwordx4 v[56:59], v34, s[32:35], s69 offen offset:2048
v_mfma_f32_16x16x32_bf16 v[88:91], v[48:51], v[212:215], v[88:91]
v_mfma_f32_16x16x32_bf16 v[84:87], v[24:27], v[124:127], v[84:87]
ds_read_b128 v[124:127], v32 offset:864
s_waitcnt lgkmcnt(4)
v_mfma_f32_16x16x32_bf16 v[84:87], v[160:163], v[108:111], v[84:87]
v_mfma_f32_16x16x32_bf16 v[84:87], v[48:51], v[112:115], v[84:87]
buffer_load_dwordx4 v[136:139], v34, s[32:35], s69 offen offset:3072
s_waitcnt lgkmcnt(3)
v_mfma_f32_16x16x32_bf16 v[120:123], v[164:167], v[128:131], v[84:87]
s_add_u32 s69, s69, 4096
ds_read_b128 v[140:143], v32 offset:576
s_waitcnt lgkmcnt(3)
v_mfma_f32_16x16x32_bf16 v[80:83], v[160:163], v[132:135], v[80:83]
v_mfma_f32_16x16x32_bf16 v[80:83], v[48:51], v[108:111], v[80:83]
s_waitcnt lgkmcnt(2)
v_mfma_f32_16x16x32_bf16 v[116:119], v[164:167], v[252:255], v[80:83]
buffer_load_dwordx4 v[148:151], v34, s[32:35], s69 offen offset:0
v_mfma_f32_16x16x32_bf16 v[116:119], v[172:175], v[128:131], v[116:119]
v_mfma_f32_16x16x32_bf16 v[76:79], v[48:51], v[132:135], v[76:79]
s_waitcnt lgkmcnt(1)
v_mfma_f32_16x16x32_bf16 v[112:115], v[164:167], v[124:127], v[76:79]
v_mfma_f32_16x16x32_bf16 v[112:115], v[172:175], v[252:255], v[112:115]
s_mov_b32 s97, 22528
buffer_load_dword v44, v40, s[32:35], s97 offen
s_waitcnt vmcnt(13)
v_mfma_f32_16x16x32_bf16 v[112:115], v[184:187], v[128:131], v[112:115]
buffer_load_dwordx4 v[4:7], v34, s[32:35], s69 offen offset:1024
s_waitcnt lgkmcnt(0)
v_mfma_f32_16x16x32_bf16 v[108:111], v[164:167], v[140:143], v[72:75]
v_mfma_f32_16x16x32_bf16 v[108:111], v[172:175], v[124:127], v[108:111]
v_mfma_f32_16x16x32_bf16 v[108:111], v[184:187], v[252:255], v[108:111]
s_waitcnt vmcnt(13)
v_mfma_f32_16x16x32_bf16 v[108:111], v[188:191], v[128:131], v[108:111]
ds_read_b128 v[248:251], v31 offset:2304
s_waitcnt vmcnt(12)
v_mfma_f32_16x16x32_bf16 v[104:107], v[192:195], v[128:131], v[104:107]
ds_read_b128 v[12:15], v31 offset:2592
v_mfma_f32_16x16x32_bf16 v[104:107], v[188:191], v[252:255], v[104:107]
ds_read_b128 v[16:19], v32 offset:2304
v_mfma_f32_16x16x32_bf16 v[104:107], v[184:187], v[124:127], v[104:107]
ds_read_b128 v[156:159], v32 offset:2592
v_mfma_f32_16x16x32_bf16 v[104:107], v[172:175], v[140:143], v[104:107]
v_mfma_f32_16x16x32_bf16 v[100:103], v[184:187], v[140:143], v[100:103]
ds_read_b128 v[216:219], v32 offset:2016
v_mfma_f32_16x16x32_bf16 v[100:103], v[188:191], v[124:127], v[100:103]
v_mfma_f32_16x16x32_bf16 v[100:103], v[192:195], v[252:255], v[100:103]
s_waitcnt vmcnt(11)
v_mfma_f32_16x16x32_bf16 v[100:103], v[196:199], v[128:131], v[100:103]
ds_read_b128 v[220:223], v32 offset:1728
s_waitcnt lgkmcnt(5)
v_mfma_f32_16x16x32_bf16 v[96:99], v[160:163], v[248:251], v[96:99]
s_waitcnt lgkmcnt(4)
v_mfma_f32_16x16x32_bf16 v[96:99], v[48:51], v[12:15], v[96:99]
s_waitcnt lgkmcnt(3)
v_mfma_f32_16x16x32_bf16 v[132:135], v[164:167], v[16:19], v[96:99]
v_mov_b32 v47, 3
s_mov_b64 exec, 1
ds_max_u32 v41, v47
s_mov_b64 exec, -1
s_waitcnt lgkmcnt(3)
v_mfma_f32_16x16x32_bf16 v[132:135], v[172:175], v[156:159], v[132:135]
v_mfma_f32_16x16x32_bf16 v[92:95], v[48:51], v[248:251], v[92:95]
s_mov_b64 exec, 1
ds_add_u32 v41, v42 offset:20
s_mov_b64 exec, -1
s_waitcnt lgkmcnt(3)
v_mfma_f32_16x16x32_bf16 v[128:131], v[164:167], v[216:219], v[92:95]
v_mfma_f32_16x16x32_bf16 v[128:131], v[172:175], v[16:19], v[128:131]
v_mfma_f32_16x16x32_bf16 v[128:131], v[184:187], v[156:159], v[128:131]
s_waitcnt lgkmcnt(2)
v_mfma_f32_16x16x32_bf16 v[124:127], v[164:167], v[220:223], v[88:91]
v_mfma_f32_16x16x32_bf16 v[124:127], v[172:175], v[216:219], v[124:127]
v_mfma_f32_16x16x32_bf16 v[124:127], v[184:187], v[16:19], v[124:127]
v_mfma_f32_16x16x32_bf16 v[124:127], v[188:191], v[156:159], v[124:127]
v_mfma_f32_16x16x32_bf16 v[120:123], v[192:195], v[156:159], v[120:123]
v_mfma_f32_16x16x32_bf16 v[120:123], v[188:191], v[16:19], v[120:123]
v_mfma_f32_16x16x32_bf16 v[120:123], v[184:187], v[216:219], v[120:123]
v_mfma_f32_16x16x32_bf16 v[120:123], v[172:175], v[220:223], v[120:123]
v_mfma_f32_16x16x32_bf16 v[116:119], v[184:187], v[220:223], v[116:119]
v_mfma_f32_16x16x32_bf16 v[116:119], v[188:191], v[216:219], v[116:119]
v_mfma_f32_16x16x32_bf16 v[116:119], v[192:195], v[16:19], v[116:119]
v_mfma_f32_16x16x32_bf16 v[116:119], v[196:199], v[156:159], v[116:119]
s_waitcnt vmcnt(10)
v_mfma_f32_16x16x32_bf16 v[112:115], v[200:203], v[156:159], v[112:115]
v_mfma_f32_16x16x32_bf16 v[112:115], v[196:199], v[16:19], v[112:115]
v_mfma_f32_16x16x32_bf16 v[112:115], v[192:195], v[216:219], v[112:115]
v_mfma_f32_16x16x32_bf16 v[112:115], v[188:191], v[220:223], v[112:115]
v_mfma_f32_16x16x32_bf16 v[108:111], v[192:195], v[220:223], v[108:111]
v_mfma_f32_16x16x32_bf16 v[108:111], v[196:199], v[216:219], v[108:111]
v_mfma_f32_16x16x32_bf16 v[108:111], v[200:203], v[16:19], v[108:111]
s_waitcnt vmcnt(9)
v_mfma_f32_16x16x32_bf16 v[108:111], v[204:207], v[156:159], v[108:111]
ds_read_b128 v[52:55], v32 offset:2880
s_waitcnt vmcnt(8)
v_mfma_f32_16x16x32_bf16 v[104:107], v[176:179], v[156:159], v[104:107]
ds_read_b128 v[144:147], v32 offset:3168
v_mfma_f32_16x16x32_bf16 v[104:107], v[204:207], v[16:19], v[104:107]
ds_read_b128 v[168:171], v32 offset:3456
v_mfma_f32_16x16x32_bf16 v[104:107], v[200:203], v[216:219], v[104:107]
ds_read_b128 v[8:11], v32 offset:3744
v_mfma_f32_16x16x32_bf16 v[104:107], v[196:199], v[220:223], v[104:107]
v_mfma_f32_16x16x32_bf16 v[100:103], v[200:203], v[220:223], v[100:103]
v_mfma_f32_16x16x32_bf16 v[100:103], v[204:207], v[216:219], v[100:103]
v_mfma_f32_16x16x32_bf16 v[100:103], v[176:179], v[16:19], v[100:103]
s_waitcnt vmcnt(7)
v_mfma_f32_16x16x32_bf16 v[100:103], v[180:183], v[156:159], v[100:103]
s_waitcnt lgkmcnt(3)
v_mfma_f32_16x16x32_bf16 v[132:135], v[184:187], v[52:55], v[132:135]
s_waitcnt vmcnt(1)
v_cmp_ne_u32 vcc, v43, v44
s_waitcnt lgkmcnt(2)
v_mfma_f32_16x16x32_bf16 v[132:135], v[188:191], v[144:147], v[132:135]
s_waitcnt lgkmcnt(1)
v_mfma_f32_16x16x32_bf16 v[132:135], v[192:195], v[168:171], v[132:135]
s_waitcnt lgkmcnt(0)
v_mfma_f32_16x16x32_bf16 v[132:135], v[196:199], v[8:11], v[132:135]
v_mfma_f32_16x16x32_bf16 v[128:131], v[200:203], v[8:11], v[128:131]
v_mfma_f32_16x16x32_bf16 v[128:131], v[196:199], v[168:171], v[128:131]
v_mfma_f32_16x16x32_bf16 v[128:131], v[192:195], v[144:147], v[128:131]
s_cbranch_vccnz L_fw03
L_fb03:
v_mfma_f32_16x16x32_bf16 v[128:131], v[188:191], v[52:55], v[128:131]
v_mfma_f32_16x16x32_bf16 v[124:127], v[192:195], v[52:55], v[124:127]
buffer_load_dwordx4 v[208:211], v34, s[32:35], s69 offen offset:2048
v_mfma_f32_16x16x32_bf16 v[124:127], v[196:199], v[144:147], v[124:127]
v_mfma_f32_16x16x32_bf16 v[124:127], v[200:203], v[168:171], v[124:127]
v_mfma_f32_16x16x32_bf16 v[124:127], v[204:207], v[8:11], v[124:127]
v_mfma_f32_16x16x32_bf16 v[120:123], v[176:179], v[8:11], v[120:123]
buffer_load_dwordx4 v[152:155], v34, s[32:35], s69 offen offset:3072
v_mfma_f32_16x16x32_bf16 v[120:123], v[204:207], v[168:171], v[120:123]
s_add_u32 s69, s69, 4096
v_mfma_f32_16x16x32_bf16 v[120:123], v[200:203], v[144:147], v[120:123]
v_mfma_f32_16x16x32_bf16 v[120:123], v[196:199], v[52:55], v[120:123]
v_mfma_f32_16x16x32_bf16 v[116:119], v[200:203], v[52:55], v[116:119]
buffer_load_dwordx4 v[20:23], v34, s[32:35], s69 offen offset:0
v_mfma_f32_16x16x32_bf16 v[116:119], v[204:207], v[144:147], v[116:119]
v_mfma_f32_16x16x32_bf16 v[116:119], v[176:179], v[168:171], v[116:119]
v_mfma_f32_16x16x32_bf16 v[116:119], v[180:183], v[8:11], v[116:119]
v_mfma_f32_16x16x32_bf16 v[112:115], v[240:243], v[8:11], v[112:115]
buffer_load_dwordx4 v[212:215], v34, s[32:35], s69 offen offset:1024
v_mfma_f32_16x16x32_bf16 v[112:115], v[180:183], v[168:171], v[112:115]
ds_read_b32 v28, v41 offset:20
v_mfma_f32_16x16x32_bf16 v[112:115], v[176:179], v[144:147], v[112:115]
v_mfma_f32_16x16x32_bf16 v[112:115], v[204:207], v[52:55], v[112:115]
v_mfma_f32_16x16x32_bf16 v[108:111], v[176:179], v[52:55], v[108:111]
buffer_load_dwordx4 v[24:27], v34, s[32:35], s69 offen offset:2048
v_mfma_f32_16x16x32_bf16 v[108:111], v[180:183], v[144:147], v[108:111]
v_mfma_f32_16x16x32_bf16 v[108:111], v[240:243], v[168:171], v[108:111]
v_mfma_f32_16x16x32_bf16 v[108:111], v[244:247], v[8:11], v[108:111]
s_waitcnt lgkmcnt(0)
v_cmp_ne_u32 vcc, 4, v28
ds_read_b128 v[140:143], v32 offset:4032
v_mfma_f32_16x16x32_bf16 v[104:107], v[56:59], v[8:11], v[104:107]
ds_read_b128 v[252:255], v32 offset:4320
v_mfma_f32_16x16x32_bf16 v[104:107], v[244:247], v[168:171], v[104:107]
ds_read_b128 v[160:163], v32 offset:4608
v_mfma_f32_16x16x32_bf16 v[104:107], v[240:243], v[144:147], v[104:107]
ds_read_b128 v[12:15], v32 offset:4896
v_mfma_f32_16x16x32_bf16 v[104:107], v[180:183], v[52:55], v[104:107]
buffer_load_dwordx4 v[248:251], v34, s[32:35], s69 offen offset:3072
v_mfma_f32_16x16x32_bf16 v[100:103], v[240:243], v[52:55], v[100:103]
s_add_u32 s69, s69, 4096
v_mfma_f32_16x16x32_bf16 v[100:103], v[244:247], v[144:147], v[100:103]
s_cbranch_vccnz L_slow0R
L_back0R:
v_mfma_f32_16x16x32_bf16 v[100:103], v[56:59], v[168:171], v[100:103]
v_mfma_f32_16x16x32_bf16 v[100:103], v[136:139], v[8:11], v[100:103]
buffer_load_dwordx4 v[48:51], v34, s[32:35], s69 offen offset:0
s_waitcnt lgkmcnt(3)
v_mfma_f32_16x16x32_bf16 v[132:135], v[200:203], v[140:143], v[132:135]
s_waitcnt lgkmcnt(2)
v_mfma_f32_16x16x32_bf16 v[132:135], v[204:207], v[252:255], v[132:135]
s_waitcnt lgkmcnt(1)
v_mfma_f32_16x16x32_bf16 v[132:135], v[176:179], v[160:163], v[132:135]
ds_write_b128 v35, v[64:67] offset:0
s_waitcnt lgkmcnt(1)
v_mfma_f32_16x16x32_bf16 v[132:135], v[180:183], v[12:15], v[132:135]
buffer_load_dwordx4 v[164:167], v34, s[32:35], s69 offen offset:1024
v_mfma_f32_16x16x32_bf16 v[128:131], v[240:243], v[12:15], v[128:131]
v_mfma_f32_16x16x32_bf16 v[128:131], v[180:183], v[160:163], v[128:131]
v_mfma_f32_16x16x32_bf16 v[128:131], v[176:179], v[252:255], v[128:131]
v_mfma_f32_16x16x32_bf16 v[128:131], v[204:207], v[140:143], v[128:131]
buffer_load_dwordx4 v[172:175], v34, s[32:35], s69 offen offset:2048
v_mfma_f32_16x16x32_bf16 v[124:127], v[176:179], v[140:143], v[124:127]
v_mfma_f32_16x16x32_bf16 v[124:127], v[180:183], v[252:255], v[124:127]
v_mfma_f32_16x16x32_bf16 v[124:127], v[240:243], v[160:163], v[124:127]
v_mfma_f32_16x16x32_bf16 v[124:127], v[244:247], v[12:15], v[124:127]
ds_write_b128 v35, v[68:71] offset:1024
v_mfma_f32_16x16x32_bf16 v[120:123], v[56:59], v[12:15], v[120:123]
buffer_load_dwordx4 v[220:223], v34, s[32:35], s69 offen offset:3072
v_mfma_f32_16x16x32_bf16 v[120:123], v[244:247], v[160:163], v[120:123]
s_add_u32 s69, s69, 4096
v_mfma_f32_16x16x32_bf16 v[120:123], v[240:243], v[252:255], v[120:123]
v_mfma_f32_16x16x32_bf16 v[120:123], v[180:183], v[140:143], v[120:123]
v_mfma_f32_16x16x32_bf16 v[116:119], v[240:243], v[140:143], v[116:119]
buffer_load_dwordx4 v[216:219], v34, s[32:35], s69 offen offset:0
v_mfma_f32_16x16x32_bf16 v[116:119], v[244:247], v[252:255], v[116:119]
v_mfma_f32_16x16x32_bf16 v[116:119], v[56:59], v[160:163], v[116:119]
v_mfma_f32_16x16x32_bf16 v[116:119], v[136:139], v[12:15], v[116:119]
ds_read_b128 v[16:19], v32 offset:352
v_mfma_f32_16x16x32_bf16 v[112:115], v[148:151], v[12:15], v[112:115]
ds_write_b128 v35, v[72:75] offset:2048
v_mfma_f32_16x16x32_bf16 v[112:115], v[136:139], v[160:163], v[112:115]
buffer_load_dwordx4 v[156:159], v34, s[32:35], s69 offen offset:1024
v_mfma_f32_16x16x32_bf16 v[112:115], v[56:59], v[252:255], v[112:115]
v_mfma_f32_16x16x32_bf16 v[112:115], v[244:247], v[140:143], v[112:115]
v_mfma_f32_16x16x32_bf16 v[108:111], v[56:59], v[140:143], v[108:111]
v_mfma_f32_16x16x32_bf16 v[108:111], v[136:139], v[252:255], v[108:111]
ds_read_b128 v[184:187], v32 offset:64
v_mfma_f32_16x16x32_bf16 v[108:111], v[148:151], v[160:163], v[108:111]
buffer_load_dwordx4 v[188:191], v34, s[32:35], s69 offen offset:2048
s_waitcnt vmcnt(13)
v_mfma_f32_16x16x32_bf16 v[108:111], v[4:7], v[12:15], v[108:111]
ds_read_b128 v[192:195], v32 offset:5184
s_waitcnt lgkmcnt(3)
s_waitcnt vmcnt(12)
v_mfma_f32_16x16x32_bf16 v[104:107], v[208:211], v[16:19], v[104:107]
ds_read_b128 v[196:199], v32 offset:5472
v_mfma_f32_16x16x32_bf16 v[104:107], v[4:7], v[160:163], v[104:107]
ds_write_b128 v35, v[76:79] offset:3072
v_mfma_f32_16x16x32_bf16 v[104:107], v[148:151], v[252:255], v[104:107]
ds_read_b128 v[52:55], v32 offset:5760
ds_read_b128 v[144:147], v32 offset:6048
v_mfma_f32_16x16x32_bf16 v[104:107], v[136:139], v[140:143], v[104:107]
buffer_load_dwordx4 v[168:171], v34, s[32:35], s69 offen offset:3072
v_mfma_f32_16x16x32_bf16 v[100:103], v[148:151], v[140:143], v[100:103]
s_add_u32 s69, s69, 4096
v_mfma_f32_16x16x32_bf16 v[100:103], v[4:7], v[252:255], v[100:103]
s_waitcnt lgkmcnt(5)
v_mfma_f32_16x16x32_bf16 v[100:103], v[208:211], v[184:187], v[100:103]
s_waitcnt vmcnt(12)
v_mfma_f32_16x16x32_bf16 v[100:103], v[152:155], v[16:19], v[100:103]
buffer_load_dwordx4 v[8:11], v34, s[32:35], s69 offen offset:0
s_waitcnt lgkmcnt(4)
v_mfma_f32_16x16x32_bf16 v[132:135], v[240:243], v[192:195], v[132:135]
s_waitcnt lgkmcnt(3)
v_mfma_f32_16x16x32_bf16 v[132:135], v[244:247], v[196:199], v[132:135]
s_waitcnt lgkmcnt(1)
v_mfma_f32_16x16x32_bf16 v[132:135], v[56:59], v[52:55], v[132:135]
ds_write_b128 v35, v[80:83] offset:4096
s_waitcnt lgkmcnt(1)
v_mfma_f32_16x16x32_bf16 v[132:135], v[136:139], v[144:147], v[132:135]
ds_read_b128 v[200:203], v32 offset:1504
v_mfma_f32_16x16x32_bf16 v[128:131], v[148:151], v[144:147], v[128:131]
buffer_load_dwordx4 v[204:207], v34, s[32:35], s69 offen offset:1024
v_mfma_f32_16x16x32_bf16 v[128:131], v[136:139], v[52:55], v[128:131]
v_mfma_f32_16x16x32_bf16 v[128:131], v[56:59], v[196:199], v[128:131]
v_mfma_f32_16x16x32_bf16 v[128:131], v[244:247], v[192:195], v[128:131]
v_mfma_f32_16x16x32_bf16 v[124:127], v[56:59], v[192:195], v[124:127]
v_mfma_f32_16x16x32_bf16 v[124:127], v[136:139], v[196:199], v[124:127]
ds_read_b128 v[176:179], v32 offset:1216
v_mfma_f32_16x16x32_bf16 v[124:127], v[148:151], v[52:55], v[124:127]
v_mfma_f32_16x16x32_bf16 v[124:127], v[4:7], v[144:147], v[124:127]
ds_write_b128 v35, v[84:87] offset:5120
s_waitcnt lgkmcnt(2)
v_mfma_f32_16x16x32_bf16 v[120:123], v[208:211], v[200:203], v[120:123]
v_mfma_f32_16x16x32_bf16 v[120:123], v[4:7], v[52:55], v[120:123]
s_mov_b32 s97, 26624
buffer_load_dword v44, v40, s[32:35], s97 offen
v_mfma_f32_16x16x32_bf16 v[120:123], v[148:151], v[196:199], v[120:123]
ds_read_b128 v[180:183], v32 offset:928
v_mfma_f32_16x16x32_bf16 v[120:123], v[136:139], v[192:195], v[120:123]
ds_read_b128 v[12:15], v32 offset:640
v_mfma_f32_16x16x32_bf16 v[116:119], v[148:151], v[192:195], v[116:119]
v_mfma_f32_16x16x32_bf16 v[116:119], v[4:7], v[196:199], v[116:119]
s_waitcnt lgkmcnt(3)
v_mfma_f32_16x16x32_bf16 v[116:119], v[208:211], v[176:179], v[116:119]
v_mfma_f32_16x16x32_bf16 v[116:119], v[152:155], v[200:203], v[116:119]
s_waitcnt vmcnt(14)
v_mfma_f32_16x16x32_bf16 v[112:115], v[20:23], v[200:203], v[112:115]
ds_write_b128 v35, v[88:91] offset:6144
v_mfma_f32_16x16x32_bf16 v[112:115], v[152:155], v[176:179], v[112:115]
s_waitcnt lgkmcnt(2)
v_mfma_f32_16x16x32_bf16 v[112:115], v[208:211], v[180:183], v[112:115]
v_mfma_f32_16x16x32_bf16 v[112:115], v[4:7], v[192:195], v[112:115]
s_waitcnt lgkmcnt(1)
v_mfma_f32_16x16x32_bf16 v[108:111], v[208:211], v[12:15], v[108:111]
v_mfma_f32_16x16x32_bf16 v[108:111], v[152:155], v[180:183], v[108:111]
v_mfma_f32_16x16x32_bf16 v[108:111], v[20:23], v[176:179], v[108:111]
s_waitcnt vmcnt(13)
v_mfma_f32_16x16x32_bf16 v[108:111], v[212:215], v[200:203], v[108:111]
ds_read_b128 v[160:163], v32 offset:6336
s_waitcnt vmcnt(12)
v_mfma_f32_16x16x32_bf16 v[104:107], v[24:27], v[200:203], v[104:107]
ds_read_b128 v[140:143], v32 offset:6624
v_mfma_f32_16x16x32_bf16 v[104:107], v[212:215], v[176:179], v[104:107]
ds_write_b128 v35, v[92:95] offset:7168
v_mfma_f32_16x16x32_bf16 v[104:107], v[20:23], v[180:183], v[104:107]
ds_read_b128 v[252:255], v32 offset:2368
ds_read_b128 v[184:187], v32 offset:2656
v_mfma_f32_16x16x32_bf16 v[104:107], v[152:155], v[12:15], v[104:107]
v_mfma_f32_16x16x32_bf16 v[100:103], v[20:23], v[12:15], v[100:103]
v_mfma_f32_16x16x32_bf16 v[100:103], v[212:215], v[180:183], v[100:103]
ds_read_b128 v[16:19], v32 offset:2080
v_mfma_f32_16x16x32_bf16 v[100:103], v[24:27], v[176:179], v[100:103]
s_waitcnt vmcnt(11)
v_mfma_f32_16x16x32_bf16 v[100:103], v[248:251], v[200:203], v[100:103]
ds_read_b128 v[240:243], v32 offset:1792
s_waitcnt lgkmcnt(6)
v_mfma_f32_16x16x32_bf16 v[132:135], v[148:151], v[160:163], v[132:135]
s_waitcnt lgkmcnt(5)
v_mfma_f32_16x16x32_bf16 v[132:135], v[4:7], v[140:143], v[132:135]
s_waitcnt lgkmcnt(3)
v_mfma_f32_16x16x32_bf16 v[132:135], v[208:211], v[252:255], v[132:135]
ds_write_b128 v35, v[96:99] offset:8192
s_waitcnt lgkmcnt(3)
v_mfma_f32_16x16x32_bf16 v[132:135], v[152:155], v[184:187], v[132:135]
v_mfma_f32_16x16x32_bf16 v[128:131], v[20:23], v[184:187], v[128:131]
v_mfma_f32_16x16x32_bf16 v[128:131], v[152:155], v[252:255], v[128:131]
s_waitcnt lgkmcnt(2)
v_mfma_f32_16x16x32_bf16 v[128:131], v[208:211], v[16:19], v[128:131]
v_mfma_f32_16x16x32_bf16 v[128:131], v[4:7], v[160:163], v[128:131]
s_waitcnt lgkmcnt(1)
v_mfma_f32_16x16x32_bf16 v[124:127], v[208:211], v[240:243], v[124:127]
v_mfma_f32_16x16x32_bf16 v[124:127], v[152:155], v[16:19], v[124:127]
s_mov_b64 exec, 1
ds_add_u32 v45, v42 offset:24
s_mov_b64 exec, -1
v_mfma_f32_16x16x32_bf16 v[124:127], v[20:23], v[252:255], v[124:127]
v_mfma_f32_16x16x32_bf16 v[124:127], v[212:215], v[184:187], v[124:127]
v_mfma_f32_16x16x32_bf16 v[120:123], v[24:27], v[184:187], v[120:123]
v_mfma_f32_16x16x32_bf16 v[120:123], v[212:215], v[252:255], v[120:123]
v_mfma_f32_16x16x32_bf16 v[120:123], v[20:23], v[16:19], v[120:123]
v_mfma_f32_16x16x32_bf16 v[120:123], v[152:155], v[240:243], v[120:123]
v_mfma_f32_16x16x32_bf16 v[116:119], v[20:23], v[240:243], v[116:119]
v_mfma_f32_16x16x32_bf16 v[116:119], v[212:215], v[16:19], v[116:119]
v_mfma_f32_16x16x32_bf16 v[116:119], v[24:27], v[252:255], v[116:119]
v_mfma_f32_16x16x32_bf16 v[116:119], v[248:251], v[184:187], v[116:119]
s_waitcnt vmcnt(10)
v_mfma_f32_16x16x32_bf16 v[112:115], v[48:51], v[184:187], v[112:115]
v_mfma_f32_16x16x32_bf16 v[112:115], v[248:251], v[252:255], v[112:115]
v_mfma_f32_16x16x32_bf16 v[112:115], v[24:27], v[16:19], v[112:115]
v_mfma_f32_16x16x32_bf16 v[112:115], v[212:215], v[240:243], v[112:115]
v_mfma_f32_16x16x32_bf16 v[108:111], v[24:27], v[240:243], v[108:111]
v_mfma_f32_16x16x32_bf16 v[108:111], v[248:251], v[16:19], v[108:111]
v_mfma_f32_16x16x32_bf16 v[108:111], v[48:51], v[252:255], v[108:111]
s_waitcnt vmcnt(9)
v_mfma_f32_16x16x32_bf16 v[108:111], v[164:167], v[184:187], v[108:111]
s_waitcnt vmcnt(0)
v_cmp_ne_u32 vcc, v43, v44
ds_read_b128 v[244:247], v32 offset:2944
v_mfma_f32_16x16x32_bf16 v[104:107], v[172:175], v[184:187], v[104:107]
ds_read_b128 v[56:59], v32 offset:3232
v_mfma_f32_16x16x32_bf16 v[104:107], v[164:167], v[252:255], v[104:107]
ds_read_b128 v[144:147], v32 offset:3520
v_mfma_f32_16x16x32_bf16 v[104:107], v[48:51], v[16:19], v[104:107]
ds_read_b32 v28, v45 offset:24
v_mfma_f32_16x16x32_bf16 v[104:107], v[248:251], v[240:243], v[104:107]
ds_read_b128 v[52:55], v32 offset:3808
v_mfma_f32_16x16x32_bf16 v[100:103], v[48:51], v[240:243], v[100:103]
v_mfma_f32_16x16x32_bf16 v[100:103], v[164:167], v[16:19], v[100:103]
s_cbranch_vccnz L_fw04
L_fb04:
v_mfma_f32_16x16x32_bf16 v[100:103], v[172:175], v[252:255], v[100:103]
v_mfma_f32_16x16x32_bf16 v[100:103], v[220:223], v[184:187], v[100:103]
buffer_load_dwordx4 v[136:139], v34, s[32:35], s69 offen offset:2048
s_waitcnt lgkmcnt(4)
v_mfma_f32_16x16x32_bf16 v[132:135], v[20:23], v[244:247], v[132:135]
s_waitcnt lgkmcnt(1)
v_cmp_ne_u32 vcc, 2, v28
v_mfma_f32_16x16x32_bf16 v[132:135], v[212:215], v[56:59], v[132:135]
v_mfma_f32_16x16x32_bf16 v[132:135], v[24:27], v[144:147], v[132:135]
s_waitcnt lgkmcnt(0)
v_mfma_f32_16x16x32_bf16 v[132:135], v[248:251], v[52:55], v[132:135]
buffer_load_dwordx4 v[196:199], v34, s[32:35], s69 offen offset:3072
v_mfma_f32_16x16x32_bf16 v[128:131], v[48:51], v[52:55], v[128:131]
s_add_u32 s69, s69, 4096
v_mfma_f32_16x16x32_bf16 v[128:131], v[248:251], v[144:147], v[128:131]
v_mfma_f32_16x16x32_bf16 v[128:131], v[24:27], v[56:59], v[128:131]
s_cbranch_vccnz L_slow0P
L_back0P:
v_mfma_f32_16x16x32_bf16 v[128:131], v[212:215], v[244:247], v[128:131]
buffer_load_dwordx4 v[192:195], v34, s[32:35], s69 offen offset:0
v_mfma_f32_16x16x32_bf16 v[124:127], v[24:27], v[244:247], v[124:127]
v_mfma_f32_16x16x32_bf16 v[124:127], v[248:251], v[56:59], v[124:127]
v_mfma_f32_16x16x32_bf16 v[124:127], v[48:51], v[144:147], v[124:127]
v_mfma_f32_16x16x32_bf16 v[124:127], v[164:167], v[52:55], v[124:127]
buffer_load_dwordx4 v[12:15], v34, s[32:35], s69 offen offset:1024
v_mfma_f32_16x16x32_bf16 v[120:123], v[172:175], v[52:55], v[120:123]
v_mfma_f32_16x16x32_bf16 v[120:123], v[164:167], v[144:147], v[120:123]
v_mfma_f32_16x16x32_bf16 v[120:123], v[48:51], v[56:59], v[120:123]
v_mfma_f32_16x16x32_bf16 v[120:123], v[248:251], v[244:247], v[120:123]
buffer_load_dwordx4 v[180:183], v34, s[32:35], s69 offen offset:2048
v_mfma_f32_16x16x32_bf16 v[116:119], v[48:51], v[244:247], v[116:119]
v_mfma_f32_16x16x32_bf16 v[116:119], v[164:167], v[56:59], v[116:119]
v_mfma_f32_16x16x32_bf16 v[116:119], v[172:175], v[144:147], v[116:119]
v_mfma_f32_16x16x32_bf16 v[116:119], v[220:223], v[52:55], v[116:119]
buffer_load_dwordx4 v[176:179], v34, s[32:35], s69 offen offset:3072
v_mfma_f32_16x16x32_bf16 v[112:115], v[216:219], v[52:55], v[112:115]
s_add_u32 s69, s69, 4096
v_mfma_f32_16x16x32_bf16 v[112:115], v[220:223], v[144:147], v[112:115]
v_mfma_f32_16x16x32_bf16 v[112:115], v[172:175], v[56:59], v[112:115]
v_mfma_f32_16x16x32_bf16 v[112:115], v[164:167], v[244:247], v[112:115]
buffer_load_dwordx4 v[200:203], v34, s[32:35], s69 offen offset:0
v_mfma_f32_16x16x32_bf16 v[108:111], v[172:175], v[244:247], v[108:111]
v_mfma_f32_16x16x32_bf16 v[108:111], v[220:223], v[56:59], v[108:111]
v_mfma_f32_16x16x32_bf16 v[108:111], v[216:219], v[144:147], v[108:111]
v_mfma_f32_16x16x32_bf16 v[108:111], v[156:159], v[52:55], v[108:111]
ds_read_b128 v[148:151], v32 offset:4096
v_mfma_f32_16x16x32_bf16 v[104:107], v[188:191], v[52:55], v[104:107]
ds_read_b128 v[232:235], v36 offset:2048
v_mfma_f32_16x16x32_bf16 v[104:107], v[156:159], v[144:147], v[104:107]
ds_read_b128 v[140:143], v32 offset:4384
ds_read_b128 v[160:163], v32 offset:4672
v_mfma_f32_16x16x32_bf16 v[104:107], v[216:219], v[56:59], v[104:107]
ds_read_b128 v[4:7], v32 offset:4960
v_mfma_f32_16x16x32_bf16 v[104:107], v[220:223], v[244:247], v[104:107]
buffer_load_dwordx4 v[208:211], v34, s[32:35], s69 offen offset:1024
v_mfma_f32_16x16x32_bf16 v[100:103], v[216:219], v[244:247], v[100:103]
ds_read_b128 v[228:231], v36 offset:1024
v_mfma_f32_16x16x32_bf16 v[100:103], v[156:159], v[56:59], v[100:103]
v_mfma_f32_16x16x32_bf16 v[100:103], v[188:191], v[144:147], v[100:103]
v_mfma_f32_16x16x32_bf16 v[100:103], v[168:171], v[52:55], v[100:103]
buffer_load_dwordx4 v[152:155], v34, s[32:35], s69 offen offset:2048
s_waitcnt lgkmcnt(5)
v_mfma_f32_16x16x32_bf16 v[132:135], v[48:51], v[148:151], v[132:135]
s_waitcnt lgkmcnt(4)
v_add_f32 v108, v108, v232
v_add_f32 v109, v109, v233
s_waitcnt lgkmcnt(3)
v_mfma_f32_16x16x32_bf16 v[132:135], v[164:167], v[140:143], v[132:135]
v_add_f32 v110, v110, v234
v_add_f32 v111, v111, v235
s_waitcnt lgkmcnt(2)
v_mfma_f32_16x16x32_bf16 v[132:135], v[172:175], v[160:163], v[132:135]
ds_read_b128 v[224:227], v36 offset:0
s_waitcnt lgkmcnt(2)
v_mfma_f32_16x16x32_bf16 v[132:135], v[220:223], v[4:7], v[132:135]
buffer_load_dwordx4 v[64:67], v34, s[32:35], s69 offen offset:3072
v_mfma_f32_16x16x32_bf16 v[128:131], v[216:219], v[4:7], v[128:131]
s_add_u32 s69, s69, 4096
s_waitcnt lgkmcnt(1)
v_add_f32 v104, v104, v228
v_add_f32 v105, v105, v229
v_mfma_f32_16x16x32_bf16 v[128:131], v[220:223], v[160:163], v[128:131]
v_add_f32 v106, v106, v230
v_add_f32 v107, v107, v231
v_mfma_f32_16x16x32_bf16 v[128:131], v[172:175], v[140:143], v[128:131]
buffer_store_dword v61, v60, s[40:43], 0 offen sc1
v_mfma_f32_16x16x32_bf16 v[128:131], v[164:167], v[148:151], v[128:131]
buffer_load_dwordx4 v[68:71], v34, s[32:35], s69 offen offset:0
v_mfma_f32_16x16x32_bf16 v[124:127], v[172:175], v[148:151], v[124:127]
s_waitcnt lgkmcnt(0)
v_add_f32 v100, v100, v224
v_add_f32 v101, v101, v225
v_mfma_f32_16x16x32_bf16 v[124:127], v[220:223], v[140:143], v[124:127]
v_add_f32 v102, v102, v226
v_add_f32 v103, v103, v227
v_mfma_f32_16x16x32_bf16 v[124:127], v[216:219], v[160:163], v[124:127]
v_mfma_f32_16x16x32_bf16 v[124:127], v[156:159], v[4:7], v[124:127]
buffer_load_dwordx4 v[72:75], v34, s[32:35], s69 offen offset:1024
v_mfma_f32_16x16x32_bf16 v[120:123], v[188:191], v[4:7], v[120:123]
v_mfma_f32_16x16x32_bf16 v[120:123], v[156:159], v[160:163], v[120:123]
v_mfma_f32_16x16x32_bf16 v[120:123], v[216:219], v[140:143], v[120:123]
v_mfma_f32_16x16x32_bf16 v[120:123], v[220:223], v[148:151], v[120:123]
buffer_load_dwordx4 v[76:79], v34, s[32:35], s69 offen offset:2048
v_mfma_f32_16x16x32_bf16 v[116:119], v[216:219], v[148:151], v[116:119]
v_mfma_f32_16x16x32_bf16 v[116:119], v[156:159], v[140:143], v[116:119]
v_mfma_f32_16x16x32_bf16 v[116:119], v[188:191], v[160:163], v[116:119]
v_mfma_f32_16x16x32_bf16 v[116:119], v[168:171], v[4:7], v[116:119]
ds_read_b128 v[80:83], v32 offset:416
v_mfma_f32_16x16x32_bf16 v[112:115], v[8:11], v[4:7], v[112:115]
ds_read_b128 v[224:227], v36 offset:4096
v_mfma_f32_16x16x32_bf16 v[112:115], v[168:171], v[160:163], v[112:115]
buffer_load_dwordx4 v[84:87], v34, s[32:35], s69 offen offset:3072
v_mfma_f32_16x16x32_bf16 v[112:115], v[188:191], v[140:143], v[112:115]
s_add_u32 s69, s69, 4096
v_mfma_f32_16x16x32_bf16 v[112:115], v[156:159], v[148:151], v[112:115]
v_mfma_f32_16x16x32_bf16 v[108:111], v[188:191], v[148:151], v[108:111]
ds_read_b128 v[236:239], v36 offset:3072
v_mfma_f32_16x16x32_bf16 v[108:111], v[168:171], v[140:143], v[108:111]
ds_read_b128 v[88:91], v32 offset:128
v_mfma_f32_16x16x32_bf16 v[108:111], v[8:11], v[160:163], v[108:111]
buffer_load_dwordx4 v[92:95], v34, s[32:35], s69 offen offset:0
v_mfma_f32_16x16x32_bf16 v[108:111], v[204:207], v[4:7], v[108:111]
ds_read_b128 v[96:99], v32 offset:5248
s_waitcnt lgkmcnt(4)
s_waitcnt vmcnt(15)
v_mfma_f32_16x16x32_bf16 v[104:107], v[136:139], v[80:83], v[104:107]
s_waitcnt lgkmcnt(3)
v_add_f32 v116, v116, v224
v_add_f32 v117, v117, v225
v_mfma_f32_16x16x32_bf16 v[104:107], v[204:207], v[160:163], v[104:107]
v_add_f32 v118, v118, v226
v_add_f32 v119, v119, v227
v_mfma_f32_16x16x32_bf16 v[104:107], v[8:11], v[140:143], v[104:107]
ds_read_b128 v[240:243], v32 offset:5536
ds_read_b128 v[16:19], v32 offset:5824
v_mfma_f32_16x16x32_bf16 v[104:107], v[168:171], v[148:151], v[104:107]
ds_read_b128 v[252:255], v32 offset:6112
v_mfma_f32_16x16x32_bf16 v[100:103], v[8:11], v[148:151], v[100:103]
s_waitcnt lgkmcnt(5)
v_add_f32 v112, v112, v236
v_add_f32 v113, v113, v237
v_mfma_f32_16x16x32_bf16 v[100:103], v[204:207], v[140:143], v[100:103]
v_add_f32 v114, v114, v238
v_add_f32 v115, v115, v239
s_waitcnt lgkmcnt(4)
v_mfma_f32_16x16x32_bf16 v[100:103], v[136:139], v[88:91], v[100:103]
buffer_load_dwordx4 v[184:187], v34, s[32:35], s69 offen offset:1024
s_waitcnt vmcnt(15)
v_mfma_f32_16x16x32_bf16 v[100:103], v[196:199], v[80:83], v[100:103]
s_waitcnt lgkmcnt(3)
v_mfma_f32_16x16x32_bf16 v[132:135], v[216:219], v[96:99], v[132:135]
s_waitcnt lgkmcnt(2)
v_mfma_f32_16x16x32_bf16 v[132:135], v[156:159], v[240:243], v[132:135]
s_waitcnt lgkmcnt(1)
v_mfma_f32_16x16x32_bf16 v[132:135], v[188:191], v[16:19], v[132:135]
s_waitcnt lgkmcnt(0)
v_mfma_f32_16x16x32_bf16 v[132:135], v[168:171], v[252:255], v[132:135]
ds_read_b128 v[20:23], v32 offset:1568
v_mfma_f32_16x16x32_bf16 v[128:131], v[8:11], v[252:255], v[128:131]
v_mfma_f32_16x16x32_bf16 v[128:131], v[168:171], v[16:19], v[128:131]
v_mfma_f32_16x16x32_bf16 v[128:131], v[188:191], v[240:243], v[128:131]
v_mfma_f32_16x16x32_bf16 v[128:131], v[156:159], v[96:99], v[128:131]
v_mfma_f32_16x16x32_bf16 v[124:127], v[188:191], v[96:99], v[124:127]
ds_read_b128 v[236:239], v36 offset:7168
v_mfma_f32_16x16x32_bf16 v[124:127], v[168:171], v[240:243], v[124:127]
ds_read_b128 v[212:215], v32 offset:1280
v_mfma_f32_16x16x32_bf16 v[124:127], v[8:11], v[16:19], v[124:127]
v_mfma_f32_16x16x32_bf16 v[124:127], v[204:207], v[252:255], v[124:127]
s_waitcnt lgkmcnt(2)
v_mfma_f32_16x16x32_bf16 v[120:123], v[136:139], v[20:23], v[120:123]
ds_read_b128 v[232:235], v36 offset:6144
v_mfma_f32_16x16x32_bf16 v[120:123], v[204:207], v[16:19], v[120:123]
ds_read_b128 v[24:27], v32 offset:992
v_mfma_f32_16x16x32_bf16 v[120:123], v[8:11], v[240:243], v[120:123]
v_mfma_f32_16x16x32_bf16 v[120:123], v[168:171], v[96:99], v[120:123]
ds_read_b128 v[248:251], v32 offset:704
v_mfma_f32_16x16x32_bf16 v[116:119], v[8:11], v[96:99], v[116:119]
s_waitcnt lgkmcnt(4)
v_add_f32 v128, v128, v236
v_add_f32 v129, v129, v237
v_mfma_f32_16x16x32_bf16 v[116:119], v[204:207], v[240:243], v[116:119]
v_add_f32 v130, v130, v238
v_add_f32 v131, v131, v239
s_waitcnt lgkmcnt(3)
v_mfma_f32_16x16x32_bf16 v[116:119], v[136:139], v[212:215], v[116:119]
ds_read_b128 v[228:231], v36 offset:5120
v_mfma_f32_16x16x32_bf16 v[116:119], v[196:199], v[20:23], v[116:119]
s_waitcnt vmcnt(14)
v_mfma_f32_16x16x32_bf16 v[112:115], v[192:195], v[20:23], v[112:115]
s_waitcnt lgkmcnt(3)
v_add_f32 v124, v124, v232
v_add_f32 v125, v125, v233
v_mfma_f32_16x16x32_bf16 v[112:115], v[196:199], v[212:215], v[112:115]
v_add_f32 v126, v126, v234
v_add_f32 v127, v127, v235
s_waitcnt lgkmcnt(2)
v_mfma_f32_16x16x32_bf16 v[112:115], v[136:139], v[24:27], v[112:115]
s_mov_b32 s97, 30720
buffer_load_dword v44, v46, s[32:35], s97 offen
v_mfma_f32_16x16x32_bf16 v[112:115], v[204:207], v[96:99], v[112:115]
s_waitcnt lgkmcnt(1)
v_mfma_f32_16x16x32_bf16 v[108:111], v[136:139], v[248:251], v[108:111]
s_waitcnt lgkmcnt(0)
v_add_f32 v120, v120, v228
v_add_f32 v121, v121, v229
v_mfma_f32_16x16x32_bf16 v[108:111], v[196:199], v[24:27], v[108:111]
v_add_f32 v122, v122, v230
v_add_f32 v123, v123, v231
v_mfma_f32_16x16x32_bf16 v[108:111], v[192:195], v[212:215], v[108:111]
s_waitcnt vmcnt(14)
v_mfma_f32_16x16x32_bf16 v[108:111], v[12:15], v[20:23], v[108:111]
ds_read_b128 v[244:247], v32 offset:6400
s_waitcnt vmcnt(13)
v_mfma_f32_16x16x32_bf16 v[104:107], v[180:183], v[20:23], v[104:107]
ds_read_b128 v[56:59], v32 offset:6688
v_mfma_f32_16x16x32_bf16 v[104:107], v[12:15], v[212:215], v[104:107]
ds_read_b128 v[144:147], v32 offset:2432
v_mfma_f32_16x16x32_bf16 v[104:107], v[192:195], v[24:27], v[104:107]
ds_read_b128 v[52:55], v32 offset:2720
v_mfma_f32_16x16x32_bf16 v[104:107], v[196:199], v[248:251], v[104:107]
v_mfma_f32_16x16x32_bf16 v[100:103], v[192:195], v[248:251], v[100:103]
v_mfma_f32_16x16x32_bf16 v[100:103], v[12:15], v[24:27], v[100:103]
ds_read_b128 v[48:51], v32 offset:2144
v_mfma_f32_16x16x32_bf16 v[100:103], v[180:183], v[212:215], v[100:103]
s_waitcnt vmcnt(12)
v_mfma_f32_16x16x32_bf16 v[100:103], v[176:179], v[20:23], v[100:103]
ds_read_b128 v[164:167], v32 offset:1856
s_waitcnt lgkmcnt(5)
v_mfma_f32_16x16x32_bf16 v[132:135], v[8:11], v[244:247], v[132:135]
s_waitcnt lgkmcnt(4)
v_mfma_f32_16x16x32_bf16 v[132:135], v[204:207], v[56:59], v[132:135]
s_waitcnt lgkmcnt(3)
v_mfma_f32_16x16x32_bf16 v[132:135], v[136:139], v[144:147], v[132:135]
s_waitcnt lgkmcnt(2)
v_mfma_f32_16x16x32_bf16 v[132:135], v[196:199], v[52:55], v[132:135]
v_mfma_f32_16x16x32_bf16 v[128:131], v[192:195], v[52:55], v[128:131]
ds_read_b128 v[224:227], v36 offset:8192
v_mfma_f32_16x16x32_bf16 v[128:131], v[196:199], v[144:147], v[128:131]
s_waitcnt lgkmcnt(2)
v_mfma_f32_16x16x32_bf16 v[128:131], v[136:139], v[48:51], v[128:131]
v_mfma_f32_16x16x32_bf16 v[128:131], v[204:207], v[244:247], v[128:131]
s_waitcnt lgkmcnt(1)
v_mfma_f32_16x16x32_bf16 v[124:127], v[136:139], v[164:167], v[124:127]
v_mfma_f32_16x16x32_bf16 v[124:127], v[196:199], v[48:51], v[124:127]
v_mfma_f32_16x16x32_bf16 v[124:127], v[192:195], v[144:147], v[124:127]
v_mfma_f32_16x16x32_bf16 v[124:127], v[12:15], v[52:55], v[124:127]
v_mfma_f32_16x16x32_bf16 v[120:123], v[180:183], v[52:55], v[120:123]
s_waitcnt lgkmcnt(0)
v_add_f32 v132, v132, v224
v_add_f32 v133, v133, v225
v_mfma_f32_16x16x32_bf16 v[120:123], v[12:15], v[144:147], v[120:123]
v_add_f32 v134, v134, v226
v_add_f32 v135, v135, v227
v_mfma_f32_16x16x32_bf16 v[120:123], v[192:195], v[48:51], v[120:123]
v_mfma_f32_16x16x32_bf16 v[120:123], v[196:199], v[164:167], v[120:123]
v_mfma_f32_16x16x32_bf16 v[116:119], v[192:195], v[164:167], v[116:119]
v_mfma_f32_16x16x32_bf16 v[116:119], v[12:15], v[48:51], v[116:119]
v_mfma_f32_16x16x32_bf16 v[116:119], v[180:183], v[144:147], v[116:119]
v_mfma_f32_16x16x32_bf16 v[116:119], v[176:179], v[52:55], v[116:119]
s_waitcnt vmcnt(11)
v_mfma_f32_16x16x32_bf16 v[112:115], v[200:203], v[52:55], v[112:115]
v_mfma_f32_16x16x32_bf16 v[112:115], v[176:179], v[144:147], v[112:115]
v_mfma_f32_16x16x32_bf16 v[112:115], v[180:183], v[48:51], v[112:115]
v_mfma_f32_16x16x32_bf16 v[112:115], v[12:15], v[164:167], v[112:115]
v_mfma_f32_16x16x32_bf16 v[108:111], v[180:183], v[164:167], v[108:111]
v_mfma_f32_16x16x32_bf16 v[108:111], v[176:179], v[48:51], v[108:111]
v_mfma_f32_16x16x32_bf16 v[108:111], v[200:203], v[144:147], v[108:111]
s_waitcnt vmcnt(10)
v_mfma_f32_16x16x32_bf16 v[108:111], v[208:211], v[52:55], v[108:111]
ds_read_b128 v[172:175], v32 offset:3008
s_waitcnt vmcnt(9)
v_mfma_f32_16x16x32_bf16 v[104:107], v[152:155], v[52:55], v[104:107]
ds_read_b128 v[220:223], v32 offset:3296
v_mfma_f32_16x16x32_bf16 v[104:107], v[208:211], v[144:147], v[104:107]
ds_read_b128 v[4:7], v32 offset:3584
v_mfma_f32_16x16x32_bf16 v[104:107], v[200:203], v[48:51], v[104:107]
ds_read_b128 v[160:163], v32 offset:3872
v_mfma_f32_16x16x32_bf16 v[104:107], v[176:179], v[164:167], v[104:107]
v_mfma_f32_16x16x32_bf16 v[100:103], v[200:203], v[164:167], v[100:103]
v_mfma_f32_16x16x32_bf16 v[100:103], v[208:211], v[48:51], v[100:103]
v_mfma_f32_16x16x32_bf16 v[100:103], v[152:155], v[144:147], v[100:103]
s_waitcnt vmcnt(8)
v_mfma_f32_16x16x32_bf16 v[100:103], v[64:67], v[52:55], v[100:103]
s_waitcnt lgkmcnt(3)
v_mfma_f32_16x16x32_bf16 v[132:135], v[192:195], v[172:175], v[132:135]
s_waitcnt vmcnt(0)
v_cmp_ne_u32 vcc, v43, v44
s_waitcnt lgkmcnt(2)
v_mfma_f32_16x16x32_bf16 v[132:135], v[12:15], v[220:223], v[132:135]
s_waitcnt lgkmcnt(1)
v_mfma_f32_16x16x32_bf16 v[132:135], v[180:183], v[4:7], v[132:135]
s_waitcnt lgkmcnt(0)
v_mfma_f32_16x16x32_bf16 v[132:135], v[176:179], v[160:163], v[132:135]
v_mfma_f32_16x16x32_bf16 v[128:131], v[200:203], v[160:163], v[128:131]
v_mfma_f32_16x16x32_bf16 v[128:131], v[176:179], v[4:7], v[128:131]
v_mfma_f32_16x16x32_bf16 v[128:131], v[180:183], v[220:223], v[128:131]
s_cbranch_vccnz L_fw05
L_fb05:
v_mfma_f32_16x16x32_bf16 v[128:131], v[12:15], v[172:175], v[128:131]
v_mfma_f32_16x16x32_bf16 v[124:127], v[180:183], v[172:175], v[124:127]
buffer_load_dwordx4 v[148:151], v34, s[32:35], s69 offen offset:2048
v_mfma_f32_16x16x32_bf16 v[124:127], v[176:179], v[220:223], v[124:127]
v_mfma_f32_16x16x32_bf16 v[124:127], v[200:203], v[4:7], v[124:127]
v_mfma_f32_16x16x32_bf16 v[124:127], v[208:211], v[160:163], v[124:127]
s_mov_b64 exec, 1
ds_add_u32 v41, v42 offset:4
s_mov_b64 exec, -1
v_mfma_f32_16x16x32_bf16 v[120:123], v[152:155], v[160:163], v[120:123]
buffer_load_dwordx4 v[140:143], v34, s[32:35], s69 offen offset:3072
v_mfma_f32_16x16x32_bf16 v[120:123], v[208:211], v[4:7], v[120:123]
s_add_u32 s69, s69, 4096
v_mfma_f32_16x16x32_bf16 v[120:123], v[200:203], v[220:223], v[120:123]
v_mfma_f32_16x16x32_bf16 v[120:123], v[176:179], v[172:175], v[120:123]
v_mfma_f32_16x16x32_bf16 v[116:119], v[200:203], v[172:175], v[116:119]
buffer_load_dwordx4 v[88:91], v34, s[32:35], s69 offen offset:0
v_mfma_f32_16x16x32_bf16 v[116:119], v[208:211], v[220:223], v[116:119]
v_mfma_f32_16x16x32_bf16 v[116:119], v[152:155], v[4:7], v[116:119]
v_mfma_f32_16x16x32_bf16 v[116:119], v[64:67], v[160:163], v[116:119]
v_mfma_f32_16x16x32_bf16 v[112:115], v[68:71], v[160:163], v[112:115]
buffer_load_dwordx4 v[80:83], v34, s[32:35], s69 offen offset:1024
v_mfma_f32_16x16x32_bf16 v[112:115], v[64:67], v[4:7], v[112:115]
v_mfma_f32_16x16x32_bf16 v[112:115], v[152:155], v[220:223], v[112:115]
v_mfma_f32_16x16x32_bf16 v[112:115], v[208:211], v[172:175], v[112:115]
v_mfma_f32_16x16x32_bf16 v[108:111], v[152:155], v[172:175], v[108:111]
buffer_load_dwordx4 v[216:219], v34, s[32:35], s69 offen offset:2048
v_mfma_f32_16x16x32_bf16 v[108:111], v[64:67], v[220:223], v[108:111]
v_mfma_f32_16x16x32_bf16 v[108:111], v[68:71], v[4:7], v[108:111]
v_mfma_f32_16x16x32_bf16 v[108:111], v[72:75], v[160:163], v[108:111]
ds_read_b128 v[156:159], v32 offset:4160
v_mfma_f32_16x16x32_bf16 v[104:107], v[76:79], v[160:163], v[104:107]
ds_read_b128 v[188:191], v32 offset:4448
v_mfma_f32_16x16x32_bf16 v[104:107], v[72:75], v[4:7], v[104:107]
ds_read_b128 v[252:255], v32 offset:4736
v_mfma_f32_16x16x32_bf16 v[104:107], v[68:71], v[220:223], v[104:107]
ds_read_b128 v[16:19], v32 offset:5024
v_mfma_f32_16x16x32_bf16 v[104:107], v[64:67], v[172:175], v[104:107]
buffer_load_dwordx4 v[168:171], v34, s[32:35], s69 offen offset:3072
v_mfma_f32_16x16x32_bf16 v[100:103], v[68:71], v[172:175], v[100:103]
s_add_u32 s69, s69, 4096
v_mfma_f32_16x16x32_bf16 v[100:103], v[72:75], v[220:223], v[100:103]
v_mfma_f32_16x16x32_bf16 v[100:103], v[76:79], v[4:7], v[100:103]
v_mfma_f32_16x16x32_bf16 v[100:103], v[84:87], v[160:163], v[100:103]
buffer_load_dwordx4 v[240:243], v34, s[32:35], s69 offen offset:0
s_waitcnt lgkmcnt(3)
v_mfma_f32_16x16x32_bf16 v[132:135], v[200:203], v[156:159], v[132:135]
s_waitcnt lgkmcnt(2)
v_mfma_f32_16x16x32_bf16 v[132:135], v[208:211], v[188:191], v[132:135]
s_waitcnt lgkmcnt(1)
v_mfma_f32_16x16x32_bf16 v[132:135], v[152:155], v[252:255], v[132:135]
s_waitcnt lgkmcnt(0)
v_mfma_f32_16x16x32_bf16 v[132:135], v[64:67], v[16:19], v[132:135]
buffer_load_dwordx4 v[96:99], v34, s[32:35], s69 offen offset:1024
v_mfma_f32_16x16x32_bf16 v[128:131], v[68:71], v[16:19], v[128:131]
v_mfma_f32_16x16x32_bf16 v[128:131], v[64:67], v[252:255], v[128:131]
v_mfma_f32_16x16x32_bf16 v[128:131], v[152:155], v[188:191], v[128:131]
v_mfma_f32_16x16x32_bf16 v[128:131], v[208:211], v[156:159], v[128:131]
buffer_load_dwordx4 v[248:251], v34, s[32:35], s69 offen offset:2048
v_mfma_f32_16x16x32_bf16 v[124:127], v[152:155], v[156:159], v[124:127]
v_mfma_f32_16x16x32_bf16 v[124:127], v[64:67], v[188:191], v[124:127]
v_mfma_f32_16x16x32_bf16 v[124:127], v[68:71], v[252:255], v[124:127]
v_mfma_f32_16x16x32_bf16 v[124:127], v[72:75], v[16:19], v[124:127]
buffer_load_dwordx4 v[24:27], v34, s[32:35], s69 offen offset:3072
v_mfma_f32_16x16x32_bf16 v[120:123], v[76:79], v[16:19], v[120:123]
s_add_u32 s69, s69, 4096
v_mfma_f32_16x16x32_bf16 v[120:123], v[72:75], v[252:255], v[120:123]
v_mfma_f32_16x16x32_bf16 v[120:123], v[68:71], v[188:191], v[120:123]
v_mfma_f32_16x16x32_bf16 v[120:123], v[64:67], v[156:159], v[120:123]
buffer_load_dwordx4 v[212:215], v34, s[32:35], s69 offen offset:0
v_mfma_f32_16x16x32_bf16 v[116:119], v[68:71], v[156:159], v[116:119]
v_mfma_f32_16x16x32_bf16 v[116:119], v[72:75], v[188:191], v[116:119]
v_mfma_f32_16x16x32_bf16 v[116:119], v[76:79], v[252:255], v[116:119]
v_mfma_f32_16x16x32_bf16 v[116:119], v[84:87], v[16:19], v[116:119]
ds_read_b128 v[20:23], v32 offset:480
v_mfma_f32_16x16x32_bf16 v[112:115], v[92:95], v[16:19], v[112:115]
buffer_load_dwordx4 v[8:11], v34, s[32:35], s69 offen offset:1024
v_mfma_f32_16x16x32_bf16 v[112:115], v[84:87], v[252:255], v[112:115]
v_mfma_f32_16x16x32_bf16 v[112:115], v[76:79], v[188:191], v[112:115]
v_mfma_f32_16x16x32_bf16 v[112:115], v[72:75], v[156:159], v[112:115]
v_mfma_f32_16x16x32_bf16 v[108:111], v[76:79], v[156:159], v[108:111]
buffer_load_dwordx4 v[56:59], v34, s[32:35], s69 offen offset:2048
v_mfma_f32_16x16x32_bf16 v[108:111], v[84:87], v[188:191], v[108:111]
ds_read_b128 v[244:247], v32 offset:192
v_mfma_f32_16x16x32_bf16 v[108:111], v[92:95], v[252:255], v[108:111]
v_mfma_f32_16x16x32_bf16 v[108:111], v[184:187], v[16:19], v[108:111]
ds_read_b128 v[204:207], v32 offset:5312
s_waitcnt lgkmcnt(2)
s_waitcnt vmcnt(12)
v_mfma_f32_16x16x32_bf16 v[104:107], v[148:151], v[20:23], v[104:107]
ds_read_b128 v[136:139], v32 offset:5600
v_mfma_f32_16x16x32_bf16 v[104:107], v[184:187], v[252:255], v[104:107]
ds_read_b128 v[196:199], v32 offset:5888
v_mfma_f32_16x16x32_bf16 v[104:107], v[92:95], v[188:191], v[104:107]
ds_read_b128 v[164:167], v32 offset:6176
v_mfma_f32_16x16x32_bf16 v[104:107], v[84:87], v[156:159], v[104:107]
buffer_load_dwordx4 v[48:51], v34, s[32:35], s69 offen offset:3072
v_mfma_f32_16x16x32_bf16 v[100:103], v[92:95], v[156:159], v[100:103]
s_add_u32 s69, s69, 4096
v_mfma_f32_16x16x32_bf16 v[100:103], v[184:187], v[188:191], v[100:103]
s_waitcnt lgkmcnt(4)
v_mfma_f32_16x16x32_bf16 v[100:103], v[148:151], v[244:247], v[100:103]
s_waitcnt vmcnt(12)
v_mfma_f32_16x16x32_bf16 v[100:103], v[140:143], v[20:23], v[100:103]
buffer_load_dwordx4 v[144:147], v34, s[32:35], s69 offen offset:0
s_waitcnt lgkmcnt(3)
v_mfma_f32_16x16x32_bf16 v[132:135], v[68:71], v[204:207], v[132:135]
s_waitcnt lgkmcnt(2)
v_mfma_f32_16x16x32_bf16 v[132:135], v[72:75], v[136:139], v[132:135]
s_waitcnt lgkmcnt(1)
v_mfma_f32_16x16x32_bf16 v[132:135], v[76:79], v[196:199], v[132:135]
s_waitcnt lgkmcnt(0)
v_mfma_f32_16x16x32_bf16 v[132:135], v[84:87], v[164:167], v[132:135]
ds_read_b128 v[52:55], v32 offset:1632
v_mfma_f32_16x16x32_bf16 v[128:131], v[92:95], v[164:167], v[128:131]
buffer_store_dword v43, v61, s[32:35], 0 offen sc1
v_mfma_f32_16x16x32_bf16 v[128:131], v[84:87], v[196:199], v[128:131]
buffer_load_dwordx4 v[192:195], v34, s[32:35], s69 offen offset:1024
v_mfma_f32_16x16x32_bf16 v[128:131], v[76:79], v[136:139], v[128:131]
v_mfma_f32_16x16x32_bf16 v[128:131], v[72:75], v[204:207], v[128:131]
v_mfma_f32_16x16x32_bf16 v[124:127], v[76:79], v[204:207], v[124:127]
v_mfma_f32_16x16x32_bf16 v[124:127], v[84:87], v[136:139], v[124:127]
ds_read_b128 v[12:15], v32 offset:1344
v_mfma_f32_16x16x32_bf16 v[124:127], v[92:95], v[196:199], v[124:127]
buffer_load_dwordx4 v[180:183], v34, s[32:35], s69 offen offset:2048
v_mfma_f32_16x16x32_bf16 v[124:127], v[184:187], v[164:167], v[124:127]
s_waitcnt lgkmcnt(1)
v_mfma_f32_16x16x32_bf16 v[120:123], v[148:151], v[52:55], v[120:123]
v_mfma_f32_16x16x32_bf16 v[120:123], v[184:187], v[196:199], v[120:123]
ds_read_b128 v[176:179], v32 offset:1056
v_mfma_f32_16x16x32_bf16 v[120:123], v[92:95], v[136:139], v[120:123]
buffer_load_dwordx4 v[172:175], v34, s[32:35], s69 offen offset:3072
v_mfma_f32_16x16x32_bf16 v[120:123], v[84:87], v[204:207], v[120:123]
s_add_u32 s69, s69, 4096
ds_read_b128 v[220:223], v32 offset:768
v_mfma_f32_16x16x32_bf16 v[116:119], v[92:95], v[204:207], v[116:119]
v_mfma_f32_16x16x32_bf16 v[116:119], v[184:187], v[136:139], v[116:119]
s_waitcnt lgkmcnt(2)
v_mfma_f32_16x16x32_bf16 v[116:119], v[148:151], v[12:15], v[116:119]
buffer_load_dwordx4 v[4:7], v34, s[32:35], s69 offen offset:0
v_mfma_f32_16x16x32_bf16 v[116:119], v[140:143], v[52:55], v[116:119]
s_waitcnt vmcnt(17)
v_mfma_f32_16x16x32_bf16 v[112:115], v[88:91], v[52:55], v[112:115]
v_mfma_f32_16x16x32_bf16 v[112:115], v[140:143], v[12:15], v[112:115]
s_waitcnt lgkmcnt(1)
v_mfma_f32_16x16x32_bf16 v[112:115], v[148:151], v[176:179], v[112:115]
buffer_load_dwordx4 v[160:163], v34, s[32:35], s69 offen offset:1024
v_mfma_f32_16x16x32_bf16 v[112:115], v[184:187], v[204:207], v[112:115]
s_waitcnt lgkmcnt(0)
v_mfma_f32_16x16x32_bf16 v[108:111], v[148:151], v[220:223], v[108:111]
v_mfma_f32_16x16x32_bf16 v[108:111], v[140:143], v[176:179], v[108:111]
v_mfma_f32_16x16x32_bf16 v[108:111], v[88:91], v[12:15], v[108:111]
buffer_load_dwordx4 v[200:203], v34, s[32:35], s69 offen offset:2048
s_waitcnt vmcnt(18)
v_mfma_f32_16x16x32_bf16 v[108:111], v[80:83], v[52:55], v[108:111]
ds_read_b128 v[208:211], v32 offset:6464
s_waitcnt vmcnt(17)
v_mfma_f32_16x16x32_bf16 v[104:107], v[216:219], v[52:55], v[104:107]
ds_read_b128 v[152:155], v32 offset:6752
v_mfma_f32_16x16x32_bf16 v[104:107], v[80:83], v[12:15], v[104:107]
ds_read_b128 v[64:67], v32 offset:2496
v_mfma_f32_16x16x32_bf16 v[104:107], v[88:91], v[176:179], v[104:107]
ds_read_b128 v[16:19], v32 offset:2784
v_mfma_f32_16x16x32_bf16 v[104:107], v[140:143], v[220:223], v[104:107]
buffer_load_dwordx4 v[252:255], v34, s[32:35], s69 offen offset:3072
v_mfma_f32_16x16x32_bf16 v[100:103], v[88:91], v[220:223], v[100:103]
s_add_u32 s69, s69, 4096
v_mfma_f32_16x16x32_bf16 v[100:103], v[80:83], v[176:179], v[100:103]
ds_read_b128 v[156:159], v32 offset:2208
v_mfma_f32_16x16x32_bf16 v[100:103], v[216:219], v[12:15], v[100:103]
s_waitcnt vmcnt(17)
v_mfma_f32_16x16x32_bf16 v[100:103], v[168:171], v[52:55], v[100:103]
ds_read_b128 v[188:191], v32 offset:1920
s_waitcnt lgkmcnt(5)
v_mfma_f32_16x16x32_bf16 v[132:135], v[92:95], v[208:211], v[132:135]
buffer_load_dwordx4 v[244:247], v34, s[32:35], s69 offen offset:0
s_waitcnt lgkmcnt(4)
v_mfma_f32_16x16x32_bf16 v[132:135], v[184:187], v[152:155], v[132:135]
s_waitcnt lgkmcnt(3)
v_mfma_f32_16x16x32_bf16 v[132:135], v[148:151], v[64:67], v[132:135]
s_waitcnt lgkmcnt(2)
v_mfma_f32_16x16x32_bf16 v[132:135], v[140:143], v[16:19], v[132:135]
v_mfma_f32_16x16x32_bf16 v[128:131], v[88:91], v[16:19], v[128:131]
buffer_load_dwordx4 v[20:23], v34, s[32:35], s69 offen offset:1024
v_mfma_f32_16x16x32_bf16 v[128:131], v[140:143], v[64:67], v[128:131]
s_waitcnt lgkmcnt(1)
v_mfma_f32_16x16x32_bf16 v[128:131], v[148:151], v[156:159], v[128:131]
v_mfma_f32_16x16x32_bf16 v[128:131], v[184:187], v[208:211], v[128:131]
s_waitcnt lgkmcnt(0)
v_mfma_f32_16x16x32_bf16 v[124:127], v[148:151], v[188:191], v[124:127]
v_mfma_f32_16x16x32_bf16 v[124:127], v[140:143], v[156:159], v[124:127]
v_mfma_f32_16x16x32_bf16 v[124:127], v[88:91], v[64:67], v[124:127]
v_mfma_f32_16x16x32_bf16 v[124:127], v[80:83], v[16:19], v[124:127]
v_mfma_f32_16x16x32_bf16 v[120:123], v[216:219], v[16:19], v[120:123]
v_mfma_f32_16x16x32_bf16 v[120:123], v[80:83], v[64:67], v[120:123]
v_mfma_f32_16x16x32_bf16 v[120:123], v[88:91], v[156:159], v[120:123]
ds_read_b128 v[68:71], v32 offset:3648
v_mfma_f32_16x16x32_bf16 v[120:123], v[140:143], v[188:191], v[120:123]
ds_read_b128 v[72:75], v32 offset:3936
v_mfma_f32_16x16x32_bf16 v[116:119], v[88:91], v[188:191], v[116:119]
ds_read_b128 v[76:79], v32 offset:4224
v_mfma_f32_16x16x32_bf16 v[116:119], v[80:83], v[156:159], v[116:119]
ds_read_b128 v[164:167], v32 offset:4512
v_mfma_f32_16x16x32_bf16 v[116:119], v[216:219], v[64:67], v[116:119]
ds_read_b128 v[196:199], v33 offset:0
v_mfma_f32_16x16x32_bf16 v[116:119], v[168:171], v[16:19], v[116:119]
ds_read_b128 v[84:87], v33 offset:288
s_waitcnt vmcnt(18)
v_mfma_f32_16x16x32_bf16 v[112:115], v[240:243], v[16:19], v[112:115]
ds_read_b128 v[136:139], v33 offset:576
v_mfma_f32_16x16x32_bf16 v[112:115], v[168:171], v[64:67], v[112:115]
ds_read_b128 v[204:207], v33 offset:864
v_mfma_f32_16x16x32_bf16 v[112:115], v[216:219], v[156:159], v[112:115]
ds_read_b128 v[220:223], v33 offset:1152
v_mfma_f32_16x16x32_bf16 v[112:115], v[80:83], v[188:191], v[112:115]
ds_read_b128 v[176:179], v33 offset:1440
v_mfma_f32_16x16x32_bf16 v[108:111], v[216:219], v[188:191], v[108:111]
ds_read_b128 v[12:15], v33 offset:1728
v_mfma_f32_16x16x32_bf16 v[108:111], v[168:171], v[156:159], v[108:111]
ds_read_b128 v[52:55], v33 offset:2016
v_mfma_f32_16x16x32_bf16 v[108:111], v[240:243], v[64:67], v[108:111]
s_waitcnt vmcnt(17)
v_mfma_f32_16x16x32_bf16 v[108:111], v[96:99], v[16:19], v[108:111]
ds_read_b128 v[92:95], v32 offset:3072
s_waitcnt vmcnt(16)
v_mfma_f32_16x16x32_bf16 v[104:107], v[248:251], v[16:19], v[104:107]
ds_read_b128 v[152:155], v32 offset:3360
v_mfma_f32_16x16x32_bf16 v[104:107], v[96:99], v[64:67], v[104:107]
v_mfma_f32_16x16x32_bf16 v[104:107], v[240:243], v[156:159], v[104:107]
v_mfma_f32_16x16x32_bf16 v[104:107], v[168:171], v[188:191], v[104:107]
v_mfma_f32_16x16x32_bf16 v[100:103], v[240:243], v[188:191], v[100:103]
v_mfma_f32_16x16x32_bf16 v[100:103], v[96:99], v[156:159], v[100:103]
v_mfma_f32_16x16x32_bf16 v[100:103], v[248:251], v[64:67], v[100:103]
s_waitcnt vmcnt(15)
v_mfma_f32_16x16x32_bf16 v[100:103], v[24:27], v[16:19], v[100:103]
s_waitcnt lgkmcnt(1)
v_mfma_f32_16x16x32_bf16 v[132:135], v[88:91], v[92:95], v[132:135]
s_waitcnt lgkmcnt(0)
v_mfma_f32_16x16x32_bf16 v[132:135], v[80:83], v[152:155], v[132:135]
v_mfma_f32_16x16x32_bf16 v[128:131], v[216:219], v[152:155], v[128:131]
v_mfma_f32_16x16x32_bf16 v[128:131], v[80:83], v[92:95], v[128:131]
v_mfma_f32_16x16x32_bf16 v[124:127], v[216:219], v[92:95], v[124:127]
v_mfma_f32_16x16x32_bf16 v[124:127], v[168:171], v[152:155], v[124:127]
v_mfma_f32_16x16x32_bf16 v[120:123], v[240:243], v[152:155], v[120:123]
v_mfma_f32_16x16x32_bf16 v[120:123], v[168:171], v[92:95], v[120:123]
v_mfma_f32_16x16x32_bf16 v[116:119], v[240:243], v[92:95], v[116:119]
v_mfma_f32_16x16x32_bf16 v[116:119], v[96:99], v[152:155], v[116:119]
v_mfma_f32_16x16x32_bf16 v[112:115], v[248:251], v[152:155], v[112:115]
v_mfma_f32_16x16x32_bf16 v[112:115], v[96:99], v[92:95], v[112:115]
v_mfma_f32_16x16x32_bf16 v[108:111], v[248:251], v[92:95], v[108:111]
v_mfma_f32_16x16x32_bf16 v[108:111], v[24:27], v[152:155], v[108:111]
s_waitcnt vmcnt(14)
v_mfma_f32_16x16x32_bf16 v[104:107], v[212:215], v[152:155], v[104:107]
v_mfma_f32_16x16x32_bf16 v[104:107], v[24:27], v[92:95], v[104:107]
v_mfma_f32_16x16x32_bf16 v[100:103], v[212:215], v[92:95], v[100:103]
s_waitcnt vmcnt(13)
v_mfma_f32_16x16x32_bf16 v[100:103], v[8:11], v[152:155], v[100:103]
s_waitcnt vmcnt(12)
v_mfma_f32_16x16x32_bf16 v[100:103], v[56:59], v[68:71], v[100:103]
s_waitcnt vmcnt(11)
v_mfma_f32_16x16x32_bf16 v[100:103], v[48:51], v[72:75], v[100:103]
s_waitcnt vmcnt(10)
v_mfma_f32_16x16x32_bf16 v[100:103], v[144:147], v[76:79], v[100:103]
s_waitcnt vmcnt(8)
v_mfma_f32_16x16x32_bf16 v[100:103], v[192:195], v[164:167], v[100:103]
s_waitcnt vmcnt(7)
v_mfma_f32_16x16x32_bf16 v[100:103], v[180:183], v[196:199], v[100:103]
s_waitcnt vmcnt(6)
v_mfma_f32_16x16x32_bf16 v[100:103], v[172:175], v[84:87], v[100:103]
s_waitcnt vmcnt(5)
v_mfma_f32_16x16x32_bf16 v[100:103], v[4:7], v[136:139], v[100:103]
s_waitcnt vmcnt(4)
v_mfma_f32_16x16x32_bf16 v[100:103], v[160:163], v[204:207], v[100:103]
s_waitcnt vmcnt(3)
v_mfma_f32_16x16x32_bf16 v[100:103], v[200:203], v[220:223], v[100:103]
s_waitcnt vmcnt(2)
v_mfma_f32_16x16x32_bf16 v[100:103], v[252:255], v[176:179], v[100:103]
s_waitcnt vmcnt(1)
v_mfma_f32_16x16x32_bf16 v[100:103], v[244:247], v[12:15], v[100:103]
ds_read_b128 v[184:187], v32 offset:4800
s_waitcnt vmcnt(0)
v_mfma_f32_16x16x32_bf16 v[100:103], v[20:23], v[52:55], v[100:103]
v_mfma_f32_16x16x32_bf16 v[104:107], v[8:11], v[68:71], v[104:107]
ds_read_b128 v[208:211], v33 offset:2304
v_mfma_f32_16x16x32_bf16 v[104:107], v[56:59], v[72:75], v[104:107]
v_mfma_f32_16x16x32_bf16 v[104:107], v[48:51], v[76:79], v[104:107]
v_mfma_f32_16x16x32_bf16 v[104:107], v[144:147], v[164:167], v[104:107]
s_waitcnt lgkmcnt(1)
v_mfma_f32_16x16x32_bf16 v[104:107], v[192:195], v[184:187], v[104:107]
v_mfma_f32_16x16x32_bf16 v[104:107], v[180:183], v[84:87], v[104:107]
v_mul_f32 v224, s90, v100
v_mul_f32 v225, s90, v101
v_mfma_f32_16x16x32_bf16 v[104:107], v[172:175], v[136:139], v[104:107]
v_mul_f32 v226, s92, v102
v_mul_f32 v227, s92, v103
v_mfma_f32_16x16x32_bf16 v[104:107], v[4:7], v[204:207], v[104:107]
v_min_f32 v224, s94, v224
v_min_f32 v225, s94, v225
v_mfma_f32_16x16x32_bf16 v[104:107], v[160:163], v[220:223], v[104:107]
v_exp_f32 v224, v224
v_mfma_f32_16x16x32_bf16 v[104:107], v[200:203], v[176:179], v[104:107]
v_exp_f32 v225, v225
v_mfma_f32_16x16x32_bf16 v[104:107], v[252:255], v[12:15], v[104:107]
v_exp_f32 v226, v226
v_mfma_f32_16x16x32_bf16 v[104:107], v[244:247], v[52:55], v[104:107]
v_exp_f32 v227, v227
s_waitcnt lgkmcnt(0)
v_mfma_f32_16x16x32_bf16 v[104:107], v[20:23], v[208:211], v[104:107]
ds_read_b128 v[148:151], v32 offset:5088
v_add_f32 v228, 1.0, v224
v_mfma_f32_16x16x32_bf16 v[108:111], v[212:215], v[68:71], v[108:111]
v_add_f32 v229, 1.0, v225
v_fma_f32 v228, v228, v226, v228
v_mfma_f32_16x16x32_bf16 v[108:111], v[8:11], v[72:75], v[108:111]
ds_read_b128 v[140:143], v33 offset:2592
v_fma_f32 v229, v229, v227, v229
v_mfma_f32_16x16x32_bf16 v[108:111], v[56:59], v[76:79], v[108:111]
v_rcp_f32 v228, v228
v_mfma_f32_16x16x32_bf16 v[108:111], v[48:51], v[164:167], v[108:111]
v_rcp_f32 v229, v229
v_mfma_f32_16x16x32_bf16 v[108:111], v[144:147], v[184:187], v[108:111]
v_add_f32 v230, -1.0, v224
v_add_f32 v231, -1.0, v225
s_waitcnt lgkmcnt(1)
v_mfma_f32_16x16x32_bf16 v[108:111], v[192:195], v[148:151], v[108:111]
v_mul_f32 v230, v230, v228
v_mul_f32 v231, v231, v229
v_mfma_f32_16x16x32_bf16 v[108:111], v[180:183], v[136:139], v[108:111]
v_cvt_pk_bf16_f32 v100, v230, v231
v_mfma_f32_16x16x32_bf16 v[108:111], v[172:175], v[204:207], v[108:111]
buffer_store_dword v100, v37, s[36:39], 0 offen offset:0
v_mfma_f32_16x16x32_bf16 v[108:111], v[4:7], v[220:223], v[108:111]
v_mul_f32 v232, s90, v104
v_mul_f32 v233, s90, v105
v_mfma_f32_16x16x32_bf16 v[108:111], v[160:163], v[176:179], v[108:111]
v_mul_f32 v234, s92, v106
v_mul_f32 v235, s92, v107
v_mfma_f32_16x16x32_bf16 v[108:111], v[200:203], v[12:15], v[108:111]
v_min_f32 v232, s94, v232
v_min_f32 v233, s94, v233
v_mfma_f32_16x16x32_bf16 v[108:111], v[252:255], v[52:55], v[108:111]
v_exp_f32 v232, v232
v_mfma_f32_16x16x32_bf16 v[108:111], v[244:247], v[208:211], v[108:111]
v_exp_f32 v233, v233
s_waitcnt lgkmcnt(0)
v_mfma_f32_16x16x32_bf16 v[108:111], v[20:23], v[140:143], v[108:111]
v_exp_f32 v234, v234
v_mfma_f32_16x16x32_bf16 v[112:115], v[24:27], v[68:71], v[112:115]
ds_read_b128 v[188:191], v32 offset:5376
v_mfma_f32_16x16x32_bf16 v[112:115], v[212:215], v[72:75], v[112:115]
v_exp_f32 v235, v235
v_mfma_f32_16x16x32_bf16 v[112:115], v[8:11], v[76:79], v[112:115]
ds_read_b128 v[156:159], v33 offset:2880
v_add_f32 v236, 1.0, v232
v_mfma_f32_16x16x32_bf16 v[112:115], v[56:59], v[164:167], v[112:115]
v_add_f32 v237, 1.0, v233
v_fma_f32 v236, v236, v234, v236
v_mfma_f32_16x16x32_bf16 v[112:115], v[48:51], v[184:187], v[112:115]
v_fma_f32 v237, v237, v235, v237
v_mfma_f32_16x16x32_bf16 v[112:115], v[144:147], v[148:151], v[112:115]
v_rcp_f32 v236, v236
s_waitcnt lgkmcnt(1)
v_mfma_f32_16x16x32_bf16 v[112:115], v[192:195], v[188:191], v[112:115]
v_rcp_f32 v237, v237
v_mfma_f32_16x16x32_bf16 v[112:115], v[180:183], v[204:207], v[112:115]
v_add_f32 v238, -1.0, v232
v_add_f32 v239, -1.0, v233
v_mfma_f32_16x16x32_bf16 v[112:115], v[172:175], v[220:223], v[112:115]
v_mul_f32 v238, v238, v236
v_mul_f32 v239, v239, v237
v_mfma_f32_16x16x32_bf16 v[112:115], v[4:7], v[176:179], v[112:115]
v_cvt_pk_bf16_f32 v104, v238, v239
v_mfma_f32_16x16x32_bf16 v[112:115], v[160:163], v[12:15], v[112:115]
buffer_store_dword v104, v37, s[36:39], 0 offen offset:1152
v_mfma_f32_16x16x32_bf16 v[112:115], v[200:203], v[52:55], v[112:115]
v_mul_f32 v224, s90, v108
v_mul_f32 v225, s90, v109
v_mfma_f32_16x16x32_bf16 v[112:115], v[252:255], v[208:211], v[112:115]
v_mul_f32 v226, s92, v110
v_mul_f32 v227, s92, v111
v_mfma_f32_16x16x32_bf16 v[112:115], v[244:247], v[140:143], v[112:115]
v_min_f32 v224, s94, v224
v_min_f32 v225, s94, v225
s_waitcnt lgkmcnt(0)
v_mfma_f32_16x16x32_bf16 v[112:115], v[20:23], v[156:159], v[112:115]
v_exp_f32 v224, v224
v_mfma_f32_16x16x32_bf16 v[116:119], v[248:251], v[68:71], v[116:119]
v_exp_f32 v225, v225
v_mfma_f32_16x16x32_bf16 v[116:119], v[24:27], v[72:75], v[116:119]
ds_read_b128 v[64:67], v32 offset:5664
v_mfma_f32_16x16x32_bf16 v[116:119], v[212:215], v[76:79], v[116:119]
v_exp_f32 v226, v226
v_mfma_f32_16x16x32_bf16 v[116:119], v[8:11], v[164:167], v[116:119]
ds_read_b128 v[16:19], v33 offset:3168
v_mfma_f32_16x16x32_bf16 v[116:119], v[56:59], v[184:187], v[116:119]
v_exp_f32 v227, v227
v_mfma_f32_16x16x32_bf16 v[116:119], v[48:51], v[148:151], v[116:119]
v_add_f32 v228, 1.0, v224
v_add_f32 v229, 1.0, v225
v_mfma_f32_16x16x32_bf16 v[116:119], v[144:147], v[188:191], v[116:119]
v_fma_f32 v228, v228, v226, v228
v_fma_f32 v229, v229, v227, v229
s_waitcnt lgkmcnt(1)
v_mfma_f32_16x16x32_bf16 v[116:119], v[192:195], v[64:67], v[116:119]
v_rcp_f32 v228, v228
v_mfma_f32_16x16x32_bf16 v[116:119], v[180:183], v[220:223], v[116:119]
v_rcp_f32 v229, v229
v_mfma_f32_16x16x32_bf16 v[116:119], v[172:175], v[176:179], v[116:119]
v_add_f32 v230, -1.0, v224
v_add_f32 v231, -1.0, v225
v_mfma_f32_16x16x32_bf16 v[116:119], v[4:7], v[12:15], v[116:119]
v_mul_f32 v230, v230, v228
v_mul_f32 v231, v231, v229
v_mfma_f32_16x16x32_bf16 v[116:119], v[160:163], v[52:55], v[116:119]
v_cvt_pk_bf16_f32 v108, v230, v231
v_mfma_f32_16x16x32_bf16 v[116:119], v[200:203], v[208:211], v[116:119]
buffer_store_dword v108, v37, s[36:39], 0 offen offset:2304
v_mfma_f32_16x16x32_bf16 v[116:119], v[252:255], v[140:143], v[116:119]
v_mul_f32 v232, s90, v112
v_mul_f32 v233, s90, v113
v_mfma_f32_16x16x32_bf16 v[116:119], v[244:247], v[156:159], v[116:119]
v_mul_f32 v234, s92, v114
v_mul_f32 v235, s92, v115
s_waitcnt lgkmcnt(0)
v_mfma_f32_16x16x32_bf16 v[116:119], v[20:23], v[16:19], v[116:119]
v_min_f32 v232, s94, v232
v_min_f32 v233, s94, v233
v_mfma_f32_16x16x32_bf16 v[120:123], v[96:99], v[68:71], v[120:123]
v_exp_f32 v232, v232
v_mfma_f32_16x16x32_bf16 v[120:123], v[248:251], v[72:75], v[120:123]
v_exp_f32 v233, v233
v_mfma_f32_16x16x32_bf16 v[120:123], v[24:27], v[76:79], v[120:123]
ds_read_b128 v[88:91], v32 offset:5952
v_mfma_f32_16x16x32_bf16 v[120:123], v[212:215], v[164:167], v[120:123]
v_exp_f32 v234, v234
v_mfma_f32_16x16x32_bf16 v[120:123], v[8:11], v[184:187], v[120:123]
ds_read_b128 v[80:83], v33 offset:3456
v_mfma_f32_16x16x32_bf16 v[120:123], v[56:59], v[148:151], v[120:123]
v_exp_f32 v235, v235
v_mfma_f32_16x16x32_bf16 v[120:123], v[48:51], v[188:191], v[120:123]
v_add_f32 v236, 1.0, v232
v_add_f32 v237, 1.0, v233
v_mfma_f32_16x16x32_bf16 v[120:123], v[144:147], v[64:67], v[120:123]
v_fma_f32 v236, v236, v234, v236
v_fma_f32 v237, v237, v235, v237
s_waitcnt lgkmcnt(1)
v_mfma_f32_16x16x32_bf16 v[120:123], v[192:195], v[88:91], v[120:123]
v_rcp_f32 v236, v236
v_mfma_f32_16x16x32_bf16 v[120:123], v[180:183], v[176:179], v[120:123]
v_rcp_f32 v237, v237
v_mfma_f32_16x16x32_bf16 v[120:123], v[172:175], v[12:15], v[120:123]
v_add_f32 v238, -1.0, v232
v_add_f32 v239, -1.0, v233
v_mfma_f32_16x16x32_bf16 v[120:123], v[4:7], v[52:55], v[120:123]
v_mul_f32 v238, v238, v236
v_mul_f32 v239, v239, v237
v_mfma_f32_16x16x32_bf16 v[120:123], v[160:163], v[208:211], v[120:123]
v_cvt_pk_bf16_f32 v112, v238, v239
v_mfma_f32_16x16x32_bf16 v[120:123], v[200:203], v[140:143], v[120:123]
buffer_store_dword v112, v38, s[36:39], 0 offen offset:0
v_mfma_f32_16x16x32_bf16 v[120:123], v[252:255], v[156:159], v[120:123]
v_mul_f32 v224, s90, v116
v_mul_f32 v225, s90, v117
v_mfma_f32_16x16x32_bf16 v[120:123], v[244:247], v[16:19], v[120:123]
v_mul_f32 v226, s92, v118
v_mul_f32 v227, s92, v119
s_waitcnt lgkmcnt(0)
v_mfma_f32_16x16x32_bf16 v[120:123], v[20:23], v[80:83], v[120:123]
v_min_f32 v224, s94, v224
v_min_f32 v225, s94, v225
v_mfma_f32_16x16x32_bf16 v[124:127], v[240:243], v[68:71], v[124:127]
v_exp_f32 v224, v224
v_mfma_f32_16x16x32_bf16 v[124:127], v[96:99], v[72:75], v[124:127]
v_exp_f32 v225, v225
v_mfma_f32_16x16x32_bf16 v[124:127], v[248:251], v[76:79], v[124:127]
v_exp_f32 v226, v226
v_mfma_f32_16x16x32_bf16 v[124:127], v[24:27], v[164:167], v[124:127]
ds_read_b128 v[92:95], v32 offset:6240
v_mfma_f32_16x16x32_bf16 v[124:127], v[212:215], v[184:187], v[124:127]
v_exp_f32 v227, v227
v_mfma_f32_16x16x32_bf16 v[124:127], v[8:11], v[148:151], v[124:127]
ds_read_b128 v[152:155], v33 offset:3744
v_add_f32 v228, 1.0, v224
v_mfma_f32_16x16x32_bf16 v[124:127], v[56:59], v[188:191], v[124:127]
v_add_f32 v229, 1.0, v225
v_fma_f32 v228, v228, v226, v228
v_mfma_f32_16x16x32_bf16 v[124:127], v[48:51], v[64:67], v[124:127]
v_fma_f32 v229, v229, v227, v229
v_mfma_f32_16x16x32_bf16 v[124:127], v[144:147], v[88:91], v[124:127]
v_rcp_f32 v228, v228
s_waitcnt lgkmcnt(1)
v_mfma_f32_16x16x32_bf16 v[124:127], v[192:195], v[92:95], v[124:127]
v_rcp_f32 v229, v229
v_mfma_f32_16x16x32_bf16 v[124:127], v[180:183], v[12:15], v[124:127]
v_add_f32 v230, -1.0, v224
v_add_f32 v231, -1.0, v225
v_mfma_f32_16x16x32_bf16 v[124:127], v[172:175], v[52:55], v[124:127]
v_mul_f32 v230, v230, v228
v_mul_f32 v231, v231, v229
v_mfma_f32_16x16x32_bf16 v[124:127], v[4:7], v[208:211], v[124:127]
v_cvt_pk_bf16_f32 v116, v230, v231
v_mfma_f32_16x16x32_bf16 v[124:127], v[160:163], v[140:143], v[124:127]
buffer_store_dword v116, v38, s[36:39], 0 offen offset:1152
v_mfma_f32_16x16x32_bf16 v[124:127], v[200:203], v[156:159], v[124:127]
v_mul_f32 v232, s90, v120
v_mul_f32 v233, s90, v121
v_mfma_f32_16x16x32_bf16 v[124:127], v[252:255], v[16:19], v[124:127]
v_mul_f32 v234, s92, v122
v_mul_f32 v235, s92, v123
v_mfma_f32_16x16x32_bf16 v[124:127], v[244:247], v[80:83], v[124:127]
v_min_f32 v232, s94, v232
v_min_f32 v233, s94, v233
s_waitcnt lgkmcnt(0)
v_mfma_f32_16x16x32_bf16 v[124:127], v[20:23], v[152:155], v[124:127]
v_exp_f32 v232, v232
v_mfma_f32_16x16x32_bf16 v[128:131], v[168:171], v[68:71], v[128:131]
v_exp_f32 v233, v233
v_mfma_f32_16x16x32_bf16 v[128:131], v[240:243], v[72:75], v[128:131]
v_exp_f32 v234, v234
v_mfma_f32_16x16x32_bf16 v[128:131], v[96:99], v[76:79], v[128:131]
v_exp_f32 v235, v235
v_mfma_f32_16x16x32_bf16 v[128:131], v[248:251], v[164:167], v[128:131]
v_add_f32 v236, 1.0, v232
v_add_f32 v237, 1.0, v233
v_mfma_f32_16x16x32_bf16 v[128:131], v[24:27], v[184:187], v[128:131]
ds_read_b128 v[196:199], v32 offset:6528
v_fma_f32 v236, v236, v234, v236
v_mfma_f32_16x16x32_bf16 v[128:131], v[212:215], v[148:151], v[128:131]
v_fma_f32 v237, v237, v235, v237
v_mfma_f32_16x16x32_bf16 v[128:131], v[8:11], v[188:191], v[128:131]
ds_read_b128 v[84:87], v33 offset:4032
v_mfma_f32_16x16x32_bf16 v[128:131], v[56:59], v[64:67], v[128:131]
v_rcp_f32 v236, v236
v_mfma_f32_16x16x32_bf16 v[128:131], v[48:51], v[88:91], v[128:131]
v_rcp_f32 v237, v237
v_mfma_f32_16x16x32_bf16 v[128:131], v[144:147], v[92:95], v[128:131]
v_add_f32 v238, -1.0, v232
v_add_f32 v239, -1.0, v233
s_waitcnt lgkmcnt(1)
v_mfma_f32_16x16x32_bf16 v[128:131], v[192:195], v[196:199], v[128:131]
v_mul_f32 v238, v238, v236
v_mul_f32 v239, v239, v237
v_mfma_f32_16x16x32_bf16 v[128:131], v[180:183], v[52:55], v[128:131]
v_cvt_pk_bf16_f32 v120, v238, v239
v_mfma_f32_16x16x32_bf16 v[128:131], v[172:175], v[208:211], v[128:131]
buffer_store_dword v120, v38, s[36:39], 0 offen offset:2304
v_mfma_f32_16x16x32_bf16 v[128:131], v[4:7], v[140:143], v[128:131]
v_mul_f32 v224, s90, v124
v_mul_f32 v225, s90, v125
v_mfma_f32_16x16x32_bf16 v[128:131], v[160:163], v[156:159], v[128:131]
v_mul_f32 v226, s92, v126
v_mul_f32 v227, s92, v127
v_mfma_f32_16x16x32_bf16 v[128:131], v[200:203], v[16:19], v[128:131]
v_min_f32 v224, s94, v224
v_min_f32 v225, s94, v225
v_mfma_f32_16x16x32_bf16 v[128:131], v[252:255], v[80:83], v[128:131]
v_exp_f32 v224, v224
v_mfma_f32_16x16x32_bf16 v[128:131], v[244:247], v[152:155], v[128:131]
v_exp_f32 v225, v225
s_waitcnt lgkmcnt(0)
v_mfma_f32_16x16x32_bf16 v[128:131], v[20:23], v[84:87], v[128:131]
v_exp_f32 v226, v226
v_mfma_f32_16x16x32_bf16 v[132:135], v[216:219], v[68:71], v[132:135]
v_exp_f32 v227, v227
v_mfma_f32_16x16x32_bf16 v[132:135], v[168:171], v[72:75], v[132:135]
v_add_f32 v228, 1.0, v224
v_add_f32 v229, 1.0, v225
v_mfma_f32_16x16x32_bf16 v[132:135], v[240:243], v[76:79], v[132:135]
v_fma_f32 v228, v228, v226, v228
v_fma_f32 v229, v229, v227, v229
v_mfma_f32_16x16x32_bf16 v[132:135], v[96:99], v[164:167], v[132:135]
v_rcp_f32 v228, v228
v_mfma_f32_16x16x32_bf16 v[132:135], v[248:251], v[184:187], v[132:135]
v_rcp_f32 v229, v229
v_mfma_f32_16x16x32_bf16 v[132:135], v[24:27], v[148:151], v[132:135]
ds_read_b128 v[136:139], v32 offset:6816
v_add_f32 v230, -1.0, v224
v_mfma_f32_16x16x32_bf16 v[132:135], v[212:215], v[188:191], v[132:135]
v_add_f32 v231, -1.0, v225
v_mul_f32 v230, v230, v228
v_mfma_f32_16x16x32_bf16 v[132:135], v[8:11], v[64:67], v[132:135]
ds_read_b128 v[100:103], v33 offset:4320
v_mul_f32 v231, v231, v229
v_mfma_f32_16x16x32_bf16 v[132:135], v[56:59], v[88:91], v[132:135]
v_cvt_pk_bf16_f32 v124, v230, v231
v_mfma_f32_16x16x32_bf16 v[132:135], v[48:51], v[92:95], v[132:135]
buffer_store_dword v124, v39, s[36:39], 0 offen offset:0
v_mfma_f32_16x16x32_bf16 v[132:135], v[144:147], v[196:199], v[132:135]
v_mul_f32 v232, s90, v128
v_mul_f32 v233, s90, v129
s_waitcnt lgkmcnt(1)
v_mfma_f32_16x16x32_bf16 v[132:135], v[192:195], v[136:139], v[132:135]
v_mul_f32 v234, s92, v130
v_mul_f32 v235, s92, v131
v_mfma_f32_16x16x32_bf16 v[132:135], v[180:183], v[208:211], v[132:135]
v_min_f32 v232, s94, v232
v_min_f32 v233, s94, v233
v_mfma_f32_16x16x32_bf16 v[132:135], v[172:175], v[140:143], v[132:135]
v_exp_f32 v232, v232
v_mfma_f32_16x16x32_bf16 v[132:135], v[4:7], v[156:159], v[132:135]
v_exp_f32 v233, v233
v_mfma_f32_16x16x32_bf16 v[132:135], v[160:163], v[16:19], v[132:135]
v_exp_f32 v234, v234
v_mfma_f32_16x16x32_bf16 v[132:135], v[200:203], v[80:83], v[132:135]
v_exp_f32 v235, v235
v_mfma_f32_16x16x32_bf16 v[132:135], v[252:255], v[152:155], v[132:135]
v_add_f32 v236, 1.0, v232
v_add_f32 v237, 1.0, v233
v_mfma_f32_16x16x32_bf16 v[132:135], v[244:247], v[84:87], v[132:135]
v_fma_f32 v236, v236, v234, v236
v_fma_f32 v237, v237, v235, v237
s_waitcnt lgkmcnt(0)
v_mfma_f32_16x16x32_bf16 v[132:135], v[20:23], v[100:103], v[132:135]
v_rcp_f32 v236, v236
v_rcp_f32 v237, v237
v_add_f32 v238, -1.0, v232
v_add_f32 v239, -1.0, v233
v_mul_f32 v238, v238, v236
v_mul_f32 v239, v239, v237
v_cvt_pk_bf16_f32 v128, v238, v239
buffer_store_dword v128, v39, s[36:39], 0 offen offset:1152
v_pk_mul_f32 v[224:225], v[132:133], s[90:91]
v_pk_mul_f32 v[226:227], v[134:135], s[92:93]
v_min_f32 v224, s94, v224
v_min_f32 v225, s94, v225
v_exp_f32 v224, v224
v_exp_f32 v225, v225
v_exp_f32 v226, v226
v_exp_f32 v227, v227
v_pk_add_f32 v[228:229], v[224:225], 1.0 op_sel_hi:[1,0]
v_pk_add_f32 v[230:231], v[224:225], -1.0 op_sel_hi:[1,0]
v_pk_fma_f32 v[228:229], v[228:229], v[226:227], v[228:229]
v_rcp_f32 v228, v228
v_rcp_f32 v229, v229
s_nop 0
v_pk_mul_f32 v[230:231], v[230:231], v[228:229]
v_cvt_pk_bf16_f32 v132, v230, v231
buffer_store_dword v132, v39, s[36:39], 0 offen offset:2304
s_endpgm
L_slow0D:
ds_read_b32 v28, v41 offset:16
s_waitcnt lgkmcnt(0)
v_cmp_ne_u32 vcc, 4, v28
s_nop 4
s_cbranch_vccnz L_slow0D
s_branch L_back0D
L_slow0R:
ds_read_b32 v28, v41 offset:20
s_waitcnt lgkmcnt(0)
v_cmp_ne_u32 vcc, 4, v28
s_nop 4
s_cbranch_vccnz L_slow0R
s_branch L_back0R
L_slow0P:
ds_read_b32 v28, v45 offset:24
s_waitcnt lgkmcnt(0)
v_cmp_ne_u32 vcc, 2, v28
s_nop 4
s_cbranch_vccnz L_slow0P
s_branch L_back0P
L_fw00:
buffer_load_dword v44, v40, s[32:35], s97 offen sc1
ds_read_b32 v47, v41 offset:12
s_add_u32 s61, s61, 1
s_waitcnt vmcnt(0) lgkmcnt(0)
v_cmp_ne_u32 vcc, v43, v44
v_readfirstlane_b32 s46, v47
s_nop 3
s_cbranch_vccz L_fb00
s_cmp_lg_u32 s46, 0
s_cbranch_scc1 L_fb00
s_cmp_lg_u32 s61, 3000
s_cbranch_scc1 L_fw00
v_mov_b32 v47, 0x10000
s_mov_b64 exec, 1
ds_add_u32 v41, v47 offset:4
s_mov_b64 exec, -1
s_branch L_fw00
L_fw01:
buffer_load_dword v44, v40, s[32:35], s97 offen sc1
ds_read_b32 v47, v41 offset:12
s_add_u32 s61, s61, 1
s_waitcnt vmcnt(0) lgkmcnt(0)
v_cmp_ne_u32 vcc, v43, v44
v_readfirstlane_b32 s46, v47
s_nop 3
s_cbranch_vccz L_fb01
s_cmp_lg_u32 s46, 0
s_cbranch_scc1 L_fb01
s_cmp_lg_u32 s61, 3000
s_cbranch_scc1 L_fw01
v_mov_b32 v47, 0x10000
s_mov_b64 exec, 1
ds_add_u32 v41, v47 offset:4
s_mov_b64 exec, -1
s_branch L_fw01
L_fw02:
buffer_load_dword v44, v40, s[32:35], s97 offen sc1
ds_read_b32 v47, v41 offset:12
s_add_u32 s61, s61, 1
s_waitcnt vmcnt(0) lgkmcnt(0)
v_cmp_ne_u32 vcc, v43, v44
v_readfirstlane_b32 s46, v47
s_nop 3
s_cbranch_vccz L_fb02
s_cmp_lg_u32 s46, 0
s_cbranch_scc1 L_fb02
s_cmp_lg_u32 s61, 3000
s_cbranch_scc1 L_fw02
v_mov_b32 v47, 0x10000
s_mov_b64 exec, 1
ds_add_u32 v41, v47 offset:4
s_mov_b64 exec, -1
s_branch L_fw02
L_fw03:
buffer_load_dword v44, v40, s[32:35], s97 offen sc1
ds_read_b32 v47, v41 offset:12
s_add_u32 s61, s61, 1
s_waitcnt vmcnt(0) lgkmcnt(0)
v_cmp_ne_u32 vcc, v43, v44
v_readfirstlane_b32 s46, v47
s_nop 3
s_cbranch_vccz L_fb03
s_cmp_lg_u32 s46, 0
s_cbranch_scc1 L_fb03
s_cmp_lg_u32 s61, 3000
s_cbranch_scc1 L_fw03
v_mov_b32 v47, 0x10000
s_mov_b64 exec, 1
ds_add_u32 v41, v47 offset:4
s_mov_b64 exec, -1
s_branch L_fw03
L_fw04:
buffer_load_dword v44, v40, s[32:35], s97 offen sc1
ds_read_b32 v47, v41 offset:12
s_add_u32 s61, s61, 1
s_waitcnt vmcnt(0) lgkmcnt(0)
v_cmp_ne_u32 vcc, v43, v44
v_readfirstlane_b32 s46, v47
s_nop 3
s_cbranch_vccz L_fb04
s_cmp_lg_u32 s46, 0
s_cbranch_scc1 L_fb04
s_cmp_lg_u32 s61, 3000
s_cbranch_scc1 L_fw04
v_mov_b32 v47, 0x10000
s_mov_b64 exec, 1
ds_add_u32 v41, v47 offset:4
s_mov_b64 exec, -1
s_branch L_fw04
L_fw05:
buffer_load_dword v44, v46, s[32:35], s97 offen sc1
ds_read_b32 v47, v41 offset:12
s_add_u32 s61, s61, 1
s_waitcnt vmcnt(0) lgkmcnt(0)
v_cmp_ne_u32 vcc, v43, v44
v_readfirstlane_b32 s46, v47
s_nop 3
s_cbranch_vccz L_fb05
s_cmp_lg_u32 s46, 0
s_cbranch_scc1 L_fb05
s_cmp_lg_u32 s61, 3000
s_cbranch_scc1 L_fw05
v_mov_b32 v47, 0x10000
s_mov_b64 exec, 1
ds_add_u32 v41, v47 offset:4
s_mov_b64 exec, -1
s_branch L_fw05
L_ks00:
ds_read_b32 v47, v41 offset:12
s_add_u32 s47, s96, 0
s_waitcnt lgkmcnt(0)
buffer_load_dwordx4 v[100:103], v34, s[32:35], s47 offen offset:0 sc1
buffer_load_dwordx4 v[104:107], v34, s[32:35], s47 offen offset:1024 sc1
buffer_load_dwordx4 v[116:119], v34, s[32:35], s47 offen offset:2048 sc1
buffer_load_dwordx4 v[120:123], v34, s[32:35], s47 offen offset:3072 sc1
v_readfirstlane_b32 s46, v47
s_add_u32 s61, s61, 1
s_waitcnt vmcnt(0)
s_cmp_lg_u32 s46, 0
s_cbranch_scc1 L_kb00
v_bitop3_b32 v28, v101, v106, v43 bitop3:0x7e
v_bitop3_b32 v29, v117, v122, v43 bitop3:0x7e
v_or_b32 v28, v28, v29
v_cmp_ne_u32 s[48:49], 0, v28
s_nop 2
s_cmp_eq_u64 s[48:49], 0
s_cbranch_scc1 L_kb00
s_cmp_lg_u32 s61, 3000
s_cbranch_scc1 L_ks00
v_mov_b32 v47, 0x10000
s_mov_b64 exec, 1
ds_add_u32 v41, v47 offset:4
s_mov_b64 exec, -1
s_branch L_ks00
L_ks02:
ds_read_b32 v47, v41 offset:12
s_add_u32 s47, s96, 4096
s_waitcnt lgkmcnt(0)
buffer_load_dwordx4 v[108:111], v34, s[32:35], s47 offen offset:0 sc1
buffer_load_dwordx4 v[112:115], v34, s[32:35], s47 offen offset:1024 sc1
buffer_load_dwordx4 v[124:127], v34, s[32:35], s47 offen offset:2048 sc1
buffer_load_dwordx4 v[128:131], v34, s[32:35], s47 offen offset:3072 sc1
v_readfirstlane_b32 s46, v47
s_add_u32 s61, s61, 1
s_waitcnt vmcnt(0)
s_cmp_lg_u32 s46, 0
s_cbranch_scc1 L_kb02
v_bitop3_b32 v28, v109, v114, v43 bitop3:0x7e
v_bitop3_b32 v29, v125, v130, v43 bitop3:0x7e
v_or_b32 v28, v28, v29
v_cmp_ne_u32 s[48:49], 0, v28
s_nop 2
s_cmp_eq_u64 s[48:49], 0
s_cbranch_scc1 L_kb02
s_cmp_lg_u32 s61, 3000
s_cbranch_scc1 L_ks02
v_mov_b32 v47, 0x10000
s_mov_b64 exec, 1
ds_add_u32 v41, v47 offset:4
s_mov_b64 exec, -1
s_branch L_ks02
L_ks04:
ds_read_b32 v47, v41 offset:12
s_add_u32 s47, s96, 8192
s_waitcnt lgkmcnt(0)
buffer_load_dwordx4 v[4:7], v34, s[32:35], s47 offen offset:0 sc1
buffer_load_dwordx4 v[8:11], v34, s[32:35], s47 offen offset:1024 sc1
buffer_load_dwordx4 v[12:15], v34, s[32:35], s47 offen offset:2048 sc1
buffer_load_dwordx4 v[16:19], v34, s[32:35], s47 offen offset:3072 sc1
v_readfirstlane_b32 s46, v47
s_add_u32 s61, s61, 1
s_waitcnt vmcnt(0)
s_cmp_lg_u32 s46, 0
s_cbranch_scc1 L_kb04
v_bitop3_b32 v28, v5, v10, v43 bitop3:0x7e
v_bitop3_b32 v29, v13, v18, v43 bitop3:0x7e
v_or_b32 v28, v28, v29
v_cmp_ne_u32 s[48:49], 0, v28
s_nop 2
s_cmp_eq_u64 s[48:49], 0
s_cbranch_scc1 L_kb04
s_cmp_lg_u32 s61, 3000
s_cbranch_scc1 L_ks04
v_mov_b32 v47, 0x10000
s_mov_b64 exec, 1
ds_add_u32 v41, v47 offset:4
s_mov_b64 exec, -1
s_branch L_ks04
L_ks06:
ds_read_b32 v47, v41 offset:12
s_add_u32 s47, s96, 12288
s_waitcnt lgkmcnt(0)
buffer_load_dwordx4 v[20:23], v34, s[32:35], s47 offen offset:0 sc1
buffer_load_dwordx4 v[24:27], v34, s[32:35], s47 offen offset:1024 sc1
buffer_load_dwordx4 v[48:51], v34, s[32:35], s47 offen offset:2048 sc1
buffer_load_dwordx4 v[52:55], v34, s[32:35], s47 offen offset:3072 sc1
v_readfirstlane_b32 s46, v47
s_add_u32 s61, s61, 1
s_waitcnt vmcnt(0)
s_cmp_lg_u32 s46, 0
s_cbranch_scc1 L_kb06
v_bitop3_b32 v28, v21, v26, v43 bitop3:0x7e
v_bitop3_b32 v29, v49, v54, v43 bitop3:0x7e
v_or_b32 v28, v28, v29
v_cmp_ne_u32 s[48:49], 0, v28
s_nop 2
s_cmp_eq_u64 s[48:49], 0
s_cbranch_scc1 L_kb06
s_cmp_lg_u32 s61, 3000
s_cbranch_scc1 L_ks06
v_mov_b32 v47, 0x10000
s_mov_b64 exec, 1
ds_add_u32 v41, v47 offset:4
s_mov_b64 exec, -1
s_branch L_ks06
L_ks08:
ds_read_b32 v47, v41 offset:12
s_add_u32 s47, s96, 16384
s_waitcnt lgkmcnt(0)
buffer_load_dwordx4 v[108:111], v34, s[32:35], s47 offen offset:0 sc1
buffer_load_dwordx4 v[112:115], v34, s[32:35], s47 offen offset:1024 sc1
buffer_load_dwordx4 v[124:127], v34, s[32:35], s47 offen offset:2048 sc1
buffer_load_dwordx4 v[128:131], v34, s[32:35], s47 offen offset:3072 sc1
v_readfirstlane_b32 s46, v47
s_add_u32 s61, s61, 1
s_waitcnt vmcnt(0)
s_cmp_lg_u32 s46, 0
s_cbranch_scc1 L_kb08
v_bitop3_b32 v28, v109, v114, v43 bitop3:0x7e
v_bitop3_b32 v29, v125, v130, v43 bitop3:0x7e
v_or_b32 v28, v28, v29
v_cmp_ne_u32 s[48:49], 0, v28
s_nop 2
s_cmp_eq_u64 s[48:49], 0
s_cbranch_scc1 L_kb08
s_cmp_lg_u32 s61, 3000
s_cbranch_scc1 L_ks08
v_mov_b32 v47, 0x10000
s_mov_b64 exec, 1
ds_add_u32 v41, v47 offset:4
s_mov_b64 exec, -1
s_branch L_ks08
L_ks010:
ds_read_b32 v47, v41 offset:12
s_add_u32 s47, s96, 20480
s_waitcnt lgkmcnt(0)
buffer_load_dwordx4 v[168:171], v34, s[32:35], s47 offen offset:0 sc1
buffer_load_dwordx4 v[172:175], v34, s[32:35], s47 offen offset:1024 sc1
buffer_load_dwordx4 v[184:187], v34, s[32:35], s47 offen offset:2048 sc1
buffer_load_dwordx4 v[188:191], v34, s[32:35], s47 offen offset:3072 sc1
v_readfirstlane_b32 s46, v47
s_add_u32 s61, s61, 1
s_waitcnt vmcnt(0)
s_cmp_lg_u32 s46, 0
s_cbranch_scc1 L_kb010
v_bitop3_b32 v28, v169, v174, v43 bitop3:0x7e
v_bitop3_b32 v29, v185, v190, v43 bitop3:0x7e
v_or_b32 v28, v28, v29
v_cmp_ne_u32 s[48:49], 0, v28
s_nop 2
s_cmp_eq_u64 s[48:49], 0
s_cbranch_scc1 L_kb010
s_cmp_lg_u32 s61, 3000
s_cbranch_scc1 L_ks010
v_mov_b32 v47, 0x10000
s_mov_b64 exec, 1
ds_add_u32 v41, v47 offset:4
s_mov_b64 exec, -1
s_branch L_ks010
L_ks012:
ds_read_b32 v47, v41 offset:12
s_add_u32 s47, s96, 24576
s_waitcnt lgkmcnt(0)
buffer_load_dwordx4 v[192:195], v34, s[32:35], s47 offen offset:0 sc1
buffer_load_dwordx4 v[196:199], v34, s[32:35], s47 offen offset:1024 sc1
buffer_load_dwordx4 v[200:203], v34, s[32:35], s47 offen offset:2048 sc1
buffer_load_dwordx4 v[204:207], v34, s[32:35], s47 offen offset:3072 sc1
v_readfirstlane_b32 s46, v47
s_add_u32 s61, s61, 1
s_waitcnt vmcnt(0)
s_cmp_lg_u32 s46, 0
s_cbranch_scc1 L_kb012
v_bitop3_b32 v28, v193, v198, v43 bitop3:0x7e
v_bitop3_b32 v29, v201, v206, v43 bitop3:0x7e
v_or_b32 v28, v28, v29
v_cmp_ne_u32 s[48:49], 0, v28
s_nop 2
s_cmp_eq_u64 s[48:49], 0
s_cbranch_scc1 L_kb012
s_cmp_lg_u32 s61, 3000
s_cbranch_scc1 L_ks012
v_mov_b32 v47, 0x10000
s_mov_b64 exec, 1
ds_add_u32 v41, v47 offset:4
s_mov_b64 exec, -1
s_branch L_ks012
L_ks014:
ds_read_b32 v47, v41 offset:12
s_add_u32 s47, s96, 28672
s_waitcnt lgkmcnt(0)
buffer_load_dwordx4 v[208:211], v34, s[32:35], s47 offen offset:0 sc1
buffer_load_dwordx4 v[212:215], v34, s[32:35], s47 offen offset:1024 sc1
buffer_load_dwordx4 v[124:127], v34, s[32:35], s47 offen offset:2048 sc1
buffer_load_dwordx4 v[128:131], v34, s[32:35], s47 offen offset:3072 sc1
v_readfirstlane_b32 s46, v47
s_add_u32 s61, s61, 1
s_waitcnt vmcnt(0)
s_cmp_lg_u32 s46, 0
s_cbranch_scc1 L_kb014
v_bitop3_b32 v28, v209, v214, v43 bitop3:0x7e
v_bitop3_b32 v29, v125, v130, v43 bitop3:0x7e
v_or_b32 v28, v28, v29
v_cmp_ne_u32 s[48:49], 0, v28
s_nop 2
s_cmp_eq_u64 s[48:49], 0
s_cbranch_scc1 L_kb014
s_cmp_lg_u32 s61, 3000
s_cbranch_scc1 L_ks014
v_mov_b32 v47, 0x10000
s_mov_b64 exec, 1
ds_add_u32 v41, v47 offset:4
s_mov_b64 exec, -1
s_branch L_ks014
.p2align 6
L_warmB:
s_branch L_warmret
L_typeB:
buffer_load_dwordx4 v[100:103], v34, s[32:35], s50 offen offset:0
buffer_load_dwordx4 v[104:107], v34, s[32:35], s50 offen offset:1024
buffer_load_dwordx4 v[116:119], v34, s[32:35], s50 offen offset:2048
buffer_load_dwordx4 v[120:123], v34, s[32:35], s50 offen offset:3072
s_add_u32 s50, s50, 4096
buffer_load_dwordx4 v[108:111], v34, s[32:35], s50 offen offset:0
buffer_load_dwordx4 v[112:115], v34, s[32:35], s50 offen offset:1024
buffer_load_dwordx4 v[124:127], v34, s[32:35], s50 offen offset:2048
buffer_load_dwordx4 v[128:131], v34, s[32:35], s50 offen offset:3072
s_add_u32 s50, s50, 4096
ds_read_b128 v[132:135], v30 offset:128
ds_read_b128 v[136:139], v30 offset:416
ds_read_b128 v[140:143], v30 offset:704
ds_read_b128 v[144:147], v30 offset:992
ds_read_b128 v[148:151], v30 offset:1280
ds_read_b128 v[152:155], v30 offset:1568
ds_read_b128 v[156:159], v30 offset:1856
ds_read_b128 v[160:163], v30 offset:2144
ds_read_b128 v[164:167], v30 offset:2432
s_waitcnt vmcnt(4)
buffer_load_dwordx4 v[4:7], v34, s[32:35], s50 offen offset:0
buffer_load_dwordx4 v[8:11], v34, s[32:35], s50 offen offset:1024
buffer_load_dwordx4 v[12:15], v34, s[32:35], s50 offen offset:2048
buffer_load_dwordx4 v[16:19], v34, s[32:35], s50 offen offset:3072
s_add_u32 s50, s50, 4096
v_bitop3_b32 v28, v101, v106, v43 bitop3:0x7e
v_bitop3_b32 v29, v117, v122, v43 bitop3:0x7e
v_or_b32 v28, v28, v29
v_cmp_ne_u32 s[48:49], 0, v28
s_nop 2
s_cmp_lg_u64 s[48:49], 0
s_cbranch_scc1 L_ks10
L_kb10:
s_waitcnt vmcnt(4)
buffer_load_dwordx4 v[20:23], v34, s[32:35], s50 offen offset:0
buffer_load_dwordx4 v[24:27], v34, s[32:35], s50 offen offset:1024
buffer_load_dwordx4 v[48:51], v34, s[32:35], s50 offen offset:2048
buffer_load_dwordx4 v[52:55], v34, s[32:35], s50 offen offset:3072
s_add_u32 s50, s50, 4096
v_bitop3_b32 v28, v109, v114, v43 bitop3:0x7e
v_bitop3_b32 v29, v125, v130, v43 bitop3:0x7e
v_or_b32 v28, v28, v29
v_cmp_ne_u32 s[48:49], 0, v28
s_nop 2
s_cmp_lg_u64 s[48:49], 0
s_cbranch_scc1 L_ks12
L_kb12:
s_waitcnt lgkmcnt(8)
v_mfma_f32_16x16x32_bf16 v[64:67], v[102:105], v[132:135], 0
s_waitcnt lgkmcnt(7)
v_mfma_f32_16x16x32_bf16 v[68:71], v[102:105], v[136:139], 0
s_waitcnt lgkmcnt(6)
v_mfma_f32_16x16x32_bf16 v[72:75], v[102:105], v[140:143], 0
s_waitcnt lgkmcnt(5)
v_mfma_f32_16x16x32_bf16 v[76:79], v[102:105], v[144:147], 0
s_waitcnt lgkmcnt(4)
v_mfma_f32_16x16x32_bf16 v[80:83], v[102:105], v[148:151], 0
s_waitcnt lgkmcnt(3)
v_mfma_f32_16x16x32_bf16 v[84:87], v[102:105], v[152:155], 0
s_waitcnt lgkmcnt(2)
v_mfma_f32_16x16x32_bf16 v[88:91], v[102:105], v[156:159], 0
s_waitcnt lgkmcnt(1)
v_mfma_f32_16x16x32_bf16 v[92:95], v[102:105], v[160:163], 0
s_waitcnt lgkmcnt(0)
v_mfma_f32_16x16x32_bf16 v[96:99], v[102:105], v[164:167], 0
ds_read_b128 v[104:107], v30 offset:2720
v_mfma_f32_16x16x32_bf16 v[64:67], v[118:121], v[136:139], v[64:67]
v_mfma_f32_16x16x32_bf16 v[68:71], v[118:121], v[140:143], v[68:71]
v_mfma_f32_16x16x32_bf16 v[72:75], v[118:121], v[144:147], v[72:75]
v_mfma_f32_16x16x32_bf16 v[76:79], v[118:121], v[148:151], v[76:79]
v_mfma_f32_16x16x32_bf16 v[80:83], v[118:121], v[152:155], v[80:83]
v_mfma_f32_16x16x32_bf16 v[84:87], v[118:121], v[156:159], v[84:87]
v_mfma_f32_16x16x32_bf16 v[88:91], v[118:121], v[160:163], v[88:91]
v_mfma_f32_16x16x32_bf16 v[92:95], v[118:121], v[164:167], v[92:95]
s_waitcnt lgkmcnt(0)
v_mfma_f32_16x16x32_bf16 v[96:99], v[118:121], v[104:107], v[96:99]
ds_read_b128 v[100:103], v30 offset:3008
v_mfma_f32_16x16x32_bf16 v[64:67], v[110:113], v[140:143], v[64:67]
v_mfma_f32_16x16x32_bf16 v[68:71], v[110:113], v[144:147], v[68:71]
v_mfma_f32_16x16x32_bf16 v[72:75], v[110:113], v[148:151], v[72:75]
v_mfma_f32_16x16x32_bf16 v[76:79], v[110:113], v[152:155], v[76:79]
v_mfma_f32_16x16x32_bf16 v[80:83], v[110:113], v[156:159], v[80:83]
v_mfma_f32_16x16x32_bf16 v[84:87], v[110:113], v[160:163], v[84:87]
v_mfma_f32_16x16x32_bf16 v[88:91], v[110:113], v[164:167], v[88:91]
v_mfma_f32_16x16x32_bf16 v[92:95], v[110:113], v[104:107], v[92:95]
s_waitcnt lgkmcnt(0)
v_mfma_f32_16x16x32_bf16 v[96:99], v[110:113], v[100:103], v[96:99]
ds_read_b128 v[120:123], v30 offset:3296
v_mfma_f32_16x16x32_bf16 v[64:67], v[126:129], v[144:147], v[64:67]
buffer_load_dwordx4 v[108:111], v34, s[32:35], s50 offen offset:0
buffer_load_dwordx4 v[112:115], v34, s[32:35], s50 offen offset:1024
v_mfma_f32_16x16x32_bf16 v[68:71], v[126:129], v[148:151], v[68:71]
s_waitcnt vmcnt(6)
v_bitop3_b32 v28, v5, v10, v43 bitop3:0x7e
v_bitop3_b32 v29, v13, v18, v43 bitop3:0x7e
v_or_b32 v28, v28, v29
v_cmp_ne_u32 s[48:49], 0, v28
v_mfma_f32_16x16x32_bf16 v[72:75], v[126:129], v[152:155], v[72:75]
v_mfma_f32_16x16x32_bf16 v[76:79], v[126:129], v[156:159], v[76:79]
v_mfma_f32_16x16x32_bf16 v[80:83], v[126:129], v[160:163], v[80:83]
v_mfma_f32_16x16x32_bf16 v[84:87], v[126:129], v[164:167], v[84:87]
v_mfma_f32_16x16x32_bf16 v[88:91], v[126:129], v[104:107], v[88:91]
v_mfma_f32_16x16x32_bf16 v[92:95], v[126:129], v[100:103], v[92:95]
s_cmp_lg_u64 s[48:49], 0
s_cbranch_scc1 L_ks14
L_kb14:
s_waitcnt lgkmcnt(0)
v_mfma_f32_16x16x32_bf16 v[96:99], v[126:129], v[120:123], v[96:99]
ds_read_b128 v[116:119], v30 offset:3584
v_mfma_f32_16x16x32_bf16 v[64:67], v[6:9], v[148:151], v[64:67]
buffer_load_dwordx4 v[124:127], v34, s[32:35], s50 offen offset:2048
buffer_load_dwordx4 v[128:131], v34, s[32:35], s50 offen offset:3072
v_mfma_f32_16x16x32_bf16 v[68:71], v[6:9], v[152:155], v[68:71]
s_add_u32 s50, s50, 4096
v_mfma_f32_16x16x32_bf16 v[72:75], v[6:9], v[156:159], v[72:75]
v_mfma_f32_16x16x32_bf16 v[76:79], v[6:9], v[160:163], v[76:79]
v_mfma_f32_16x16x32_bf16 v[80:83], v[6:9], v[164:167], v[80:83]
v_mfma_f32_16x16x32_bf16 v[84:87], v[6:9], v[104:107], v[84:87]
v_mfma_f32_16x16x32_bf16 v[88:91], v[6:9], v[100:103], v[88:91]
v_mfma_f32_16x16x32_bf16 v[92:95], v[6:9], v[120:123], v[92:95]
s_waitcnt lgkmcnt(0)
v_mfma_f32_16x16x32_bf16 v[96:99], v[6:9], v[116:119], v[96:99]
ds_read_b128 v[132:135], v30 offset:3872
v_mfma_f32_16x16x32_bf16 v[64:67], v[14:17], v[152:155], v[64:67]
buffer_load_dwordx4 v[168:171], v34, s[32:35], s50 offen offset:0
buffer_load_dwordx4 v[172:175], v34, s[32:35], s50 offen offset:1024
v_mfma_f32_16x16x32_bf16 v[68:71], v[14:17], v[156:159], v[68:71]
s_waitcnt vmcnt(6)
v_bitop3_b32 v28, v21, v26, v43 bitop3:0x7e
v_bitop3_b32 v29, v49, v54, v43 bitop3:0x7e
v_or_b32 v28, v28, v29
v_cmp_ne_u32 s[48:49], 0, v28
v_mfma_f32_16x16x32_bf16 v[72:75], v[14:17], v[160:163], v[72:75]
v_mfma_f32_16x16x32_bf16 v[76:79], v[14:17], v[164:167], v[76:79]
v_mfma_f32_16x16x32_bf16 v[80:83], v[14:17], v[104:107], v[80:83]
s_mov_b32 s97, 12288
buffer_load_dword v44, v40, s[32:35], s97 offen
v_mfma_f32_16x16x32_bf16 v[84:87], v[14:17], v[100:103], v[84:87]
v_mfma_f32_16x16x32_bf16 v[88:91], v[14:17], v[120:123], v[88:91]
v_mfma_f32_16x16x32_bf16 v[92:95], v[14:17], v[116:119], v[92:95]
s_cmp_lg_u64 s[48:49], 0
s_cbranch_scc1 L_ks16
L_kb16:
s_waitcnt lgkmcnt(0)
v_mfma_f32_16x16x32_bf16 v[96:99], v[14:17], v[132:135], v[96:99]
ds_read_b128 v[176:179], v30 offset:4160
v_mfma_f32_16x16x32_bf16 v[64:67], v[22:25], v[156:159], v[64:67]
buffer_load_dwordx4 v[184:187], v34, s[32:35], s50 offen offset:2048
buffer_load_dwordx4 v[188:191], v34, s[32:35], s50 offen offset:3072
v_mfma_f32_16x16x32_bf16 v[68:71], v[22:25], v[160:163], v[68:71]
s_add_u32 s50, s50, 4096
v_mfma_f32_16x16x32_bf16 v[72:75], v[22:25], v[164:167], v[72:75]
v_mfma_f32_16x16x32_bf16 v[76:79], v[22:25], v[104:107], v[76:79]
v_mfma_f32_16x16x32_bf16 v[80:83], v[22:25], v[100:103], v[80:83]
v_mfma_f32_16x16x32_bf16 v[84:87], v[22:25], v[120:123], v[84:87]
v_mfma_f32_16x16x32_bf16 v[88:91], v[22:25], v[116:119], v[88:91]
v_mfma_f32_16x16x32_bf16 v[92:95], v[22:25], v[132:135], v[92:95]
s_waitcnt lgkmcnt(0)
v_mfma_f32_16x16x32_bf16 v[96:99], v[22:25], v[176:179], v[96:99]
ds_read_b128 v[180:183], v30 offset:4448
v_mfma_f32_16x16x32_bf16 v[64:67], v[50:53], v[160:163], v[64:67]
buffer_load_dwordx4 v[192:195], v34, s[32:35], s50 offen offset:0
buffer_load_dwordx4 v[196:199], v34, s[32:35], s50 offen offset:1024
v_mfma_f32_16x16x32_bf16 v[68:71], v[50:53], v[164:167], v[68:71]
s_waitcnt vmcnt(7)
v_bitop3_b32 v28, v109, v114, v43 bitop3:0x7e
v_bitop3_b32 v29, v125, v130, v43 bitop3:0x7e
v_or_b32 v28, v28, v29
v_cmp_ne_u32 s[48:49], 0, v28
v_mfma_f32_16x16x32_bf16 v[72:75], v[50:53], v[104:107], v[72:75]
v_mfma_f32_16x16x32_bf16 v[76:79], v[50:53], v[100:103], v[76:79]
v_mfma_f32_16x16x32_bf16 v[80:83], v[50:53], v[120:123], v[80:83]
v_mfma_f32_16x16x32_bf16 v[84:87], v[50:53], v[116:119], v[84:87]
v_mfma_f32_16x16x32_bf16 v[88:91], v[50:53], v[132:135], v[88:91]
v_mfma_f32_16x16x32_bf16 v[92:95], v[50:53], v[176:179], v[92:95]
s_cmp_lg_u64 s[48:49], 0
s_cbranch_scc1 L_ks18
L_kb18:
s_waitcnt lgkmcnt(0)
v_mfma_f32_16x16x32_bf16 v[96:99], v[50:53], v[180:183], v[96:99]
ds_read_b128 v[240:243], v30 offset:4736
v_mfma_f32_16x16x32_bf16 v[64:67], v[110:113], v[164:167], v[64:67]
buffer_load_dwordx4 v[200:203], v34, s[32:35], s50 offen offset:2048
buffer_load_dwordx4 v[204:207], v34, s[32:35], s50 offen offset:3072
v_mfma_f32_16x16x32_bf16 v[68:71], v[110:113], v[104:107], v[68:71]
s_add_u32 s50, s50, 4096
v_mfma_f32_16x16x32_bf16 v[72:75], v[110:113], v[100:103], v[72:75]
v_mfma_f32_16x16x32_bf16 v[76:79], v[110:113], v[120:123], v[76:79]
v_mfma_f32_16x16x32_bf16 v[80:83], v[110:113], v[116:119], v[80:83]
v_mfma_f32_16x16x32_bf16 v[84:87], v[110:113], v[132:135], v[84:87]
v_mfma_f32_16x16x32_bf16 v[88:91], v[110:113], v[176:179], v[88:91]
v_mfma_f32_16x16x32_bf16 v[92:95], v[110:113], v[180:183], v[92:95]
s_waitcnt lgkmcnt(0)
v_mfma_f32_16x16x32_bf16 v[96:99], v[110:113], v[240:243], v[96:99]
ds_read_b128 v[112:115], v30 offset:5024
v_mfma_f32_16x16x32_bf16 v[64:67], v[126:129], v[104:107], v[64:67]
buffer_load_dwordx4 v[208:211], v34, s[32:35], s50 offen offset:0
buffer_load_dwordx4 v[212:215], v34, s[32:35], s50 offen offset:1024
v_mfma_f32_16x16x32_bf16 v[68:71], v[126:129], v[100:103], v[68:71]
s_waitcnt vmcnt(6)
v_bitop3_b32 v28, v169, v174, v43 bitop3:0x7e
v_bitop3_b32 v29, v185, v190, v43 bitop3:0x7e
v_or_b32 v28, v28, v29
v_cmp_ne_u32 s[48:49], 0, v28
v_mfma_f32_16x16x32_bf16 v[72:75], v[126:129], v[120:123], v[72:75]
v_mfma_f32_16x16x32_bf16 v[76:79], v[126:129], v[116:119], v[76:79]
v_mfma_f32_16x16x32_bf16 v[80:83], v[126:129], v[132:135], v[80:83]
v_mfma_f32_16x16x32_bf16 v[84:87], v[126:129], v[176:179], v[84:87]
v_mfma_f32_16x16x32_bf16 v[88:91], v[126:129], v[180:183], v[88:91]
v_mfma_f32_16x16x32_bf16 v[92:95], v[126:129], v[240:243], v[92:95]
s_cmp_lg_u64 s[48:49], 0
s_cbranch_scc1 L_ks110
L_kb110:
s_waitcnt lgkmcnt(0)
v_mfma_f32_16x16x32_bf16 v[96:99], v[126:129], v[112:115], v[96:99]
ds_read_b128 v[104:107], v30 offset:5312
v_mfma_f32_16x16x32_bf16 v[64:67], v[170:173], v[100:103], v[64:67]
buffer_load_dwordx4 v[124:127], v34, s[32:35], s50 offen offset:2048
buffer_load_dwordx4 v[128:131], v34, s[32:35], s50 offen offset:3072
v_mfma_f32_16x16x32_bf16 v[68:71], v[170:173], v[120:123], v[68:71]
s_add_u32 s50, s50, 4096
v_mfma_f32_16x16x32_bf16 v[72:75], v[170:173], v[116:119], v[72:75]
v_mfma_f32_16x16x32_bf16 v[76:79], v[170:173], v[132:135], v[76:79]
v_mfma_f32_16x16x32_bf16 v[80:83], v[170:173], v[176:179], v[80:83]
v_mfma_f32_16x16x32_bf16 v[84:87], v[170:173], v[180:183], v[84:87]
v_mfma_f32_16x16x32_bf16 v[88:91], v[170:173], v[240:243], v[88:91]
v_mfma_f32_16x16x32_bf16 v[92:95], v[170:173], v[112:115], v[92:95]
s_waitcnt lgkmcnt(0)
v_mfma_f32_16x16x32_bf16 v[96:99], v[170:173], v[104:107], v[96:99]
ds_read_b128 v[100:103], v30 offset:5600
v_mfma_f32_16x16x32_bf16 v[64:67], v[186:189], v[120:123], v[64:67]
v_cmp_ne_u32 vcc, v43, v44
v_mfma_f32_16x16x32_bf16 v[68:71], v[186:189], v[116:119], v[68:71]
s_waitcnt vmcnt(4)
v_bitop3_b32 v28, v193, v198, v43 bitop3:0x7e
v_bitop3_b32 v29, v201, v206, v43 bitop3:0x7e
v_or_b32 v28, v28, v29
v_cmp_ne_u32 s[48:49], 0, v28
v_mfma_f32_16x16x32_bf16 v[72:75], v[186:189], v[132:135], v[72:75]
v_mfma_f32_16x16x32_bf16 v[76:79], v[186:189], v[176:179], v[76:79]
v_mfma_f32_16x16x32_bf16 v[80:83], v[186:189], v[180:183], v[80:83]
v_mfma_f32_16x16x32_bf16 v[84:87], v[186:189], v[240:243], v[84:87]
v_mfma_f32_16x16x32_bf16 v[88:91], v[186:189], v[112:115], v[88:91]
s_cbranch_vccnz L_fw10
L_fb10:
v_mfma_f32_16x16x32_bf16 v[92:95], v[186:189], v[104:107], v[92:95]
s_cmp_lg_u64 s[48:49], 0
s_cbranch_scc1 L_ks112
L_kb112:
s_waitcnt lgkmcnt(0)
v_mfma_f32_16x16x32_bf16 v[96:99], v[186:189], v[100:103], v[96:99]
ds_read_b128 v[120:123], v30 offset:5888
v_mfma_f32_16x16x32_bf16 v[64:67], v[194:197], v[116:119], v[64:67]
buffer_load_dwordx4 v[116:119], v34, s[32:35], s69 offen offset:0
v_mfma_f32_16x16x32_bf16 v[68:71], v[194:197], v[132:135], v[68:71]
v_mfma_f32_16x16x32_bf16 v[72:75], v[194:197], v[176:179], v[72:75]
v_mfma_f32_16x16x32_bf16 v[76:79], v[194:197], v[180:183], v[76:79]
v_mfma_f32_16x16x32_bf16 v[80:83], v[194:197], v[240:243], v[80:83]
buffer_load_dwordx4 v[108:111], v34, s[32:35], s69 offen offset:1024
v_mfma_f32_16x16x32_bf16 v[84:87], v[194:197], v[112:115], v[84:87]
v_mfma_f32_16x16x32_bf16 v[88:91], v[194:197], v[104:107], v[88:91]
v_mfma_f32_16x16x32_bf16 v[92:95], v[194:197], v[100:103], v[92:95]
s_waitcnt lgkmcnt(0)
v_mfma_f32_16x16x32_bf16 v[96:99], v[194:197], v[120:123], v[96:99]
ds_read_b128 v[244:247], v30 offset:6176
v_mfma_f32_16x16x32_bf16 v[64:67], v[202:205], v[132:135], v[64:67]
buffer_load_dwordx4 v[132:135], v34, s[32:35], s69 offen offset:2048
v_mfma_f32_16x16x32_bf16 v[68:71], v[202:205], v[176:179], v[68:71]
s_waitcnt vmcnt(3)
v_bitop3_b32 v28, v209, v214, v43 bitop3:0x7e
v_bitop3_b32 v29, v125, v130, v43 bitop3:0x7e
v_or_b32 v28, v28, v29
v_cmp_ne_u32 s[48:49], 0, v28
v_mfma_f32_16x16x32_bf16 v[72:75], v[202:205], v[180:183], v[72:75]
v_mfma_f32_16x16x32_bf16 v[76:79], v[202:205], v[240:243], v[76:79]
v_mfma_f32_16x16x32_bf16 v[80:83], v[202:205], v[112:115], v[80:83]
s_mov_b32 s97, 14336
buffer_load_dword v44, v40, s[32:35], s97 offen
v_mfma_f32_16x16x32_bf16 v[84:87], v[202:205], v[104:107], v[84:87]
buffer_load_dwordx4 v[248:251], v34, s[32:35], s69 offen offset:3072
v_mfma_f32_16x16x32_bf16 v[88:91], v[202:205], v[100:103], v[88:91]
s_add_u32 s69, s69, 4096
v_mfma_f32_16x16x32_bf16 v[92:95], v[202:205], v[120:123], v[92:95]
s_cmp_lg_u64 s[48:49], 0
s_cbranch_scc1 L_ks114
L_kb114:
s_waitcnt lgkmcnt(0)
v_mfma_f32_16x16x32_bf16 v[96:99], v[202:205], v[244:247], v[96:99]
ds_read_b128 v[252:255], v30 offset:6464
v_mfma_f32_16x16x32_bf16 v[64:67], v[210:213], v[176:179], v[64:67]
buffer_load_dwordx4 v[216:219], v34, s[32:35], s69 offen offset:0
v_mfma_f32_16x16x32_bf16 v[68:71], v[210:213], v[180:183], v[68:71]
v_mfma_f32_16x16x32_bf16 v[72:75], v[210:213], v[240:243], v[72:75]
v_mfma_f32_16x16x32_bf16 v[76:79], v[210:213], v[112:115], v[76:79]
v_mfma_f32_16x16x32_bf16 v[80:83], v[210:213], v[104:107], v[80:83]
buffer_load_dwordx4 v[220:223], v34, s[32:35], s69 offen offset:1024
v_mfma_f32_16x16x32_bf16 v[84:87], v[210:213], v[100:103], v[84:87]
v_mfma_f32_16x16x32_bf16 v[88:91], v[210:213], v[120:123], v[88:91]
v_mfma_f32_16x16x32_bf16 v[92:95], v[210:213], v[244:247], v[92:95]
s_waitcnt lgkmcnt(0)
v_mfma_f32_16x16x32_bf16 v[96:99], v[210:213], v[252:255], v[96:99]
ds_read_b128 v[56:59], v30 offset:6752
v_mfma_f32_16x16x32_bf16 v[64:67], v[126:129], v[180:183], v[64:67]
ds_read_b128 v[136:139], v30 offset:192
v_mfma_f32_16x16x32_bf16 v[68:71], v[126:129], v[240:243], v[68:71]
ds_read_b128 v[140:143], v30 offset:480
v_mfma_f32_16x16x32_bf16 v[72:75], v[126:129], v[112:115], v[72:75]
buffer_load_dwordx4 v[112:115], v34, s[32:35], s69 offen offset:2048
v_mfma_f32_16x16x32_bf16 v[76:79], v[126:129], v[104:107], v[76:79]
ds_read_b128 v[104:107], v30 offset:768
v_mfma_f32_16x16x32_bf16 v[80:83], v[126:129], v[100:103], v[80:83]
v_mfma_f32_16x16x32_bf16 v[84:87], v[126:129], v[120:123], v[84:87]
v_mfma_f32_16x16x32_bf16 v[88:91], v[126:129], v[244:247], v[88:91]
ds_read_b128 v[100:103], v30 offset:1056
v_mfma_f32_16x16x32_bf16 v[92:95], v[126:129], v[252:255], v[92:95]
buffer_load_dwordx4 v[120:123], v34, s[32:35], s69 offen offset:3072
s_waitcnt lgkmcnt(4)
v_mfma_f32_16x16x32_bf16 v[96:99], v[126:129], v[56:59], v[96:99]
s_add_u32 s69, s69, 4096
s_waitcnt lgkmcnt(3)
s_waitcnt vmcnt(8)
v_mfma_f32_16x16x32_bf16 v[64:67], v[116:119], v[136:139], v[64:67]
s_waitcnt lgkmcnt(2)
v_mfma_f32_16x16x32_bf16 v[68:71], v[116:119], v[140:143], v[68:71]
ds_read_b128 v[128:131], v30 offset:1344
s_waitcnt vmcnt(7)
v_mfma_f32_16x16x32_bf16 v[64:67], v[108:111], v[140:143], v[64:67]
buffer_load_dwordx4 v[124:127], v34, s[32:35], s69 offen offset:0
s_waitcnt lgkmcnt(2)
v_mfma_f32_16x16x32_bf16 v[72:75], v[116:119], v[104:107], v[72:75]
v_mfma_f32_16x16x32_bf16 v[68:71], v[108:111], v[104:107], v[68:71]
s_waitcnt vmcnt(7)
v_mfma_f32_16x16x32_bf16 v[64:67], v[132:135], v[104:107], v[64:67]
s_waitcnt lgkmcnt(1)
v_mfma_f32_16x16x32_bf16 v[76:79], v[116:119], v[100:103], v[76:79]
ds_read_b128 v[104:107], v30 offset:1632
v_mfma_f32_16x16x32_bf16 v[72:75], v[108:111], v[100:103], v[72:75]
buffer_load_dwordx4 v[144:147], v34, s[32:35], s69 offen offset:1024
v_mfma_f32_16x16x32_bf16 v[68:71], v[132:135], v[100:103], v[68:71]
s_waitcnt vmcnt(6)
v_mfma_f32_16x16x32_bf16 v[64:67], v[248:251], v[100:103], v[64:67]
s_waitcnt lgkmcnt(1)
v_mfma_f32_16x16x32_bf16 v[80:83], v[116:119], v[128:131], v[80:83]
v_mfma_f32_16x16x32_bf16 v[76:79], v[108:111], v[128:131], v[76:79]
buffer_load_dwordx4 v[100:103], v34, s[32:35], s69 offen offset:2048
v_mfma_f32_16x16x32_bf16 v[72:75], v[132:135], v[128:131], v[72:75]
ds_read_b128 v[148:151], v30 offset:1920
v_mfma_f32_16x16x32_bf16 v[68:71], v[248:251], v[128:131], v[68:71]
s_waitcnt vmcnt(6)
v_mfma_f32_16x16x32_bf16 v[64:67], v[216:219], v[128:131], v[64:67]
s_waitcnt lgkmcnt(1)
v_mfma_f32_16x16x32_bf16 v[84:87], v[116:119], v[104:107], v[84:87]
v_cmp_ne_u32 vcc, v43, v44
v_mfma_f32_16x16x32_bf16 v[80:83], v[108:111], v[104:107], v[80:83]
buffer_load_dwordx4 v[128:131], v34, s[32:35], s69 offen offset:3072
v_mfma_f32_16x16x32_bf16 v[76:79], v[132:135], v[104:107], v[76:79]
s_add_u32 s69, s69, 4096
v_mfma_f32_16x16x32_bf16 v[72:75], v[248:251], v[104:107], v[72:75]
v_mfma_f32_16x16x32_bf16 v[68:71], v[216:219], v[104:107], v[68:71]
ds_read_b128 v[4:7], v30 offset:2208
s_waitcnt vmcnt(6)
v_mfma_f32_16x16x32_bf16 v[64:67], v[220:223], v[104:107], v[64:67]
buffer_load_dwordx4 v[104:107], v34, s[32:35], s69 offen offset:0
s_waitcnt lgkmcnt(1)
v_mfma_f32_16x16x32_bf16 v[88:91], v[116:119], v[148:151], v[88:91]
s_cbranch_vccnz L_fw11
L_fb11:
v_mfma_f32_16x16x32_bf16 v[84:87], v[108:111], v[148:151], v[84:87]
v_mfma_f32_16x16x32_bf16 v[80:83], v[132:135], v[148:151], v[80:83]
v_mfma_f32_16x16x32_bf16 v[76:79], v[248:251], v[148:151], v[76:79]
buffer_load_dwordx4 v[8:11], v34, s[32:35], s69 offen offset:1024
v_mfma_f32_16x16x32_bf16 v[72:75], v[216:219], v[148:151], v[72:75]
v_mfma_f32_16x16x32_bf16 v[68:71], v[220:223], v[148:151], v[68:71]
s_waitcnt vmcnt(7)
v_mfma_f32_16x16x32_bf16 v[64:67], v[112:115], v[148:151], v[64:67]
ds_read_b128 v[152:155], v30 offset:2496
s_waitcnt lgkmcnt(1)
v_mfma_f32_16x16x32_bf16 v[92:95], v[116:119], v[4:7], v[92:95]
ds_read_b128 v[12:15], v30 offset:2784
v_mfma_f32_16x16x32_bf16 v[88:91], v[108:111], v[4:7], v[88:91]
ds_read_b128 v[16:19], v30 offset:3072
v_mfma_f32_16x16x32_bf16 v[84:87], v[132:135], v[4:7], v[84:87]
ds_read_b128 v[156:159], v30 offset:3360
v_mfma_f32_16x16x32_bf16 v[80:83], v[248:251], v[4:7], v[80:83]
buffer_load_dwordx4 v[20:23], v34, s[32:35], s69 offen offset:2048
v_mfma_f32_16x16x32_bf16 v[76:79], v[216:219], v[4:7], v[76:79]
v_mfma_f32_16x16x32_bf16 v[72:75], v[220:223], v[4:7], v[72:75]
v_mfma_f32_16x16x32_bf16 v[68:71], v[112:115], v[4:7], v[68:71]
s_waitcnt vmcnt(7)
v_mfma_f32_16x16x32_bf16 v[64:67], v[120:123], v[4:7], v[64:67]
buffer_load_dwordx4 v[24:27], v34, s[32:35], s69 offen offset:3072
s_waitcnt lgkmcnt(3)
v_mfma_f32_16x16x32_bf16 v[96:99], v[116:119], v[152:155], v[96:99]
s_add_u32 s69, s69, 4096
s_waitcnt lgkmcnt(2)
v_mfma_f32_16x16x32_bf16 v[96:99], v[108:111], v[12:15], v[96:99]
s_waitcnt lgkmcnt(1)
v_mfma_f32_16x16x32_bf16 v[96:99], v[132:135], v[16:19], v[96:99]
s_waitcnt lgkmcnt(0)
v_mfma_f32_16x16x32_bf16 v[96:99], v[248:251], v[156:159], v[96:99]
buffer_load_dwordx4 v[116:119], v34, s[32:35], s69 offen offset:0
v_mfma_f32_16x16x32_bf16 v[92:95], v[216:219], v[156:159], v[92:95]
v_mfma_f32_16x16x32_bf16 v[92:95], v[248:251], v[16:19], v[92:95]
v_mfma_f32_16x16x32_bf16 v[92:95], v[132:135], v[12:15], v[92:95]
v_mfma_f32_16x16x32_bf16 v[92:95], v[108:111], v[152:155], v[92:95]
buffer_load_dwordx4 v[108:111], v34, s[32:35], s69 offen offset:1024
v_mfma_f32_16x16x32_bf16 v[88:91], v[132:135], v[152:155], v[88:91]
v_mfma_f32_16x16x32_bf16 v[88:91], v[248:251], v[12:15], v[88:91]
v_mfma_f32_16x16x32_bf16 v[88:91], v[216:219], v[16:19], v[88:91]
v_mfma_f32_16x16x32_bf16 v[88:91], v[220:223], v[156:159], v[88:91]
buffer_load_dwordx4 v[132:135], v34, s[32:35], s69 offen offset:2048
v_mfma_f32_16x16x32_bf16 v[84:87], v[112:115], v[156:159], v[84:87]
v_mfma_f32_16x16x32_bf16 v[84:87], v[220:223], v[16:19], v[84:87]
v_mfma_f32_16x16x32_bf16 v[84:87], v[216:219], v[12:15], v[84:87]
v_mfma_f32_16x16x32_bf16 v[84:87], v[248:251], v[152:155], v[84:87]
buffer_load_dwordx4 v[160:163], v34, s[32:35], s69 offen offset:3072
v_mfma_f32_16x16x32_bf16 v[80:83], v[216:219], v[152:155], v[80:83]
s_add_u32 s69, s69, 4096
v_mfma_f32_16x16x32_bf16 v[80:83], v[220:223], v[12:15], v[80:83]
v_mfma_f32_16x16x32_bf16 v[80:83], v[112:115], v[16:19], v[80:83]
v_mfma_f32_16x16x32_bf16 v[80:83], v[120:123], v[156:159], v[80:83]
buffer_load_dwordx4 v[48:51], v34, s[32:35], s69 offen offset:0
s_waitcnt vmcnt(12)
v_mfma_f32_16x16x32_bf16 v[76:79], v[124:127], v[156:159], v[76:79]
v_mfma_f32_16x16x32_bf16 v[76:79], v[120:123], v[16:19], v[76:79]
v_mfma_f32_16x16x32_bf16 v[76:79], v[112:115], v[12:15], v[76:79]
v_mfma_f32_16x16x32_bf16 v[76:79], v[220:223], v[152:155], v[76:79]
buffer_load_dwordx4 v[52:55], v34, s[32:35], s69 offen offset:1024
v_mfma_f32_16x16x32_bf16 v[72:75], v[112:115], v[152:155], v[72:75]
v_mfma_f32_16x16x32_bf16 v[72:75], v[120:123], v[12:15], v[72:75]
v_mfma_f32_16x16x32_bf16 v[72:75], v[124:127], v[16:19], v[72:75]
s_waitcnt vmcnt(12)
v_mfma_f32_16x16x32_bf16 v[72:75], v[144:147], v[156:159], v[72:75]
ds_read_b128 v[164:167], v30 offset:3648
s_waitcnt vmcnt(11)
v_mfma_f32_16x16x32_bf16 v[68:71], v[100:103], v[156:159], v[68:71]
ds_read_b128 v[168:171], v30 offset:3936
v_mfma_f32_16x16x32_bf16 v[68:71], v[144:147], v[16:19], v[68:71]
ds_read_b128 v[172:175], v30 offset:4224
v_mfma_f32_16x16x32_bf16 v[68:71], v[124:127], v[12:15], v[68:71]
ds_read_b128 v[184:187], v30 offset:4512
v_mfma_f32_16x16x32_bf16 v[68:71], v[120:123], v[152:155], v[68:71]
v_mfma_f32_16x16x32_bf16 v[64:67], v[124:127], v[152:155], v[64:67]
v_mfma_f32_16x16x32_bf16 v[64:67], v[144:147], v[12:15], v[64:67]
v_mfma_f32_16x16x32_bf16 v[64:67], v[100:103], v[16:19], v[64:67]
s_waitcnt vmcnt(10)
v_mfma_f32_16x16x32_bf16 v[64:67], v[128:131], v[156:159], v[64:67]
s_waitcnt lgkmcnt(3)
v_mfma_f32_16x16x32_bf16 v[96:99], v[216:219], v[164:167], v[96:99]
s_waitcnt lgkmcnt(2)
v_mfma_f32_16x16x32_bf16 v[96:99], v[220:223], v[168:171], v[96:99]
s_waitcnt lgkmcnt(1)
v_mfma_f32_16x16x32_bf16 v[96:99], v[112:115], v[172:175], v[96:99]
s_waitcnt lgkmcnt(0)
v_mfma_f32_16x16x32_bf16 v[96:99], v[120:123], v[184:187], v[96:99]
v_mfma_f32_16x16x32_bf16 v[92:95], v[124:127], v[184:187], v[92:95]
v_mfma_f32_16x16x32_bf16 v[92:95], v[120:123], v[172:175], v[92:95]
v_mfma_f32_16x16x32_bf16 v[92:95], v[112:115], v[168:171], v[92:95]
v_mfma_f32_16x16x32_bf16 v[92:95], v[220:223], v[164:167], v[92:95]
v_mfma_f32_16x16x32_bf16 v[88:91], v[112:115], v[164:167], v[88:91]
v_mfma_f32_16x16x32_bf16 v[88:91], v[120:123], v[168:171], v[88:91]
v_mfma_f32_16x16x32_bf16 v[88:91], v[124:127], v[172:175], v[88:91]
v_mfma_f32_16x16x32_bf16 v[88:91], v[144:147], v[184:187], v[88:91]
v_mfma_f32_16x16x32_bf16 v[84:87], v[100:103], v[184:187], v[84:87]
v_mfma_f32_16x16x32_bf16 v[84:87], v[144:147], v[172:175], v[84:87]
s_mov_b32 s97, 18432
buffer_load_dword v44, v40, s[32:35], s97 offen
v_mfma_f32_16x16x32_bf16 v[84:87], v[124:127], v[168:171], v[84:87]
v_mfma_f32_16x16x32_bf16 v[84:87], v[120:123], v[164:167], v[84:87]
v_mfma_f32_16x16x32_bf16 v[80:83], v[124:127], v[164:167], v[80:83]
v_mfma_f32_16x16x32_bf16 v[80:83], v[144:147], v[168:171], v[80:83]
v_mfma_f32_16x16x32_bf16 v[80:83], v[100:103], v[172:175], v[80:83]
v_mfma_f32_16x16x32_bf16 v[80:83], v[128:131], v[184:187], v[80:83]
s_waitcnt vmcnt(10)
v_mfma_f32_16x16x32_bf16 v[76:79], v[104:107], v[184:187], v[76:79]
v_mfma_f32_16x16x32_bf16 v[76:79], v[128:131], v[172:175], v[76:79]
v_mfma_f32_16x16x32_bf16 v[76:79], v[100:103], v[168:171], v[76:79]
v_mfma_f32_16x16x32_bf16 v[76:79], v[144:147], v[164:167], v[76:79]
v_mfma_f32_16x16x32_bf16 v[72:75], v[100:103], v[164:167], v[72:75]
v_mfma_f32_16x16x32_bf16 v[72:75], v[128:131], v[168:171], v[72:75]
v_mfma_f32_16x16x32_bf16 v[72:75], v[104:107], v[172:175], v[72:75]
s_waitcnt vmcnt(9)
v_mfma_f32_16x16x32_bf16 v[72:75], v[8:11], v[184:187], v[72:75]
ds_read_b128 v[120:123], v30 offset:4800
s_waitcnt vmcnt(8)
v_mfma_f32_16x16x32_bf16 v[68:71], v[20:23], v[184:187], v[68:71]
ds_read_b128 v[112:115], v30 offset:5088
v_mfma_f32_16x16x32_bf16 v[68:71], v[8:11], v[172:175], v[68:71]
ds_read_b128 v[188:191], v30 offset:5376
v_mfma_f32_16x16x32_bf16 v[68:71], v[104:107], v[168:171], v[68:71]
ds_read_b128 v[192:195], v30 offset:5664
v_mfma_f32_16x16x32_bf16 v[68:71], v[128:131], v[164:167], v[68:71]
v_mfma_f32_16x16x32_bf16 v[64:67], v[104:107], v[164:167], v[64:67]
v_mfma_f32_16x16x32_bf16 v[64:67], v[8:11], v[168:171], v[64:67]
v_mfma_f32_16x16x32_bf16 v[64:67], v[20:23], v[172:175], v[64:67]
s_waitcnt vmcnt(7)
v_mfma_f32_16x16x32_bf16 v[64:67], v[24:27], v[184:187], v[64:67]
s_waitcnt lgkmcnt(3)
v_mfma_f32_16x16x32_bf16 v[96:99], v[124:127], v[120:123], v[96:99]
s_waitcnt lgkmcnt(2)
v_mfma_f32_16x16x32_bf16 v[96:99], v[144:147], v[112:115], v[96:99]
s_waitcnt lgkmcnt(1)
v_mfma_f32_16x16x32_bf16 v[96:99], v[100:103], v[188:191], v[96:99]
s_waitcnt lgkmcnt(0)
v_mfma_f32_16x16x32_bf16 v[96:99], v[128:131], v[192:195], v[96:99]
v_mfma_f32_16x16x32_bf16 v[92:95], v[104:107], v[192:195], v[92:95]
v_mfma_f32_16x16x32_bf16 v[92:95], v[128:131], v[188:191], v[92:95]
v_mfma_f32_16x16x32_bf16 v[92:95], v[100:103], v[112:115], v[92:95]
v_mfma_f32_16x16x32_bf16 v[92:95], v[144:147], v[120:123], v[92:95]
v_mfma_f32_16x16x32_bf16 v[88:91], v[100:103], v[120:123], v[88:91]
v_mfma_f32_16x16x32_bf16 v[88:91], v[128:131], v[112:115], v[88:91]
v_mfma_f32_16x16x32_bf16 v[88:91], v[104:107], v[188:191], v[88:91]
v_mfma_f32_16x16x32_bf16 v[88:91], v[8:11], v[192:195], v[88:91]
ds_read_b128 v[100:103], v31 offset:1440
v_mfma_f32_16x16x32_bf16 v[84:87], v[20:23], v[192:195], v[84:87]
v_mfma_f32_16x16x32_bf16 v[84:87], v[8:11], v[188:191], v[84:87]
v_mfma_f32_16x16x32_bf16 v[84:87], v[104:107], v[112:115], v[84:87]
v_mfma_f32_16x16x32_bf16 v[84:87], v[128:131], v[120:123], v[84:87]
v_mfma_f32_16x16x32_bf16 v[80:83], v[104:107], v[120:123], v[80:83]
v_mfma_f32_16x16x32_bf16 v[80:83], v[8:11], v[112:115], v[80:83]
ds_read_b128 v[128:131], v31 offset:1152
v_mfma_f32_16x16x32_bf16 v[80:83], v[20:23], v[188:191], v[80:83]
s_waitcnt vmcnt(0)
v_cmp_ne_u32 vcc, v43, v44
v_mfma_f32_16x16x32_bf16 v[80:83], v[24:27], v[192:195], v[80:83]
s_waitcnt lgkmcnt(1)
v_mfma_f32_16x16x32_bf16 v[76:79], v[116:119], v[100:103], v[76:79]
v_mfma_f32_16x16x32_bf16 v[76:79], v[24:27], v[188:191], v[76:79]
ds_read_b128 v[124:127], v31 offset:864
v_mfma_f32_16x16x32_bf16 v[76:79], v[20:23], v[112:115], v[76:79]
v_mfma_f32_16x16x32_bf16 v[76:79], v[8:11], v[120:123], v[76:79]
ds_read_b128 v[196:199], v31 offset:576
v_mfma_f32_16x16x32_bf16 v[72:75], v[20:23], v[120:123], v[72:75]
s_cbranch_vccnz L_fw12
L_fb12:
v_mfma_f32_16x16x32_bf16 v[72:75], v[24:27], v[112:115], v[72:75]
s_waitcnt lgkmcnt(2)
v_mfma_f32_16x16x32_bf16 v[72:75], v[116:119], v[128:131], v[72:75]
buffer_load_dwordx4 v[200:203], v34, s[32:35], s69 offen offset:2048
v_mfma_f32_16x16x32_bf16 v[72:75], v[108:111], v[100:103], v[72:75]
ds_read_b128 v[112:115], v30 offset:5952
v_mfma_f32_16x16x32_bf16 v[68:71], v[132:135], v[100:103], v[68:71]
ds_read_b128 v[204:207], v30 offset:6240
v_mfma_f32_16x16x32_bf16 v[68:71], v[108:111], v[128:131], v[68:71]
ds_read_b128 v[176:179], v30 offset:6528
s_waitcnt lgkmcnt(4)
v_mfma_f32_16x16x32_bf16 v[68:71], v[116:119], v[124:127], v[68:71]
ds_read_b128 v[208:211], v30 offset:6816
v_mfma_f32_16x16x32_bf16 v[68:71], v[24:27], v[120:123], v[68:71]
ds_read_b128 v[120:123], v31 offset:2592
s_waitcnt lgkmcnt(5)
v_mfma_f32_16x16x32_bf16 v[64:67], v[116:119], v[196:199], v[64:67]
buffer_load_dwordx4 v[212:215], v34, s[32:35], s69 offen offset:3072
v_mfma_f32_16x16x32_bf16 v[64:67], v[108:111], v[124:127], v[64:67]
s_add_u32 s69, s69, 4096
v_mfma_f32_16x16x32_bf16 v[64:67], v[132:135], v[128:131], v[64:67]
v_mfma_f32_16x16x32_bf16 v[64:67], v[160:163], v[100:103], v[64:67]
s_waitcnt lgkmcnt(4)
v_mfma_f32_16x16x32_bf16 v[96:99], v[104:107], v[112:115], v[96:99]
buffer_load_dwordx4 v[180:183], v34, s[32:35], s69 offen offset:0
s_waitcnt lgkmcnt(3)
v_mfma_f32_16x16x32_bf16 v[96:99], v[8:11], v[204:207], v[96:99]
ds_read_b128 v[100:103], v31 offset:2304
s_waitcnt lgkmcnt(3)
v_mfma_f32_16x16x32_bf16 v[96:99], v[20:23], v[176:179], v[96:99]
s_waitcnt lgkmcnt(2)
v_mfma_f32_16x16x32_bf16 v[96:99], v[24:27], v[208:211], v[96:99]
ds_read_b32 v28, v41 offset:16
s_waitcnt lgkmcnt(2)
v_mfma_f32_16x16x32_bf16 v[92:95], v[116:119], v[120:123], v[92:95]
buffer_load_dwordx4 v[240:243], v34, s[32:35], s69 offen offset:1024
v_mfma_f32_16x16x32_bf16 v[92:95], v[24:27], v[176:179], v[92:95]
ds_read_b128 v[128:131], v31 offset:2016
v_mfma_f32_16x16x32_bf16 v[92:95], v[20:23], v[204:207], v[92:95]
v_mfma_f32_16x16x32_bf16 v[92:95], v[8:11], v[112:115], v[92:95]
ds_read_b128 v[124:127], v31 offset:1728
v_mfma_f32_16x16x32_bf16 v[88:91], v[20:23], v[112:115], v[88:91]
buffer_load_dwordx4 v[244:247], v34, s[32:35], s69 offen offset:2048
v_mfma_f32_16x16x32_bf16 v[88:91], v[24:27], v[204:207], v[88:91]
s_waitcnt lgkmcnt(2)
v_cmp_ne_u32 vcc, 4, v28
v_mfma_f32_16x16x32_bf16 v[88:91], v[116:119], v[100:103], v[88:91]
v_mfma_f32_16x16x32_bf16 v[88:91], v[108:111], v[120:123], v[88:91]
v_mfma_f32_16x16x32_bf16 v[84:87], v[132:135], v[120:123], v[84:87]
buffer_load_dwordx4 v[252:255], v34, s[32:35], s69 offen offset:3072
v_mfma_f32_16x16x32_bf16 v[84:87], v[108:111], v[100:103], v[84:87]
s_add_u32 s69, s69, 4096
s_waitcnt lgkmcnt(1)
v_mfma_f32_16x16x32_bf16 v[84:87], v[116:119], v[128:131], v[84:87]
v_mfma_f32_16x16x32_bf16 v[84:87], v[24:27], v[112:115], v[84:87]
s_cbranch_vccnz L_slow1D
L_back1D:
s_waitcnt lgkmcnt(0)
v_mfma_f32_16x16x32_bf16 v[80:83], v[116:119], v[124:127], v[80:83]
buffer_load_dwordx4 v[56:59], v34, s[32:35], s69 offen offset:0
v_mfma_f32_16x16x32_bf16 v[80:83], v[108:111], v[128:131], v[80:83]
v_mfma_f32_16x16x32_bf16 v[80:83], v[132:135], v[100:103], v[80:83]
v_mfma_f32_16x16x32_bf16 v[80:83], v[160:163], v[120:123], v[80:83]
v_mfma_f32_16x16x32_bf16 v[76:79], v[48:51], v[120:123], v[76:79]
buffer_load_dwordx4 v[136:139], v34, s[32:35], s69 offen offset:1024
v_mfma_f32_16x16x32_bf16 v[76:79], v[160:163], v[100:103], v[76:79]
v_mfma_f32_16x16x32_bf16 v[76:79], v[132:135], v[128:131], v[76:79]
ds_read_b128 v[112:115], v32 offset:288
v_mfma_f32_16x16x32_bf16 v[76:79], v[108:111], v[124:127], v[76:79]
v_mfma_f32_16x16x32_bf16 v[72:75], v[132:135], v[124:127], v[72:75]
buffer_load_dwordx4 v[140:143], v34, s[32:35], s69 offen offset:2048
v_mfma_f32_16x16x32_bf16 v[72:75], v[160:163], v[128:131], v[72:75]
ds_read_b128 v[148:151], v32 offset:0
v_mfma_f32_16x16x32_bf16 v[72:75], v[48:51], v[100:103], v[72:75]
v_mfma_f32_16x16x32_bf16 v[72:75], v[52:55], v[120:123], v[72:75]
ds_read_b128 v[4:7], v31 offset:2880
v_mfma_f32_16x16x32_bf16 v[68:71], v[160:163], v[124:127], v[68:71]
ds_read_b128 v[248:251], v31 offset:3168
v_mfma_f32_16x16x32_bf16 v[68:71], v[48:51], v[128:131], v[68:71]
ds_read_b128 v[152:155], v31 offset:3456
v_mfma_f32_16x16x32_bf16 v[68:71], v[52:55], v[100:103], v[68:71]
ds_read_b128 v[120:123], v31 offset:3744
s_waitcnt lgkmcnt(5)
s_waitcnt vmcnt(8)
v_mfma_f32_16x16x32_bf16 v[104:107], v[200:203], v[112:115], v[68:71]
buffer_load_dwordx4 v[12:15], v34, s[32:35], s69 offen offset:3072
v_mfma_f32_16x16x32_bf16 v[64:67], v[48:51], v[124:127], v[64:67]
s_add_u32 s69, s69, 4096
v_mfma_f32_16x16x32_bf16 v[64:67], v[52:55], v[128:131], v[64:67]
s_waitcnt lgkmcnt(4)
v_mfma_f32_16x16x32_bf16 v[100:103], v[200:203], v[148:151], v[64:67]
s_waitcnt vmcnt(8)
v_mfma_f32_16x16x32_bf16 v[100:103], v[212:215], v[112:115], v[100:103]
buffer_load_dwordx4 v[16:19], v34, s[32:35], s69 offen offset:0
s_waitcnt lgkmcnt(3)
v_mfma_f32_16x16x32_bf16 v[96:99], v[116:119], v[4:7], v[96:99]
s_waitcnt lgkmcnt(2)
v_mfma_f32_16x16x32_bf16 v[96:99], v[108:111], v[248:251], v[96:99]
s_waitcnt lgkmcnt(1)
v_mfma_f32_16x16x32_bf16 v[96:99], v[132:135], v[152:155], v[96:99]
s_waitcnt lgkmcnt(0)
v_mfma_f32_16x16x32_bf16 v[96:99], v[160:163], v[120:123], v[96:99]
buffer_load_dwordx4 v[156:159], v34, s[32:35], s69 offen offset:1024
v_mfma_f32_16x16x32_bf16 v[92:95], v[48:51], v[120:123], v[92:95]
s_mov_b32 s97, 22528
buffer_load_dword v44, v40, s[32:35], s97 offen
v_mfma_f32_16x16x32_bf16 v[92:95], v[160:163], v[152:155], v[92:95]
v_mfma_f32_16x16x32_bf16 v[92:95], v[132:135], v[248:251], v[92:95]
ds_read_b128 v[128:131], v32 offset:1440
v_mfma_f32_16x16x32_bf16 v[92:95], v[108:111], v[4:7], v[92:95]
buffer_load_dwordx4 v[216:219], v34, s[32:35], s69 offen offset:2048
v_mfma_f32_16x16x32_bf16 v[88:91], v[132:135], v[4:7], v[88:91]
v_mfma_f32_16x16x32_bf16 v[88:91], v[160:163], v[248:251], v[88:91]
ds_read_b128 v[132:135], v32 offset:1152
v_mfma_f32_16x16x32_bf16 v[88:91], v[48:51], v[152:155], v[88:91]
v_mfma_f32_16x16x32_bf16 v[88:91], v[52:55], v[120:123], v[88:91]
buffer_load_dwordx4 v[220:223], v34, s[32:35], s69 offen offset:3072
v_mfma_f32_16x16x32_bf16 v[84:87], v[160:163], v[4:7], v[84:87]
s_add_u32 s69, s69, 4096
ds_read_b128 v[124:127], v32 offset:864
v_mfma_f32_16x16x32_bf16 v[84:87], v[48:51], v[248:251], v[84:87]
v_mfma_f32_16x16x32_bf16 v[84:87], v[52:55], v[152:155], v[84:87]
s_waitcnt lgkmcnt(2)
v_mfma_f32_16x16x32_bf16 v[120:123], v[200:203], v[128:131], v[84:87]
ds_read_b128 v[164:167], v32 offset:576
v_mfma_f32_16x16x32_bf16 v[80:83], v[48:51], v[4:7], v[80:83]
buffer_load_dwordx4 v[168:171], v34, s[32:35], s69 offen offset:0
v_mfma_f32_16x16x32_bf16 v[80:83], v[52:55], v[248:251], v[80:83]
s_waitcnt lgkmcnt(2)
v_mfma_f32_16x16x32_bf16 v[116:119], v[200:203], v[132:135], v[80:83]
v_mfma_f32_16x16x32_bf16 v[116:119], v[212:215], v[128:131], v[116:119]
v_mfma_f32_16x16x32_bf16 v[76:79], v[52:55], v[4:7], v[76:79]
s_waitcnt lgkmcnt(1)
v_mfma_f32_16x16x32_bf16 v[112:115], v[200:203], v[124:127], v[76:79]
v_mfma_f32_16x16x32_bf16 v[112:115], v[212:215], v[132:135], v[112:115]
s_waitcnt vmcnt(13)
v_mfma_f32_16x16x32_bf16 v[112:115], v[180:183], v[128:131], v[112:115]
s_waitcnt lgkmcnt(0)
v_mfma_f32_16x16x32_bf16 v[108:111], v[200:203], v[164:167], v[72:75]
v_mfma_f32_16x16x32_bf16 v[108:111], v[212:215], v[124:127], v[108:111]
v_mfma_f32_16x16x32_bf16 v[108:111], v[180:183], v[132:135], v[108:111]
s_waitcnt vmcnt(12)
v_mfma_f32_16x16x32_bf16 v[108:111], v[240:243], v[128:131], v[108:111]
ds_read_b128 v[172:175], v31 offset:4032
s_waitcnt vmcnt(11)
v_mfma_f32_16x16x32_bf16 v[104:107], v[244:247], v[128:131], v[104:107]
ds_read_b128 v[184:187], v31 offset:4320
v_mfma_f32_16x16x32_bf16 v[104:107], v[240:243], v[132:135], v[104:107]
ds_read_b128 v[144:147], v32 offset:2304
v_mfma_f32_16x16x32_bf16 v[104:107], v[180:183], v[124:127], v[104:107]
ds_read_b128 v[192:195], v32 offset:2592
v_mfma_f32_16x16x32_bf16 v[104:107], v[212:215], v[164:167], v[104:107]
v_mfma_f32_16x16x32_bf16 v[100:103], v[180:183], v[164:167], v[100:103]
ds_read_b128 v[188:191], v32 offset:2016
v_mfma_f32_16x16x32_bf16 v[100:103], v[240:243], v[124:127], v[100:103]
v_mfma_f32_16x16x32_bf16 v[100:103], v[244:247], v[132:135], v[100:103]
s_waitcnt vmcnt(10)
v_mfma_f32_16x16x32_bf16 v[100:103], v[252:255], v[128:131], v[100:103]
ds_read_b128 v[196:199], v32 offset:1728
s_waitcnt lgkmcnt(5)
v_mfma_f32_16x16x32_bf16 v[96:99], v[48:51], v[172:175], v[96:99]
s_waitcnt lgkmcnt(4)
v_mfma_f32_16x16x32_bf16 v[96:99], v[52:55], v[184:187], v[96:99]
s_waitcnt lgkmcnt(3)
v_mfma_f32_16x16x32_bf16 v[132:135], v[200:203], v[144:147], v[96:99]
s_waitcnt lgkmcnt(2)
v_mfma_f32_16x16x32_bf16 v[132:135], v[212:215], v[192:195], v[132:135]
v_mfma_f32_16x16x32_bf16 v[92:95], v[52:55], v[172:175], v[92:95]
s_mov_b64 exec, 1
ds_add_u32 v41, v42 offset:20
s_mov_b64 exec, -1
s_waitcnt lgkmcnt(2)
v_mfma_f32_16x16x32_bf16 v[128:131], v[200:203], v[188:191], v[92:95]
v_mfma_f32_16x16x32_bf16 v[128:131], v[212:215], v[144:147], v[128:131]
v_mfma_f32_16x16x32_bf16 v[128:131], v[180:183], v[192:195], v[128:131]
s_waitcnt lgkmcnt(1)
v_mfma_f32_16x16x32_bf16 v[124:127], v[200:203], v[196:199], v[88:91]
v_mfma_f32_16x16x32_bf16 v[124:127], v[212:215], v[188:191], v[124:127]
v_mfma_f32_16x16x32_bf16 v[124:127], v[180:183], v[144:147], v[124:127]
v_mfma_f32_16x16x32_bf16 v[124:127], v[240:243], v[192:195], v[124:127]
v_mfma_f32_16x16x32_bf16 v[120:123], v[244:247], v[192:195], v[120:123]
v_mfma_f32_16x16x32_bf16 v[120:123], v[240:243], v[144:147], v[120:123]
v_mfma_f32_16x16x32_bf16 v[120:123], v[180:183], v[188:191], v[120:123]
v_mfma_f32_16x16x32_bf16 v[120:123], v[212:215], v[196:199], v[120:123]
v_mfma_f32_16x16x32_bf16 v[116:119], v[180:183], v[196:199], v[116:119]
v_mfma_f32_16x16x32_bf16 v[116:119], v[240:243], v[188:191], v[116:119]
v_mfma_f32_16x16x32_bf16 v[116:119], v[244:247], v[144:147], v[116:119]
s_waitcnt vmcnt(3)
v_cmp_ne_u32 vcc, v43, v44
v_mfma_f32_16x16x32_bf16 v[116:119], v[252:255], v[192:195], v[116:119]
v_mfma_f32_16x16x32_bf16 v[112:115], v[56:59], v[192:195], v[112:115]
v_mfma_f32_16x16x32_bf16 v[112:115], v[252:255], v[144:147], v[112:115]
ds_read_b32 v28, v41 offset:20
v_mfma_f32_16x16x32_bf16 v[112:115], v[244:247], v[188:191], v[112:115]
v_mfma_f32_16x16x32_bf16 v[112:115], v[240:243], v[196:199], v[112:115]
v_mfma_f32_16x16x32_bf16 v[108:111], v[244:247], v[196:199], v[108:111]
s_cbranch_vccnz L_fw13
L_fb13:
v_mfma_f32_16x16x32_bf16 v[108:111], v[252:255], v[188:191], v[108:111]
v_mfma_f32_16x16x32_bf16 v[108:111], v[56:59], v[144:147], v[108:111]
buffer_load_dwordx4 v[208:211], v34, s[32:35], s69 offen offset:1024
v_mfma_f32_16x16x32_bf16 v[108:111], v[136:139], v[192:195], v[108:111]
s_waitcnt lgkmcnt(0)
v_cmp_ne_u32 vcc, 4, v28
ds_read_b128 v[176:179], v32 offset:2880
v_mfma_f32_16x16x32_bf16 v[104:107], v[140:143], v[192:195], v[104:107]
ds_read_b128 v[8:11], v32 offset:3168
v_mfma_f32_16x16x32_bf16 v[104:107], v[136:139], v[144:147], v[104:107]
ds_read_b128 v[20:23], v32 offset:3456
v_mfma_f32_16x16x32_bf16 v[104:107], v[56:59], v[188:191], v[104:107]
ds_read_b128 v[204:207], v32 offset:3744
v_mfma_f32_16x16x32_bf16 v[104:107], v[252:255], v[196:199], v[104:107]
buffer_load_dwordx4 v[24:27], v34, s[32:35], s69 offen offset:2048
v_mfma_f32_16x16x32_bf16 v[100:103], v[56:59], v[196:199], v[100:103]
v_mfma_f32_16x16x32_bf16 v[100:103], v[136:139], v[188:191], v[100:103]
s_cbranch_vccnz L_slow1R
L_back1R:
v_mfma_f32_16x16x32_bf16 v[100:103], v[140:143], v[144:147], v[100:103]
v_mfma_f32_16x16x32_bf16 v[100:103], v[12:15], v[192:195], v[100:103]
buffer_load_dwordx4 v[148:151], v34, s[32:35], s69 offen offset:3072
s_waitcnt lgkmcnt(3)
v_mfma_f32_16x16x32_bf16 v[132:135], v[180:183], v[176:179], v[132:135]
s_add_u32 s69, s69, 4096
s_waitcnt lgkmcnt(2)
v_mfma_f32_16x16x32_bf16 v[132:135], v[240:243], v[8:11], v[132:135]
s_waitcnt lgkmcnt(1)
v_mfma_f32_16x16x32_bf16 v[132:135], v[244:247], v[20:23], v[132:135]
ds_write_b128 v35, v[64:67] offset:0
s_waitcnt lgkmcnt(1)
v_mfma_f32_16x16x32_bf16 v[132:135], v[252:255], v[204:207], v[132:135]
buffer_load_dwordx4 v[160:163], v34, s[32:35], s69 offen offset:0
v_mfma_f32_16x16x32_bf16 v[128:131], v[56:59], v[204:207], v[128:131]
v_mfma_f32_16x16x32_bf16 v[128:131], v[252:255], v[20:23], v[128:131]
v_mfma_f32_16x16x32_bf16 v[128:131], v[244:247], v[8:11], v[128:131]
v_mfma_f32_16x16x32_bf16 v[128:131], v[240:243], v[176:179], v[128:131]
buffer_load_dwordx4 v[152:155], v34, s[32:35], s69 offen offset:1024
v_mfma_f32_16x16x32_bf16 v[124:127], v[244:247], v[176:179], v[124:127]
v_mfma_f32_16x16x32_bf16 v[124:127], v[252:255], v[8:11], v[124:127]
v_mfma_f32_16x16x32_bf16 v[124:127], v[56:59], v[20:23], v[124:127]
v_mfma_f32_16x16x32_bf16 v[124:127], v[136:139], v[204:207], v[124:127]
ds_write_b128 v35, v[68:71] offset:1024
v_mfma_f32_16x16x32_bf16 v[120:123], v[140:143], v[204:207], v[120:123]
buffer_load_dwordx4 v[248:251], v34, s[32:35], s69 offen offset:2048
v_mfma_f32_16x16x32_bf16 v[120:123], v[136:139], v[20:23], v[120:123]
v_mfma_f32_16x16x32_bf16 v[120:123], v[56:59], v[8:11], v[120:123]
v_mfma_f32_16x16x32_bf16 v[120:123], v[252:255], v[176:179], v[120:123]
v_mfma_f32_16x16x32_bf16 v[116:119], v[56:59], v[176:179], v[116:119]
buffer_load_dwordx4 v[4:7], v34, s[32:35], s69 offen offset:3072
v_mfma_f32_16x16x32_bf16 v[116:119], v[136:139], v[8:11], v[116:119]
s_add_u32 s69, s69, 4096
v_mfma_f32_16x16x32_bf16 v[116:119], v[140:143], v[20:23], v[116:119]
v_mfma_f32_16x16x32_bf16 v[116:119], v[12:15], v[204:207], v[116:119]
v_mfma_f32_16x16x32_bf16 v[112:115], v[16:19], v[204:207], v[112:115]
ds_write_b128 v35, v[72:75] offset:2048
v_mfma_f32_16x16x32_bf16 v[112:115], v[12:15], v[20:23], v[112:115]
buffer_load_dwordx4 v[164:167], v34, s[32:35], s69 offen offset:0
v_mfma_f32_16x16x32_bf16 v[112:115], v[140:143], v[8:11], v[112:115]
v_mfma_f32_16x16x32_bf16 v[112:115], v[136:139], v[176:179], v[112:115]
v_mfma_f32_16x16x32_bf16 v[108:111], v[140:143], v[176:179], v[108:111]
v_mfma_f32_16x16x32_bf16 v[108:111], v[12:15], v[8:11], v[108:111]
buffer_load_dwordx4 v[48:51], v34, s[32:35], s69 offen offset:1024
v_mfma_f32_16x16x32_bf16 v[108:111], v[16:19], v[20:23], v[108:111]
v_mfma_f32_16x16x32_bf16 v[108:111], v[156:159], v[204:207], v[108:111]
ds_read_b128 v[184:187], v32 offset:4032
s_waitcnt vmcnt(11)
v_mfma_f32_16x16x32_bf16 v[104:107], v[216:219], v[204:207], v[104:107]
ds_read_b128 v[172:175], v32 offset:4320
v_mfma_f32_16x16x32_bf16 v[104:107], v[156:159], v[20:23], v[104:107]
ds_write_b128 v35, v[76:79] offset:3072
v_mfma_f32_16x16x32_bf16 v[104:107], v[16:19], v[8:11], v[104:107]
ds_read_b128 v[52:55], v32 offset:4608
ds_read_b128 v[200:203], v32 offset:4896
v_mfma_f32_16x16x32_bf16 v[104:107], v[12:15], v[176:179], v[104:107]
buffer_load_dwordx4 v[212:215], v34, s[32:35], s69 offen offset:2048
v_mfma_f32_16x16x32_bf16 v[100:103], v[16:19], v[176:179], v[100:103]
v_mfma_f32_16x16x32_bf16 v[100:103], v[156:159], v[8:11], v[100:103]
v_mfma_f32_16x16x32_bf16 v[100:103], v[216:219], v[20:23], v[100:103]
s_waitcnt vmcnt(11)
v_mfma_f32_16x16x32_bf16 v[100:103], v[220:223], v[204:207], v[100:103]
buffer_load_dwordx4 v[196:199], v34, s[32:35], s69 offen offset:3072
s_waitcnt lgkmcnt(4)
v_mfma_f32_16x16x32_bf16 v[132:135], v[56:59], v[184:187], v[132:135]
s_add_u32 s69, s69, 4096
s_waitcnt lgkmcnt(3)
v_mfma_f32_16x16x32_bf16 v[132:135], v[136:139], v[172:175], v[132:135]
s_waitcnt lgkmcnt(1)
v_mfma_f32_16x16x32_bf16 v[132:135], v[140:143], v[52:55], v[132:135]
ds_write_b128 v35, v[80:83] offset:4096
s_waitcnt lgkmcnt(1)
v_mfma_f32_16x16x32_bf16 v[132:135], v[12:15], v[200:203], v[132:135]
buffer_load_dwordx4 v[188:191], v34, s[32:35], s69 offen offset:0
v_mfma_f32_16x16x32_bf16 v[128:131], v[16:19], v[200:203], v[128:131]
v_mfma_f32_16x16x32_bf16 v[128:131], v[12:15], v[52:55], v[128:131]
v_mfma_f32_16x16x32_bf16 v[128:131], v[140:143], v[172:175], v[128:131]
v_mfma_f32_16x16x32_bf16 v[128:131], v[136:139], v[184:187], v[128:131]
buffer_load_dwordx4 v[144:147], v34, s[32:35], s69 offen offset:1024
v_mfma_f32_16x16x32_bf16 v[124:127], v[140:143], v[184:187], v[124:127]
v_mfma_f32_16x16x32_bf16 v[124:127], v[12:15], v[172:175], v[124:127]
v_mfma_f32_16x16x32_bf16 v[124:127], v[16:19], v[52:55], v[124:127]
v_mfma_f32_16x16x32_bf16 v[124:127], v[156:159], v[200:203], v[124:127]
ds_write_b128 v35, v[84:87] offset:5120
v_mfma_f32_16x16x32_bf16 v[120:123], v[216:219], v[200:203], v[120:123]
buffer_load_dwordx4 v[192:195], v34, s[32:35], s69 offen offset:2048
v_mfma_f32_16x16x32_bf16 v[120:123], v[156:159], v[52:55], v[120:123]
v_mfma_f32_16x16x32_bf16 v[120:123], v[16:19], v[172:175], v[120:123]
v_mfma_f32_16x16x32_bf16 v[120:123], v[12:15], v[184:187], v[120:123]
v_mfma_f32_16x16x32_bf16 v[116:119], v[16:19], v[184:187], v[116:119]
buffer_load_dwordx4 v[180:183], v34, s[32:35], s69 offen offset:3072
v_mfma_f32_16x16x32_bf16 v[116:119], v[156:159], v[172:175], v[116:119]
s_add_u32 s69, s69, 4096
v_mfma_f32_16x16x32_bf16 v[116:119], v[216:219], v[52:55], v[116:119]
ds_read_b128 v[240:243], v32 offset:640
v_mfma_f32_16x16x32_bf16 v[116:119], v[220:223], v[200:203], v[116:119]
s_waitcnt vmcnt(15)
v_mfma_f32_16x16x32_bf16 v[112:115], v[168:171], v[200:203], v[112:115]
ds_write_b128 v35, v[88:91] offset:6144
v_mfma_f32_16x16x32_bf16 v[112:115], v[220:223], v[52:55], v[112:115]
ds_read_b128 v[244:247], v32 offset:352
v_mfma_f32_16x16x32_bf16 v[112:115], v[216:219], v[172:175], v[112:115]
v_mfma_f32_16x16x32_bf16 v[112:115], v[156:159], v[184:187], v[112:115]
v_mfma_f32_16x16x32_bf16 v[108:111], v[216:219], v[184:187], v[108:111]
ds_read_b128 v[252:255], v32 offset:64
v_mfma_f32_16x16x32_bf16 v[108:111], v[220:223], v[172:175], v[108:111]
v_mfma_f32_16x16x32_bf16 v[108:111], v[168:171], v[52:55], v[108:111]
s_waitcnt lgkmcnt(3)
s_waitcnt vmcnt(14)
v_mfma_f32_16x16x32_bf16 v[108:111], v[208:211], v[240:243], v[108:111]
ds_read_b128 v[176:179], v32 offset:5184
s_waitcnt vmcnt(13)
v_mfma_f32_16x16x32_bf16 v[104:107], v[24:27], v[240:243], v[104:107]
ds_read_b128 v[8:11], v32 offset:5472
s_waitcnt lgkmcnt(3)
v_mfma_f32_16x16x32_bf16 v[104:107], v[208:211], v[244:247], v[104:107]
ds_write_b128 v35, v[92:95] offset:7168
v_mfma_f32_16x16x32_bf16 v[104:107], v[168:171], v[172:175], v[104:107]
ds_read_b128 v[20:23], v32 offset:5760
ds_read_b128 v[204:207], v32 offset:6048
v_mfma_f32_16x16x32_bf16 v[104:107], v[220:223], v[184:187], v[104:107]
v_mfma_f32_16x16x32_bf16 v[100:103], v[168:171], v[184:187], v[100:103]
s_waitcnt lgkmcnt(5)
v_mfma_f32_16x16x32_bf16 v[100:103], v[208:211], v[252:255], v[100:103]
v_mfma_f32_16x16x32_bf16 v[100:103], v[24:27], v[244:247], v[100:103]
s_waitcnt vmcnt(12)
v_mfma_f32_16x16x32_bf16 v[100:103], v[148:151], v[240:243], v[100:103]
s_waitcnt lgkmcnt(4)
v_mfma_f32_16x16x32_bf16 v[132:135], v[16:19], v[176:179], v[132:135]
s_waitcnt lgkmcnt(3)
v_mfma_f32_16x16x32_bf16 v[132:135], v[156:159], v[8:11], v[132:135]
s_waitcnt lgkmcnt(1)
v_mfma_f32_16x16x32_bf16 v[132:135], v[216:219], v[20:23], v[132:135]
ds_write_b128 v35, v[96:99] offset:8192
s_waitcnt lgkmcnt(1)
v_mfma_f32_16x16x32_bf16 v[132:135], v[220:223], v[204:207], v[132:135]
ds_read_b128 v[56:59], v32 offset:1792
v_mfma_f32_16x16x32_bf16 v[128:131], v[168:171], v[204:207], v[128:131]
s_mov_b32 s97, 26624
buffer_load_dword v44, v40, s[32:35], s97 offen
v_mfma_f32_16x16x32_bf16 v[128:131], v[220:223], v[20:23], v[128:131]
ds_read_b128 v[136:139], v32 offset:1504
v_mfma_f32_16x16x32_bf16 v[128:131], v[216:219], v[8:11], v[128:131]
v_mfma_f32_16x16x32_bf16 v[128:131], v[156:159], v[176:179], v[128:131]
v_mfma_f32_16x16x32_bf16 v[124:127], v[216:219], v[176:179], v[124:127]
ds_read_b128 v[140:143], v32 offset:1216
v_mfma_f32_16x16x32_bf16 v[124:127], v[220:223], v[8:11], v[124:127]
s_mov_b64 exec, 1
ds_add_u32 v45, v42 offset:24
s_mov_b64 exec, -1
v_mfma_f32_16x16x32_bf16 v[124:127], v[168:171], v[20:23], v[124:127]
s_waitcnt lgkmcnt(3)
v_mfma_f32_16x16x32_bf16 v[124:127], v[208:211], v[56:59], v[124:127]
v_mfma_f32_16x16x32_bf16 v[120:123], v[24:27], v[56:59], v[120:123]
s_waitcnt lgkmcnt(2)
v_mfma_f32_16x16x32_bf16 v[120:123], v[208:211], v[136:139], v[120:123]
v_mfma_f32_16x16x32_bf16 v[120:123], v[168:171], v[8:11], v[120:123]
ds_read_b128 v[12:15], v32 offset:928
v_mfma_f32_16x16x32_bf16 v[120:123], v[220:223], v[176:179], v[120:123]
v_mfma_f32_16x16x32_bf16 v[116:119], v[168:171], v[176:179], v[116:119]
s_waitcnt lgkmcnt(2)
v_mfma_f32_16x16x32_bf16 v[116:119], v[208:211], v[140:143], v[116:119]
v_mfma_f32_16x16x32_bf16 v[116:119], v[24:27], v[136:139], v[116:119]
v_mfma_f32_16x16x32_bf16 v[116:119], v[148:151], v[56:59], v[116:119]
s_waitcnt vmcnt(12)
v_mfma_f32_16x16x32_bf16 v[112:115], v[160:163], v[56:59], v[112:115]
v_mfma_f32_16x16x32_bf16 v[112:115], v[148:151], v[136:139], v[112:115]
v_mfma_f32_16x16x32_bf16 v[112:115], v[24:27], v[140:143], v[112:115]
s_waitcnt lgkmcnt(0)
v_mfma_f32_16x16x32_bf16 v[112:115], v[208:211], v[12:15], v[112:115]
v_mfma_f32_16x16x32_bf16 v[108:111], v[24:27], v[12:15], v[108:111]
v_mfma_f32_16x16x32_bf16 v[108:111], v[148:151], v[140:143], v[108:111]
v_mfma_f32_16x16x32_bf16 v[108:111], v[160:163], v[136:139], v[108:111]
s_waitcnt vmcnt(11)
v_mfma_f32_16x16x32_bf16 v[108:111], v[152:155], v[56:59], v[108:111]
ds_read_b128 v[200:203], v32 offset:6336
s_waitcnt vmcnt(10)
v_mfma_f32_16x16x32_bf16 v[104:107], v[248:251], v[56:59], v[104:107]
ds_read_b128 v[52:55], v32 offset:2368
v_mfma_f32_16x16x32_bf16 v[104:107], v[152:155], v[136:139], v[104:107]
ds_read_b128 v[172:175], v32 offset:2656
v_mfma_f32_16x16x32_bf16 v[104:107], v[160:163], v[140:143], v[104:107]
ds_read_b32 v28, v45 offset:24
v_mfma_f32_16x16x32_bf16 v[104:107], v[148:151], v[12:15], v[104:107]
ds_read_b128 v[184:187], v32 offset:2944
v_mfma_f32_16x16x32_bf16 v[100:103], v[160:163], v[12:15], v[100:103]
v_mfma_f32_16x16x32_bf16 v[100:103], v[152:155], v[140:143], v[100:103]
v_mfma_f32_16x16x32_bf16 v[100:103], v[248:251], v[136:139], v[100:103]
ds_read_b128 v[252:255], v32 offset:2080
s_waitcnt vmcnt(9)
v_mfma_f32_16x16x32_bf16 v[100:103], v[4:7], v[56:59], v[100:103]
s_waitcnt lgkmcnt(5)
v_mfma_f32_16x16x32_bf16 v[132:135], v[168:171], v[200:203], v[132:135]
s_waitcnt lgkmcnt(2)
v_cmp_ne_u32 vcc, 2, v28
v_mfma_f32_16x16x32_bf16 v[132:135], v[208:211], v[52:55], v[132:135]
v_mfma_f32_16x16x32_bf16 v[132:135], v[24:27], v[172:175], v[132:135]
s_waitcnt lgkmcnt(1)
v_mfma_f32_16x16x32_bf16 v[132:135], v[148:151], v[184:187], v[132:135]
v_mfma_f32_16x16x32_bf16 v[128:131], v[160:163], v[184:187], v[128:131]
v_mfma_f32_16x16x32_bf16 v[128:131], v[148:151], v[172:175], v[128:131]
v_mfma_f32_16x16x32_bf16 v[128:131], v[24:27], v[52:55], v[128:131]
s_cbranch_vccnz L_slow1P
L_back1P:
s_waitcnt lgkmcnt(0)
v_mfma_f32_16x16x32_bf16 v[128:131], v[208:211], v[252:255], v[128:131]
v_mfma_f32_16x16x32_bf16 v[124:127], v[24:27], v[252:255], v[124:127]
v_mfma_f32_16x16x32_bf16 v[124:127], v[148:151], v[52:55], v[124:127]
v_mfma_f32_16x16x32_bf16 v[124:127], v[160:163], v[172:175], v[124:127]
v_mfma_f32_16x16x32_bf16 v[124:127], v[152:155], v[184:187], v[124:127]
v_mfma_f32_16x16x32_bf16 v[120:123], v[248:251], v[184:187], v[120:123]
v_mfma_f32_16x16x32_bf16 v[120:123], v[152:155], v[172:175], v[120:123]
v_mfma_f32_16x16x32_bf16 v[120:123], v[160:163], v[52:55], v[120:123]
v_mfma_f32_16x16x32_bf16 v[120:123], v[148:151], v[252:255], v[120:123]
v_mfma_f32_16x16x32_bf16 v[116:119], v[160:163], v[252:255], v[116:119]
v_mfma_f32_16x16x32_bf16 v[116:119], v[152:155], v[52:55], v[116:119]
v_mfma_f32_16x16x32_bf16 v[116:119], v[248:251], v[172:175], v[116:119]
s_waitcnt vmcnt(0)
v_cmp_ne_u32 vcc, v43, v44
v_mfma_f32_16x16x32_bf16 v[116:119], v[4:7], v[184:187], v[116:119]
v_mfma_f32_16x16x32_bf16 v[112:115], v[164:167], v[184:187], v[112:115]
v_mfma_f32_16x16x32_bf16 v[112:115], v[4:7], v[172:175], v[112:115]
v_mfma_f32_16x16x32_bf16 v[112:115], v[248:251], v[52:55], v[112:115]
v_mfma_f32_16x16x32_bf16 v[112:115], v[152:155], v[252:255], v[112:115]
v_mfma_f32_16x16x32_bf16 v[108:111], v[248:251], v[252:255], v[108:111]
s_cbranch_vccnz L_fw14
L_fb14:
v_mfma_f32_16x16x32_bf16 v[108:111], v[4:7], v[52:55], v[108:111]
v_mfma_f32_16x16x32_bf16 v[108:111], v[164:167], v[172:175], v[108:111]
buffer_load_dwordx4 v[244:247], v34, s[32:35], s69 offen offset:0
v_mfma_f32_16x16x32_bf16 v[108:111], v[48:51], v[184:187], v[108:111]
ds_read_b128 v[240:243], v32 offset:3232
v_mfma_f32_16x16x32_bf16 v[104:107], v[212:215], v[184:187], v[104:107]
ds_read_b128 v[232:235], v36 offset:2048
v_mfma_f32_16x16x32_bf16 v[104:107], v[48:51], v[172:175], v[104:107]
ds_read_b128 v[16:19], v32 offset:3520
ds_read_b128 v[204:207], v32 offset:3808
v_mfma_f32_16x16x32_bf16 v[104:107], v[164:167], v[52:55], v[104:107]
ds_read_b128 v[156:159], v32 offset:4096
v_mfma_f32_16x16x32_bf16 v[104:107], v[4:7], v[252:255], v[104:107]
buffer_load_dwordx4 v[216:219], v34, s[32:35], s69 offen offset:1024
v_mfma_f32_16x16x32_bf16 v[100:103], v[164:167], v[252:255], v[100:103]
ds_read_b128 v[228:231], v36 offset:1024
v_mfma_f32_16x16x32_bf16 v[100:103], v[48:51], v[52:55], v[100:103]
v_mfma_f32_16x16x32_bf16 v[100:103], v[212:215], v[172:175], v[100:103]
v_mfma_f32_16x16x32_bf16 v[100:103], v[196:199], v[184:187], v[100:103]
buffer_load_dwordx4 v[20:23], v34, s[32:35], s69 offen offset:2048
s_waitcnt lgkmcnt(5)
v_mfma_f32_16x16x32_bf16 v[132:135], v[160:163], v[240:243], v[132:135]
s_waitcnt lgkmcnt(4)
v_add_f32 v108, v108, v232
v_add_f32 v109, v109, v233
s_waitcnt lgkmcnt(3)
v_mfma_f32_16x16x32_bf16 v[132:135], v[152:155], v[16:19], v[132:135]
v_add_f32 v110, v110, v234
v_add_f32 v111, v111, v235
s_waitcnt lgkmcnt(2)
v_mfma_f32_16x16x32_bf16 v[132:135], v[248:251], v[204:207], v[132:135]
ds_read_b128 v[224:227], v36 offset:0
s_waitcnt lgkmcnt(2)
v_mfma_f32_16x16x32_bf16 v[132:135], v[4:7], v[156:159], v[132:135]
buffer_load_dwordx4 v[8:11], v34, s[32:35], s69 offen offset:3072
v_mfma_f32_16x16x32_bf16 v[128:131], v[164:167], v[156:159], v[128:131]
s_add_u32 s69, s69, 4096
s_waitcnt lgkmcnt(1)
v_add_f32 v104, v104, v228
v_add_f32 v105, v105, v229
v_mfma_f32_16x16x32_bf16 v[128:131], v[4:7], v[204:207], v[128:131]
v_add_f32 v106, v106, v230
v_add_f32 v107, v107, v231
v_mfma_f32_16x16x32_bf16 v[128:131], v[248:251], v[16:19], v[128:131]
v_mfma_f32_16x16x32_bf16 v[128:131], v[152:155], v[240:243], v[128:131]
buffer_load_dwordx4 v[220:223], v34, s[32:35], s69 offen offset:0
v_mfma_f32_16x16x32_bf16 v[124:127], v[248:251], v[240:243], v[124:127]
s_waitcnt lgkmcnt(0)
v_add_f32 v100, v100, v224
v_add_f32 v101, v101, v225
v_mfma_f32_16x16x32_bf16 v[124:127], v[4:7], v[16:19], v[124:127]
v_add_f32 v102, v102, v226
v_add_f32 v103, v103, v227
v_mfma_f32_16x16x32_bf16 v[124:127], v[164:167], v[204:207], v[124:127]
v_mfma_f32_16x16x32_bf16 v[124:127], v[48:51], v[156:159], v[124:127]
buffer_load_dwordx4 v[176:179], v34, s[32:35], s69 offen offset:1024
v_mfma_f32_16x16x32_bf16 v[120:123], v[212:215], v[156:159], v[120:123]
v_mfma_f32_16x16x32_bf16 v[120:123], v[48:51], v[204:207], v[120:123]
v_mfma_f32_16x16x32_bf16 v[120:123], v[164:167], v[16:19], v[120:123]
v_mfma_f32_16x16x32_bf16 v[120:123], v[4:7], v[240:243], v[120:123]
buffer_load_dwordx4 v[64:67], v34, s[32:35], s69 offen offset:2048
v_mfma_f32_16x16x32_bf16 v[116:119], v[164:167], v[240:243], v[116:119]
v_mfma_f32_16x16x32_bf16 v[116:119], v[48:51], v[16:19], v[116:119]
v_mfma_f32_16x16x32_bf16 v[116:119], v[212:215], v[204:207], v[116:119]
v_mfma_f32_16x16x32_bf16 v[116:119], v[196:199], v[156:159], v[116:119]
buffer_load_dwordx4 v[68:71], v34, s[32:35], s69 offen offset:3072
v_mfma_f32_16x16x32_bf16 v[112:115], v[188:191], v[156:159], v[112:115]
s_add_u32 s69, s69, 4096
ds_read_b128 v[224:227], v36 offset:4096
v_mfma_f32_16x16x32_bf16 v[112:115], v[196:199], v[204:207], v[112:115]
v_mfma_f32_16x16x32_bf16 v[112:115], v[212:215], v[16:19], v[112:115]
v_mfma_f32_16x16x32_bf16 v[112:115], v[48:51], v[240:243], v[112:115]
buffer_load_dwordx4 v[72:75], v34, s[32:35], s69 offen offset:0
v_mfma_f32_16x16x32_bf16 v[108:111], v[212:215], v[240:243], v[108:111]
ds_read_b128 v[236:239], v36 offset:3072
v_mfma_f32_16x16x32_bf16 v[108:111], v[196:199], v[16:19], v[108:111]
v_mfma_f32_16x16x32_bf16 v[108:111], v[188:191], v[204:207], v[108:111]
v_mfma_f32_16x16x32_bf16 v[108:111], v[144:147], v[156:159], v[108:111]
ds_read_b128 v[76:79], v32 offset:4384
v_mfma_f32_16x16x32_bf16 v[104:107], v[192:195], v[156:159], v[104:107]
s_waitcnt lgkmcnt(2)
v_add_f32 v116, v116, v224
v_add_f32 v117, v117, v225
v_mfma_f32_16x16x32_bf16 v[104:107], v[144:147], v[204:207], v[104:107]
v_add_f32 v118, v118, v226
v_add_f32 v119, v119, v227
v_mfma_f32_16x16x32_bf16 v[104:107], v[188:191], v[16:19], v[104:107]
ds_read_b128 v[80:83], v32 offset:4672
ds_read_b128 v[84:87], v32 offset:4960
v_mfma_f32_16x16x32_bf16 v[104:107], v[196:199], v[240:243], v[104:107]
ds_read_b128 v[88:91], v32 offset:5248
v_mfma_f32_16x16x32_bf16 v[100:103], v[188:191], v[240:243], v[100:103]
s_waitcnt lgkmcnt(4)
v_add_f32 v112, v112, v236
v_add_f32 v113, v113, v237
v_mfma_f32_16x16x32_bf16 v[100:103], v[144:147], v[16:19], v[100:103]
v_add_f32 v114, v114, v238
v_add_f32 v115, v115, v239
v_mfma_f32_16x16x32_bf16 v[100:103], v[192:195], v[204:207], v[100:103]
buffer_load_dwordx4 v[92:95], v34, s[32:35], s69 offen offset:1024
v_mfma_f32_16x16x32_bf16 v[100:103], v[180:183], v[156:159], v[100:103]
s_waitcnt lgkmcnt(3)
v_mfma_f32_16x16x32_bf16 v[132:135], v[164:167], v[76:79], v[132:135]
s_waitcnt lgkmcnt(2)
v_mfma_f32_16x16x32_bf16 v[132:135], v[48:51], v[80:83], v[132:135]
s_waitcnt lgkmcnt(1)
v_mfma_f32_16x16x32_bf16 v[132:135], v[212:215], v[84:87], v[132:135]
buffer_load_dwordx4 v[96:99], v34, s[32:35], s69 offen offset:2048
s_waitcnt lgkmcnt(0)
v_mfma_f32_16x16x32_bf16 v[132:135], v[196:199], v[88:91], v[132:135]
v_mfma_f32_16x16x32_bf16 v[128:131], v[188:191], v[88:91], v[128:131]
v_mfma_f32_16x16x32_bf16 v[128:131], v[196:199], v[84:87], v[128:131]
v_mfma_f32_16x16x32_bf16 v[128:131], v[212:215], v[80:83], v[128:131]
buffer_load_dwordx4 v[12:15], v34, s[32:35], s69 offen offset:3072
v_mfma_f32_16x16x32_bf16 v[128:131], v[48:51], v[76:79], v[128:131]
s_add_u32 s69, s69, 4096
v_mfma_f32_16x16x32_bf16 v[124:127], v[212:215], v[76:79], v[124:127]
ds_read_b128 v[236:239], v36 offset:7168
v_mfma_f32_16x16x32_bf16 v[124:127], v[196:199], v[80:83], v[124:127]
v_mfma_f32_16x16x32_bf16 v[124:127], v[188:191], v[84:87], v[124:127]
buffer_load_dwordx4 v[140:143], v34, s[32:35], s69 offen offset:0
v_mfma_f32_16x16x32_bf16 v[124:127], v[144:147], v[88:91], v[124:127]
ds_read_b128 v[136:139], v32 offset:992
v_mfma_f32_16x16x32_bf16 v[120:123], v[192:195], v[88:91], v[120:123]
ds_read_b128 v[232:235], v36 offset:6144
v_mfma_f32_16x16x32_bf16 v[120:123], v[144:147], v[84:87], v[120:123]
v_mfma_f32_16x16x32_bf16 v[120:123], v[188:191], v[80:83], v[120:123]
buffer_load_dwordx4 v[56:59], v34, s[32:35], s69 offen offset:1024
v_mfma_f32_16x16x32_bf16 v[120:123], v[196:199], v[76:79], v[120:123]
v_mfma_f32_16x16x32_bf16 v[116:119], v[188:191], v[76:79], v[116:119]
s_waitcnt lgkmcnt(2)
v_add_f32 v128, v128, v236
v_add_f32 v129, v129, v237
v_mfma_f32_16x16x32_bf16 v[116:119], v[144:147], v[80:83], v[116:119]
v_add_f32 v130, v130, v238
v_add_f32 v131, v131, v239
v_mfma_f32_16x16x32_bf16 v[116:119], v[192:195], v[84:87], v[116:119]
ds_read_b128 v[228:231], v36 offset:5120
v_mfma_f32_16x16x32_bf16 v[116:119], v[180:183], v[88:91], v[116:119]
ds_read_b128 v[168:171], v32 offset:704
s_waitcnt lgkmcnt(3)
s_waitcnt vmcnt(13)
v_mfma_f32_16x16x32_bf16 v[112:115], v[244:247], v[136:139], v[112:115]
s_waitcnt lgkmcnt(2)
v_add_f32 v124, v124, v232
v_add_f32 v125, v125, v233
v_mfma_f32_16x16x32_bf16 v[112:115], v[180:183], v[84:87], v[112:115]
v_add_f32 v126, v126, v234
v_add_f32 v127, v127, v235
v_mfma_f32_16x16x32_bf16 v[112:115], v[192:195], v[80:83], v[112:115]
ds_read_b128 v[200:203], v32 offset:416
v_mfma_f32_16x16x32_bf16 v[112:115], v[144:147], v[76:79], v[112:115]
ds_read_b128 v[208:211], v32 offset:128
v_mfma_f32_16x16x32_bf16 v[108:111], v[192:195], v[76:79], v[108:111]
s_waitcnt lgkmcnt(3)
v_add_f32 v120, v120, v228
v_add_f32 v121, v121, v229
v_mfma_f32_16x16x32_bf16 v[108:111], v[180:183], v[80:83], v[108:111]
v_add_f32 v122, v122, v230
v_add_f32 v123, v123, v231
s_waitcnt lgkmcnt(2)
v_mfma_f32_16x16x32_bf16 v[108:111], v[244:247], v[168:171], v[108:111]
buffer_load_dwordx4 v[24:27], v34, s[32:35], s69 offen offset:2048
s_waitcnt vmcnt(13)
v_mfma_f32_16x16x32_bf16 v[108:111], v[216:219], v[136:139], v[108:111]
ds_read_b128 v[148:151], v32 offset:5536
s_waitcnt vmcnt(12)
v_mfma_f32_16x16x32_bf16 v[104:107], v[20:23], v[136:139], v[104:107]
ds_read_b128 v[252:255], v32 offset:5824
v_mfma_f32_16x16x32_bf16 v[104:107], v[216:219], v[168:171], v[104:107]
ds_read_b128 v[52:55], v32 offset:6112
s_waitcnt lgkmcnt(4)
v_mfma_f32_16x16x32_bf16 v[104:107], v[244:247], v[200:203], v[104:107]
ds_read_b128 v[172:175], v32 offset:6400
v_mfma_f32_16x16x32_bf16 v[104:107], v[180:183], v[76:79], v[104:107]
s_mov_b32 s97, 30720
buffer_load_dword v44, v46, s[32:35], s97 offen
s_waitcnt lgkmcnt(4)
v_mfma_f32_16x16x32_bf16 v[100:103], v[244:247], v[208:211], v[100:103]
ds_read_b128 v[184:187], v32 offset:2144
v_mfma_f32_16x16x32_bf16 v[100:103], v[216:219], v[200:203], v[100:103]
v_mfma_f32_16x16x32_bf16 v[100:103], v[20:23], v[168:171], v[100:103]
s_waitcnt vmcnt(12)
v_mfma_f32_16x16x32_bf16 v[100:103], v[8:11], v[136:139], v[100:103]
s_waitcnt lgkmcnt(4)
v_mfma_f32_16x16x32_bf16 v[132:135], v[188:191], v[148:151], v[132:135]
s_waitcnt lgkmcnt(3)
v_mfma_f32_16x16x32_bf16 v[132:135], v[144:147], v[252:255], v[132:135]
ds_read_b128 v[160:163], v32 offset:1856
s_waitcnt lgkmcnt(3)
v_mfma_f32_16x16x32_bf16 v[132:135], v[192:195], v[52:55], v[132:135]
s_waitcnt lgkmcnt(2)
v_mfma_f32_16x16x32_bf16 v[132:135], v[180:183], v[172:175], v[132:135]
s_waitcnt lgkmcnt(1)
v_mfma_f32_16x16x32_bf16 v[128:131], v[244:247], v[184:187], v[128:131]
ds_read_b128 v[224:227], v36 offset:8192
v_mfma_f32_16x16x32_bf16 v[128:131], v[180:183], v[52:55], v[128:131]
ds_read_b128 v[152:155], v32 offset:1568
v_mfma_f32_16x16x32_bf16 v[128:131], v[192:195], v[252:255], v[128:131]
v_mfma_f32_16x16x32_bf16 v[128:131], v[144:147], v[148:151], v[128:131]
ds_read_b128 v[248:251], v32 offset:1280
v_mfma_f32_16x16x32_bf16 v[124:127], v[192:195], v[148:151], v[124:127]
v_mfma_f32_16x16x32_bf16 v[124:127], v[180:183], v[252:255], v[124:127]
s_waitcnt lgkmcnt(3)
v_mfma_f32_16x16x32_bf16 v[124:127], v[244:247], v[160:163], v[124:127]
v_mfma_f32_16x16x32_bf16 v[124:127], v[216:219], v[184:187], v[124:127]
v_mfma_f32_16x16x32_bf16 v[120:123], v[20:23], v[184:187], v[120:123]
s_waitcnt lgkmcnt(2)
v_add_f32 v132, v132, v224
v_add_f32 v133, v133, v225
v_mfma_f32_16x16x32_bf16 v[120:123], v[216:219], v[160:163], v[120:123]
v_add_f32 v134, v134, v226
v_add_f32 v135, v135, v227
s_waitcnt lgkmcnt(1)
v_mfma_f32_16x16x32_bf16 v[120:123], v[244:247], v[152:155], v[120:123]
v_mfma_f32_16x16x32_bf16 v[120:123], v[180:183], v[148:151], v[120:123]
s_waitcnt lgkmcnt(0)
v_mfma_f32_16x16x32_bf16 v[116:119], v[244:247], v[248:251], v[116:119]
v_mfma_f32_16x16x32_bf16 v[116:119], v[216:219], v[152:155], v[116:119]
v_mfma_f32_16x16x32_bf16 v[116:119], v[20:23], v[160:163], v[116:119]
v_mfma_f32_16x16x32_bf16 v[116:119], v[8:11], v[184:187], v[116:119]
s_waitcnt vmcnt(11)
v_mfma_f32_16x16x32_bf16 v[112:115], v[220:223], v[184:187], v[112:115]
v_mfma_f32_16x16x32_bf16 v[112:115], v[8:11], v[160:163], v[112:115]
v_mfma_f32_16x16x32_bf16 v[112:115], v[20:23], v[152:155], v[112:115]
v_mfma_f32_16x16x32_bf16 v[112:115], v[216:219], v[248:251], v[112:115]
v_mfma_f32_16x16x32_bf16 v[108:111], v[20:23], v[248:251], v[108:111]
v_mfma_f32_16x16x32_bf16 v[108:111], v[8:11], v[152:155], v[108:111]
v_mfma_f32_16x16x32_bf16 v[108:111], v[220:223], v[160:163], v[108:111]
s_waitcnt vmcnt(10)
v_mfma_f32_16x16x32_bf16 v[108:111], v[176:179], v[184:187], v[108:111]
ds_read_b128 v[4:7], v32 offset:2432
s_waitcnt vmcnt(9)
v_mfma_f32_16x16x32_bf16 v[104:107], v[64:67], v[184:187], v[104:107]
ds_read_b128 v[240:243], v32 offset:2720
v_mfma_f32_16x16x32_bf16 v[104:107], v[176:179], v[160:163], v[104:107]
ds_read_b128 v[16:19], v32 offset:3008
v_mfma_f32_16x16x32_bf16 v[104:107], v[220:223], v[152:155], v[104:107]
ds_read_b128 v[204:207], v32 offset:3296
v_mfma_f32_16x16x32_bf16 v[104:107], v[8:11], v[248:251], v[104:107]
v_mfma_f32_16x16x32_bf16 v[100:103], v[220:223], v[248:251], v[100:103]
v_mfma_f32_16x16x32_bf16 v[100:103], v[176:179], v[152:155], v[100:103]
v_mfma_f32_16x16x32_bf16 v[100:103], v[64:67], v[160:163], v[100:103]
s_waitcnt vmcnt(8)
v_mfma_f32_16x16x32_bf16 v[100:103], v[68:71], v[184:187], v[100:103]
s_waitcnt lgkmcnt(3)
v_mfma_f32_16x16x32_bf16 v[132:135], v[244:247], v[4:7], v[132:135]
s_waitcnt lgkmcnt(2)
v_mfma_f32_16x16x32_bf16 v[132:135], v[216:219], v[240:243], v[132:135]
s_waitcnt lgkmcnt(1)
v_mfma_f32_16x16x32_bf16 v[132:135], v[20:23], v[16:19], v[132:135]
s_waitcnt lgkmcnt(0)
v_mfma_f32_16x16x32_bf16 v[132:135], v[8:11], v[204:207], v[132:135]
v_mfma_f32_16x16x32_bf16 v[128:131], v[220:223], v[204:207], v[128:131]
v_mfma_f32_16x16x32_bf16 v[128:131], v[8:11], v[16:19], v[128:131]
v_mfma_f32_16x16x32_bf16 v[128:131], v[20:23], v[240:243], v[128:131]
v_mfma_f32_16x16x32_bf16 v[128:131], v[216:219], v[4:7], v[128:131]
v_mfma_f32_16x16x32_bf16 v[124:127], v[20:23], v[4:7], v[124:127]
v_mfma_f32_16x16x32_bf16 v[124:127], v[8:11], v[240:243], v[124:127]
s_waitcnt vmcnt(0)
v_cmp_ne_u32 vcc, v43, v44
v_mfma_f32_16x16x32_bf16 v[124:127], v[220:223], v[16:19], v[124:127]
v_mfma_f32_16x16x32_bf16 v[124:127], v[176:179], v[204:207], v[124:127]
v_mfma_f32_16x16x32_bf16 v[120:123], v[64:67], v[204:207], v[120:123]
v_mfma_f32_16x16x32_bf16 v[120:123], v[176:179], v[16:19], v[120:123]
v_mfma_f32_16x16x32_bf16 v[120:123], v[220:223], v[240:243], v[120:123]
v_mfma_f32_16x16x32_bf16 v[120:123], v[8:11], v[4:7], v[120:123]
s_cbranch_vccnz L_fw15
L_fb15:
v_mfma_f32_16x16x32_bf16 v[116:119], v[220:223], v[4:7], v[116:119]
v_mfma_f32_16x16x32_bf16 v[116:119], v[176:179], v[240:243], v[116:119]
buffer_load_dwordx4 v[156:159], v34, s[32:35], s69 offen offset:3072
v_mfma_f32_16x16x32_bf16 v[116:119], v[64:67], v[16:19], v[116:119]
s_add_u32 s69, s69, 4096
v_mfma_f32_16x16x32_bf16 v[116:119], v[68:71], v[204:207], v[116:119]
v_mfma_f32_16x16x32_bf16 v[112:115], v[72:75], v[204:207], v[112:115]
s_mov_b64 exec, 1
ds_add_u32 v41, v42 offset:4
s_mov_b64 exec, -1
v_mfma_f32_16x16x32_bf16 v[112:115], v[68:71], v[16:19], v[112:115]
buffer_load_dwordx4 v[164:167], v34, s[32:35], s69 offen offset:0
v_mfma_f32_16x16x32_bf16 v[112:115], v[64:67], v[240:243], v[112:115]
v_mfma_f32_16x16x32_bf16 v[112:115], v[176:179], v[4:7], v[112:115]
v_mfma_f32_16x16x32_bf16 v[108:111], v[64:67], v[4:7], v[108:111]
v_mfma_f32_16x16x32_bf16 v[108:111], v[68:71], v[240:243], v[108:111]
buffer_load_dwordx4 v[48:51], v34, s[32:35], s69 offen offset:1024
v_mfma_f32_16x16x32_bf16 v[108:111], v[72:75], v[16:19], v[108:111]
v_mfma_f32_16x16x32_bf16 v[108:111], v[92:95], v[204:207], v[108:111]
ds_read_b128 v[212:215], v32 offset:3584
v_mfma_f32_16x16x32_bf16 v[104:107], v[96:99], v[204:207], v[104:107]
ds_read_b128 v[196:199], v32 offset:3872
v_mfma_f32_16x16x32_bf16 v[104:107], v[92:95], v[16:19], v[104:107]
ds_read_b128 v[88:91], v32 offset:4160
v_mfma_f32_16x16x32_bf16 v[104:107], v[72:75], v[240:243], v[104:107]
ds_read_b128 v[84:87], v32 offset:4448
v_mfma_f32_16x16x32_bf16 v[104:107], v[68:71], v[4:7], v[104:107]
buffer_load_dwordx4 v[80:83], v34, s[32:35], s69 offen offset:2048
v_mfma_f32_16x16x32_bf16 v[100:103], v[72:75], v[4:7], v[100:103]
v_mfma_f32_16x16x32_bf16 v[100:103], v[92:95], v[240:243], v[100:103]
v_mfma_f32_16x16x32_bf16 v[100:103], v[96:99], v[16:19], v[100:103]
v_mfma_f32_16x16x32_bf16 v[100:103], v[12:15], v[204:207], v[100:103]
buffer_load_dwordx4 v[76:79], v34, s[32:35], s69 offen offset:3072
s_waitcnt lgkmcnt(3)
v_mfma_f32_16x16x32_bf16 v[132:135], v[220:223], v[212:215], v[132:135]
s_add_u32 s69, s69, 4096
s_waitcnt lgkmcnt(2)
v_mfma_f32_16x16x32_bf16 v[132:135], v[176:179], v[196:199], v[132:135]
s_waitcnt lgkmcnt(1)
v_mfma_f32_16x16x32_bf16 v[132:135], v[64:67], v[88:91], v[132:135]
s_waitcnt lgkmcnt(0)
v_mfma_f32_16x16x32_bf16 v[132:135], v[68:71], v[84:87], v[132:135]
buffer_load_dwordx4 v[208:211], v34, s[32:35], s69 offen offset:0
v_mfma_f32_16x16x32_bf16 v[128:131], v[72:75], v[84:87], v[128:131]
v_mfma_f32_16x16x32_bf16 v[128:131], v[68:71], v[88:91], v[128:131]
v_mfma_f32_16x16x32_bf16 v[128:131], v[64:67], v[196:199], v[128:131]
v_mfma_f32_16x16x32_bf16 v[128:131], v[176:179], v[212:215], v[128:131]
buffer_load_dwordx4 v[200:203], v34, s[32:35], s69 offen offset:1024
v_mfma_f32_16x16x32_bf16 v[124:127], v[64:67], v[212:215], v[124:127]
v_mfma_f32_16x16x32_bf16 v[124:127], v[68:71], v[196:199], v[124:127]
v_mfma_f32_16x16x32_bf16 v[124:127], v[72:75], v[88:91], v[124:127]
v_mfma_f32_16x16x32_bf16 v[124:127], v[92:95], v[84:87], v[124:127]
buffer_load_dwordx4 v[168:171], v34, s[32:35], s69 offen offset:2048
v_mfma_f32_16x16x32_bf16 v[120:123], v[96:99], v[84:87], v[120:123]
v_mfma_f32_16x16x32_bf16 v[120:123], v[92:95], v[88:91], v[120:123]
v_mfma_f32_16x16x32_bf16 v[120:123], v[72:75], v[196:199], v[120:123]
v_mfma_f32_16x16x32_bf16 v[120:123], v[68:71], v[212:215], v[120:123]
buffer_load_dwordx4 v[136:139], v34, s[32:35], s69 offen offset:3072
v_mfma_f32_16x16x32_bf16 v[116:119], v[72:75], v[212:215], v[116:119]
s_add_u32 s69, s69, 4096
v_mfma_f32_16x16x32_bf16 v[116:119], v[92:95], v[196:199], v[116:119]
v_mfma_f32_16x16x32_bf16 v[116:119], v[96:99], v[88:91], v[116:119]
v_mfma_f32_16x16x32_bf16 v[116:119], v[12:15], v[84:87], v[116:119]
buffer_load_dwordx4 v[188:191], v34, s[32:35], s69 offen offset:0
v_mfma_f32_16x16x32_bf16 v[112:115], v[140:143], v[84:87], v[112:115]
v_mfma_f32_16x16x32_bf16 v[112:115], v[12:15], v[88:91], v[112:115]
v_mfma_f32_16x16x32_bf16 v[112:115], v[96:99], v[196:199], v[112:115]
v_mfma_f32_16x16x32_bf16 v[112:115], v[92:95], v[212:215], v[112:115]
buffer_load_dwordx4 v[172:175], v34, s[32:35], s69 offen offset:1024
v_mfma_f32_16x16x32_bf16 v[108:111], v[96:99], v[212:215], v[108:111]
v_mfma_f32_16x16x32_bf16 v[108:111], v[12:15], v[196:199], v[108:111]
v_mfma_f32_16x16x32_bf16 v[108:111], v[140:143], v[88:91], v[108:111]
ds_read_b128 v[52:55], v32 offset:192
v_mfma_f32_16x16x32_bf16 v[108:111], v[56:59], v[84:87], v[108:111]
ds_read_b128 v[144:147], v32 offset:4736
v_mfma_f32_16x16x32_bf16 v[104:107], v[24:27], v[84:87], v[104:107]
ds_read_b128 v[192:195], v32 offset:5024
v_mfma_f32_16x16x32_bf16 v[104:107], v[56:59], v[88:91], v[104:107]
ds_read_b128 v[252:255], v32 offset:5312
v_mfma_f32_16x16x32_bf16 v[104:107], v[140:143], v[196:199], v[104:107]
ds_read_b128 v[148:151], v32 offset:5600
v_mfma_f32_16x16x32_bf16 v[104:107], v[12:15], v[212:215], v[104:107]
buffer_load_dwordx4 v[180:183], v34, s[32:35], s69 offen offset:2048
v_mfma_f32_16x16x32_bf16 v[100:103], v[140:143], v[212:215], v[100:103]
v_mfma_f32_16x16x32_bf16 v[100:103], v[56:59], v[196:199], v[100:103]
v_mfma_f32_16x16x32_bf16 v[100:103], v[24:27], v[88:91], v[100:103]
s_waitcnt lgkmcnt(4)
s_waitcnt vmcnt(11)
v_mfma_f32_16x16x32_bf16 v[100:103], v[156:159], v[52:55], v[100:103]
buffer_load_dwordx4 v[248:251], v34, s[32:35], s69 offen offset:3072
s_waitcnt lgkmcnt(3)
v_mfma_f32_16x16x32_bf16 v[132:135], v[72:75], v[144:147], v[132:135]
s_add_u32 s69, s69, 4096
s_waitcnt lgkmcnt(2)
v_mfma_f32_16x16x32_bf16 v[132:135], v[92:95], v[192:195], v[132:135]
s_waitcnt lgkmcnt(1)
v_mfma_f32_16x16x32_bf16 v[132:135], v[96:99], v[252:255], v[132:135]
s_waitcnt lgkmcnt(0)
v_mfma_f32_16x16x32_bf16 v[132:135], v[12:15], v[148:151], v[132:135]
buffer_load_dwordx4 v[152:155], v34, s[32:35], s69 offen offset:0
v_mfma_f32_16x16x32_bf16 v[128:131], v[140:143], v[148:151], v[128:131]
v_mfma_f32_16x16x32_bf16 v[128:131], v[12:15], v[252:255], v[128:131]
v_mfma_f32_16x16x32_bf16 v[128:131], v[96:99], v[192:195], v[128:131]
v_mfma_f32_16x16x32_bf16 v[128:131], v[92:95], v[144:147], v[128:131]
buffer_load_dwordx4 v[160:163], v34, s[32:35], s69 offen offset:1024
v_mfma_f32_16x16x32_bf16 v[124:127], v[96:99], v[144:147], v[124:127]
v_mfma_f32_16x16x32_bf16 v[124:127], v[12:15], v[192:195], v[124:127]
v_mfma_f32_16x16x32_bf16 v[124:127], v[140:143], v[252:255], v[124:127]
ds_read_b128 v[184:187], v32 offset:1344
v_mfma_f32_16x16x32_bf16 v[124:127], v[56:59], v[148:151], v[124:127]
buffer_load_dwordx4 v[244:247], v34, s[32:35], s69 offen offset:2048
v_mfma_f32_16x16x32_bf16 v[120:123], v[24:27], v[148:151], v[120:123]
ds_read_b128 v[216:219], v32 offset:1056
v_mfma_f32_16x16x32_bf16 v[120:123], v[56:59], v[252:255], v[120:123]
v_mfma_f32_16x16x32_bf16 v[120:123], v[140:143], v[192:195], v[120:123]
v_mfma_f32_16x16x32_bf16 v[120:123], v[12:15], v[144:147], v[120:123]
buffer_load_dwordx4 v[20:23], v34, s[32:35], s69 offen offset:3072
v_mfma_f32_16x16x32_bf16 v[116:119], v[140:143], v[144:147], v[116:119]
s_add_u32 s69, s69, 4096
ds_read_b128 v[8:11], v32 offset:768
v_mfma_f32_16x16x32_bf16 v[116:119], v[56:59], v[192:195], v[116:119]
v_mfma_f32_16x16x32_bf16 v[116:119], v[24:27], v[252:255], v[116:119]
s_waitcnt lgkmcnt(2)
v_mfma_f32_16x16x32_bf16 v[116:119], v[156:159], v[184:187], v[116:119]
buffer_load_dwordx4 v[4:7], v34, s[32:35], s69 offen offset:0
s_waitcnt vmcnt(16)
v_mfma_f32_16x16x32_bf16 v[112:115], v[164:167], v[184:187], v[112:115]
s_waitcnt lgkmcnt(1)
v_mfma_f32_16x16x32_bf16 v[112:115], v[156:159], v[216:219], v[112:115]
v_mfma_f32_16x16x32_bf16 v[112:115], v[24:27], v[192:195], v[112:115]
ds_read_b128 v[240:243], v32 offset:480
v_mfma_f32_16x16x32_bf16 v[112:115], v[56:59], v[144:147], v[112:115]
buffer_load_dwordx4 v[16:19], v34, s[32:35], s69 offen offset:1024
v_mfma_f32_16x16x32_bf16 v[108:111], v[24:27], v[144:147], v[108:111]
s_waitcnt lgkmcnt(1)
v_mfma_f32_16x16x32_bf16 v[108:111], v[156:159], v[8:11], v[108:111]
v_mfma_f32_16x16x32_bf16 v[108:111], v[164:167], v[216:219], v[108:111]
s_waitcnt vmcnt(16)
v_mfma_f32_16x16x32_bf16 v[108:111], v[48:51], v[184:187], v[108:111]
ds_read_b128 v[204:207], v32 offset:5888
s_waitcnt vmcnt(15)
v_mfma_f32_16x16x32_bf16 v[104:107], v[80:83], v[184:187], v[104:107]
ds_read_b128 v[220:223], v32 offset:6176
v_mfma_f32_16x16x32_bf16 v[104:107], v[48:51], v[216:219], v[104:107]
ds_read_b128 v[176:179], v32 offset:6464
v_mfma_f32_16x16x32_bf16 v[104:107], v[164:167], v[8:11], v[104:107]
ds_read_b128 v[64:67], v32 offset:2496
s_waitcnt lgkmcnt(4)
v_mfma_f32_16x16x32_bf16 v[104:107], v[156:159], v[240:243], v[104:107]
buffer_load_dwordx4 v[68:71], v34, s[32:35], s69 offen offset:2048
v_mfma_f32_16x16x32_bf16 v[100:103], v[164:167], v[240:243], v[100:103]
ds_read_b128 v[84:87], v32 offset:2208
v_mfma_f32_16x16x32_bf16 v[100:103], v[48:51], v[8:11], v[100:103]
v_mfma_f32_16x16x32_bf16 v[100:103], v[80:83], v[216:219], v[100:103]
s_waitcnt vmcnt(15)
v_mfma_f32_16x16x32_bf16 v[100:103], v[76:79], v[184:187], v[100:103]
buffer_load_dwordx4 v[212:215], v34, s[32:35], s69 offen offset:3072
s_waitcnt lgkmcnt(4)
v_mfma_f32_16x16x32_bf16 v[132:135], v[140:143], v[204:207], v[132:135]
s_add_u32 s69, s69, 4096
ds_read_b128 v[196:199], v32 offset:1920
s_waitcnt lgkmcnt(4)
v_mfma_f32_16x16x32_bf16 v[132:135], v[56:59], v[220:223], v[132:135]
s_waitcnt lgkmcnt(3)
v_mfma_f32_16x16x32_bf16 v[132:135], v[24:27], v[176:179], v[132:135]
s_waitcnt lgkmcnt(2)
v_mfma_f32_16x16x32_bf16 v[132:135], v[156:159], v[64:67], v[132:135]
buffer_load_dwordx4 v[88:91], v34, s[32:35], s69 offen offset:0
v_mfma_f32_16x16x32_bf16 v[128:131], v[164:167], v[64:67], v[128:131]
s_waitcnt lgkmcnt(1)
v_mfma_f32_16x16x32_bf16 v[128:131], v[156:159], v[84:87], v[128:131]
v_mfma_f32_16x16x32_bf16 v[128:131], v[24:27], v[220:223], v[128:131]
ds_read_b128 v[52:55], v32 offset:1632
v_mfma_f32_16x16x32_bf16 v[128:131], v[56:59], v[204:207], v[128:131]
buffer_load_dwordx4 v[72:75], v34, s[32:35], s69 offen offset:1024
v_mfma_f32_16x16x32_bf16 v[124:127], v[24:27], v[204:207], v[124:127]
s_waitcnt lgkmcnt(1)
v_mfma_f32_16x16x32_bf16 v[124:127], v[156:159], v[196:199], v[124:127]
v_mfma_f32_16x16x32_bf16 v[124:127], v[164:167], v[84:87], v[124:127]
v_mfma_f32_16x16x32_bf16 v[124:127], v[48:51], v[64:67], v[124:127]
v_mfma_f32_16x16x32_bf16 v[120:123], v[80:83], v[64:67], v[120:123]
v_mfma_f32_16x16x32_bf16 v[120:123], v[48:51], v[84:87], v[120:123]
v_mfma_f32_16x16x32_bf16 v[120:123], v[164:167], v[196:199], v[120:123]
ds_read_b128 v[92:95], v32 offset:3360
s_waitcnt lgkmcnt(1)
v_mfma_f32_16x16x32_bf16 v[120:123], v[156:159], v[52:55], v[120:123]
ds_read_b128 v[96:99], v32 offset:3648
v_mfma_f32_16x16x32_bf16 v[116:119], v[164:167], v[52:55], v[116:119]
ds_read_b128 v[148:151], v32 offset:3936
v_mfma_f32_16x16x32_bf16 v[116:119], v[48:51], v[196:199], v[116:119]
ds_read_b128 v[12:15], v32 offset:4224
v_mfma_f32_16x16x32_bf16 v[116:119], v[80:83], v[84:87], v[116:119]
ds_read_b128 v[252:255], v33 offset:0
v_mfma_f32_16x16x32_bf16 v[116:119], v[76:79], v[64:67], v[116:119]
ds_read_b128 v[192:195], v33 offset:288
s_waitcnt vmcnt(17)
v_mfma_f32_16x16x32_bf16 v[112:115], v[208:211], v[64:67], v[112:115]
ds_read_b128 v[144:147], v33 offset:576
v_mfma_f32_16x16x32_bf16 v[112:115], v[76:79], v[84:87], v[112:115]
ds_read_b128 v[240:243], v33 offset:864
v_mfma_f32_16x16x32_bf16 v[112:115], v[80:83], v[196:199], v[112:115]
ds_read_b128 v[8:11], v33 offset:1152
v_mfma_f32_16x16x32_bf16 v[112:115], v[48:51], v[52:55], v[112:115]
ds_read_b128 v[216:219], v33 offset:1440
v_mfma_f32_16x16x32_bf16 v[108:111], v[80:83], v[52:55], v[108:111]
ds_read_b128 v[184:187], v33 offset:1728
v_mfma_f32_16x16x32_bf16 v[108:111], v[76:79], v[196:199], v[108:111]
ds_read_b128 v[140:143], v33 offset:2016
v_mfma_f32_16x16x32_bf16 v[108:111], v[208:211], v[84:87], v[108:111]
s_waitcnt vmcnt(16)
v_mfma_f32_16x16x32_bf16 v[108:111], v[200:203], v[64:67], v[108:111]
ds_read_b128 v[176:179], v32 offset:2784
s_waitcnt vmcnt(15)
v_mfma_f32_16x16x32_bf16 v[104:107], v[168:171], v[64:67], v[104:107]
ds_read_b128 v[220:223], v32 offset:3072
v_mfma_f32_16x16x32_bf16 v[104:107], v[200:203], v[84:87], v[104:107]
v_mfma_f32_16x16x32_bf16 v[104:107], v[208:211], v[196:199], v[104:107]
v_mfma_f32_16x16x32_bf16 v[104:107], v[76:79], v[52:55], v[104:107]
v_mfma_f32_16x16x32_bf16 v[100:103], v[208:211], v[52:55], v[100:103]
v_mfma_f32_16x16x32_bf16 v[100:103], v[200:203], v[196:199], v[100:103]
v_mfma_f32_16x16x32_bf16 v[100:103], v[168:171], v[84:87], v[100:103]
s_waitcnt vmcnt(14)
v_mfma_f32_16x16x32_bf16 v[100:103], v[136:139], v[64:67], v[100:103]
s_waitcnt lgkmcnt(1)
v_mfma_f32_16x16x32_bf16 v[132:135], v[164:167], v[176:179], v[132:135]
s_waitcnt lgkmcnt(0)
v_mfma_f32_16x16x32_bf16 v[132:135], v[48:51], v[220:223], v[132:135]
v_mfma_f32_16x16x32_bf16 v[128:131], v[80:83], v[220:223], v[128:131]
v_mfma_f32_16x16x32_bf16 v[128:131], v[48:51], v[176:179], v[128:131]
v_mfma_f32_16x16x32_bf16 v[124:127], v[80:83], v[176:179], v[124:127]
v_mfma_f32_16x16x32_bf16 v[124:127], v[76:79], v[220:223], v[124:127]
v_mfma_f32_16x16x32_bf16 v[120:123], v[208:211], v[220:223], v[120:123]
v_mfma_f32_16x16x32_bf16 v[120:123], v[76:79], v[176:179], v[120:123]
v_mfma_f32_16x16x32_bf16 v[116:119], v[208:211], v[176:179], v[116:119]
v_mfma_f32_16x16x32_bf16 v[116:119], v[200:203], v[220:223], v[116:119]
v_mfma_f32_16x16x32_bf16 v[112:115], v[168:171], v[220:223], v[112:115]
v_mfma_f32_16x16x32_bf16 v[112:115], v[200:203], v[176:179], v[112:115]
v_mfma_f32_16x16x32_bf16 v[108:111], v[168:171], v[176:179], v[108:111]
v_mfma_f32_16x16x32_bf16 v[108:111], v[136:139], v[220:223], v[108:111]
s_waitcnt vmcnt(13)
v_mfma_f32_16x16x32_bf16 v[104:107], v[188:191], v[220:223], v[104:107]
v_mfma_f32_16x16x32_bf16 v[104:107], v[136:139], v[176:179], v[104:107]
v_mfma_f32_16x16x32_bf16 v[100:103], v[188:191], v[176:179], v[100:103]
s_waitcnt vmcnt(12)
v_mfma_f32_16x16x32_bf16 v[100:103], v[172:175], v[220:223], v[100:103]
s_waitcnt vmcnt(11)
v_mfma_f32_16x16x32_bf16 v[100:103], v[180:183], v[92:95], v[100:103]
s_waitcnt vmcnt(10)
v_mfma_f32_16x16x32_bf16 v[100:103], v[248:251], v[96:99], v[100:103]
s_waitcnt vmcnt(9)
v_mfma_f32_16x16x32_bf16 v[100:103], v[152:155], v[148:151], v[100:103]
s_waitcnt vmcnt(8)
v_mfma_f32_16x16x32_bf16 v[100:103], v[160:163], v[12:15], v[100:103]
s_waitcnt vmcnt(7)
v_mfma_f32_16x16x32_bf16 v[100:103], v[244:247], v[252:255], v[100:103]
s_waitcnt vmcnt(6)
v_mfma_f32_16x16x32_bf16 v[100:103], v[20:23], v[192:195], v[100:103]
s_waitcnt vmcnt(5)
v_mfma_f32_16x16x32_bf16 v[100:103], v[4:7], v[144:147], v[100:103]
s_waitcnt vmcnt(4)
v_mfma_f32_16x16x32_bf16 v[100:103], v[16:19], v[240:243], v[100:103]
s_waitcnt vmcnt(3)
v_mfma_f32_16x16x32_bf16 v[100:103], v[68:71], v[8:11], v[100:103]
s_waitcnt vmcnt(2)
v_mfma_f32_16x16x32_bf16 v[100:103], v[212:215], v[216:219], v[100:103]
s_waitcnt vmcnt(1)
v_mfma_f32_16x16x32_bf16 v[100:103], v[88:91], v[184:187], v[100:103]
ds_read_b128 v[56:59], v32 offset:4512
s_waitcnt vmcnt(0)
v_mfma_f32_16x16x32_bf16 v[100:103], v[72:75], v[140:143], v[100:103]
v_mfma_f32_16x16x32_bf16 v[104:107], v[172:175], v[92:95], v[104:107]
ds_read_b128 v[24:27], v33 offset:2304
v_mfma_f32_16x16x32_bf16 v[104:107], v[180:183], v[96:99], v[104:107]
v_mfma_f32_16x16x32_bf16 v[104:107], v[248:251], v[148:151], v[104:107]
v_mfma_f32_16x16x32_bf16 v[104:107], v[152:155], v[12:15], v[104:107]
s_waitcnt lgkmcnt(1)
v_mfma_f32_16x16x32_bf16 v[104:107], v[160:163], v[56:59], v[104:107]
v_mfma_f32_16x16x32_bf16 v[104:107], v[244:247], v[192:195], v[104:107]
v_mul_f32 v224, s90, v100
v_mul_f32 v225, s90, v101
v_mfma_f32_16x16x32_bf16 v[104:107], v[20:23], v[144:147], v[104:107]
v_mul_f32 v226, s92, v102
v_mul_f32 v227, s92, v103
v_mfma_f32_16x16x32_bf16 v[104:107], v[4:7], v[240:243], v[104:107]
v_min_f32 v224, s94, v224
v_min_f32 v225, s94, v225
v_mfma_f32_16x16x32_bf16 v[104:107], v[16:19], v[8:11], v[104:107]
v_exp_f32 v224, v224
v_mfma_f32_16x16x32_bf16 v[104:107], v[68:71], v[216:219], v[104:107]
v_exp_f32 v225, v225
v_mfma_f32_16x16x32_bf16 v[104:107], v[212:215], v[184:187], v[104:107]
v_exp_f32 v226, v226
v_mfma_f32_16x16x32_bf16 v[104:107], v[88:91], v[140:143], v[104:107]
v_exp_f32 v227, v227
s_waitcnt lgkmcnt(0)
v_mfma_f32_16x16x32_bf16 v[104:107], v[72:75], v[24:27], v[104:107]
ds_read_b128 v[204:207], v32 offset:4800
v_add_f32 v228, 1.0, v224
v_mfma_f32_16x16x32_bf16 v[108:111], v[188:191], v[92:95], v[108:111]
v_add_f32 v229, 1.0, v225
v_fma_f32 v228, v228, v226, v228
v_mfma_f32_16x16x32_bf16 v[108:111], v[172:175], v[96:99], v[108:111]
ds_read_b128 v[156:159], v33 offset:2592
v_fma_f32 v229, v229, v227, v229
v_mfma_f32_16x16x32_bf16 v[108:111], v[180:183], v[148:151], v[108:111]
v_rcp_f32 v228, v228
v_mfma_f32_16x16x32_bf16 v[108:111], v[248:251], v[12:15], v[108:111]
v_rcp_f32 v229, v229
v_mfma_f32_16x16x32_bf16 v[108:111], v[152:155], v[56:59], v[108:111]
v_add_f32 v230, -1.0, v224
v_add_f32 v231, -1.0, v225
s_waitcnt lgkmcnt(1)
v_mfma_f32_16x16x32_bf16 v[108:111], v[160:163], v[204:207], v[108:111]
v_mul_f32 v230, v230, v228
v_mul_f32 v231, v231, v229
v_mfma_f32_16x16x32_bf16 v[108:111], v[244:247], v[144:147], v[108:111]
v_cvt_pk_bf16_f32 v100, v230, v231
v_mfma_f32_16x16x32_bf16 v[108:111], v[20:23], v[240:243], v[108:111]
buffer_store_dword v100, v37, s[36:39], 0 offen offset:0
v_mfma_f32_16x16x32_bf16 v[108:111], v[4:7], v[8:11], v[108:111]
v_mul_f32 v232, s90, v104
v_mul_f32 v233, s90, v105
v_mfma_f32_16x16x32_bf16 v[108:111], v[16:19], v[216:219], v[108:111]
v_mul_f32 v234, s92, v106
v_mul_f32 v235, s92, v107
v_mfma_f32_16x16x32_bf16 v[108:111], v[68:71], v[184:187], v[108:111]
v_min_f32 v232, s94, v232
v_min_f32 v233, s94, v233
v_mfma_f32_16x16x32_bf16 v[108:111], v[212:215], v[140:143], v[108:111]
v_exp_f32 v232, v232
v_mfma_f32_16x16x32_bf16 v[108:111], v[88:91], v[24:27], v[108:111]
v_exp_f32 v233, v233
s_waitcnt lgkmcnt(0)
v_mfma_f32_16x16x32_bf16 v[108:111], v[72:75], v[156:159], v[108:111]
v_exp_f32 v234, v234
v_mfma_f32_16x16x32_bf16 v[112:115], v[136:139], v[92:95], v[112:115]
ds_read_b128 v[52:55], v32 offset:5088
v_mfma_f32_16x16x32_bf16 v[112:115], v[188:191], v[96:99], v[112:115]
v_exp_f32 v235, v235
v_mfma_f32_16x16x32_bf16 v[112:115], v[172:175], v[148:151], v[112:115]
ds_read_b128 v[196:199], v33 offset:2880
v_add_f32 v236, 1.0, v232
v_mfma_f32_16x16x32_bf16 v[112:115], v[180:183], v[12:15], v[112:115]
v_add_f32 v237, 1.0, v233
v_fma_f32 v236, v236, v234, v236
v_mfma_f32_16x16x32_bf16 v[112:115], v[248:251], v[56:59], v[112:115]
v_fma_f32 v237, v237, v235, v237
v_mfma_f32_16x16x32_bf16 v[112:115], v[152:155], v[204:207], v[112:115]
v_rcp_f32 v236, v236
s_waitcnt lgkmcnt(1)
v_mfma_f32_16x16x32_bf16 v[112:115], v[160:163], v[52:55], v[112:115]
v_rcp_f32 v237, v237
v_mfma_f32_16x16x32_bf16 v[112:115], v[244:247], v[240:243], v[112:115]
v_add_f32 v238, -1.0, v232
v_add_f32 v239, -1.0, v233
v_mfma_f32_16x16x32_bf16 v[112:115], v[20:23], v[8:11], v[112:115]
v_mul_f32 v238, v238, v236
v_mul_f32 v239, v239, v237
v_mfma_f32_16x16x32_bf16 v[112:115], v[4:7], v[216:219], v[112:115]
v_cvt_pk_bf16_f32 v104, v238, v239
v_mfma_f32_16x16x32_bf16 v[112:115], v[16:19], v[184:187], v[112:115]
buffer_store_dword v104, v37, s[36:39], 0 offen offset:1152
v_mfma_f32_16x16x32_bf16 v[112:115], v[68:71], v[140:143], v[112:115]
v_mul_f32 v224, s90, v108
v_mul_f32 v225, s90, v109
v_mfma_f32_16x16x32_bf16 v[112:115], v[212:215], v[24:27], v[112:115]
v_mul_f32 v226, s92, v110
v_mul_f32 v227, s92, v111
v_mfma_f32_16x16x32_bf16 v[112:115], v[88:91], v[156:159], v[112:115]
v_min_f32 v224, s94, v224
v_min_f32 v225, s94, v225
s_waitcnt lgkmcnt(0)
v_mfma_f32_16x16x32_bf16 v[112:115], v[72:75], v[196:199], v[112:115]
v_exp_f32 v224, v224
v_mfma_f32_16x16x32_bf16 v[116:119], v[168:171], v[92:95], v[116:119]
v_exp_f32 v225, v225
v_mfma_f32_16x16x32_bf16 v[116:119], v[136:139], v[96:99], v[116:119]
ds_read_b128 v[84:87], v32 offset:5376
v_mfma_f32_16x16x32_bf16 v[116:119], v[188:191], v[148:151], v[116:119]
v_exp_f32 v226, v226
v_mfma_f32_16x16x32_bf16 v[116:119], v[172:175], v[12:15], v[116:119]
ds_read_b128 v[64:67], v33 offset:3168
v_mfma_f32_16x16x32_bf16 v[116:119], v[180:183], v[56:59], v[116:119]
v_exp_f32 v227, v227
v_mfma_f32_16x16x32_bf16 v[116:119], v[248:251], v[204:207], v[116:119]
v_add_f32 v228, 1.0, v224
v_add_f32 v229, 1.0, v225
v_mfma_f32_16x16x32_bf16 v[116:119], v[152:155], v[52:55], v[116:119]
v_fma_f32 v228, v228, v226, v228
v_fma_f32 v229, v229, v227, v229
s_waitcnt lgkmcnt(1)
v_mfma_f32_16x16x32_bf16 v[116:119], v[160:163], v[84:87], v[116:119]
v_rcp_f32 v228, v228
v_mfma_f32_16x16x32_bf16 v[116:119], v[244:247], v[8:11], v[116:119]
v_rcp_f32 v229, v229
v_mfma_f32_16x16x32_bf16 v[116:119], v[20:23], v[216:219], v[116:119]
v_add_f32 v230, -1.0, v224
v_add_f32 v231, -1.0, v225
v_mfma_f32_16x16x32_bf16 v[116:119], v[4:7], v[184:187], v[116:119]
v_mul_f32 v230, v230, v228
v_mul_f32 v231, v231, v229
v_mfma_f32_16x16x32_bf16 v[116:119], v[16:19], v[140:143], v[116:119]
v_cvt_pk_bf16_f32 v108, v230, v231
v_mfma_f32_16x16x32_bf16 v[116:119], v[68:71], v[24:27], v[116:119]
buffer_store_dword v108, v37, s[36:39], 0 offen offset:2304
v_mfma_f32_16x16x32_bf16 v[116:119], v[212:215], v[156:159], v[116:119]
v_mul_f32 v232, s90, v112
v_mul_f32 v233, s90, v113
v_mfma_f32_16x16x32_bf16 v[116:119], v[88:91], v[196:199], v[116:119]
v_mul_f32 v234, s92, v114
v_mul_f32 v235, s92, v115
s_waitcnt lgkmcnt(0)
v_mfma_f32_16x16x32_bf16 v[116:119], v[72:75], v[64:67], v[116:119]
v_min_f32 v232, s94, v232
v_min_f32 v233, s94, v233
v_mfma_f32_16x16x32_bf16 v[120:123], v[200:203], v[92:95], v[120:123]
v_exp_f32 v232, v232
v_mfma_f32_16x16x32_bf16 v[120:123], v[168:171], v[96:99], v[120:123]
v_exp_f32 v233, v233
v_mfma_f32_16x16x32_bf16 v[120:123], v[136:139], v[148:151], v[120:123]
ds_read_b128 v[164:167], v32 offset:5664
v_mfma_f32_16x16x32_bf16 v[120:123], v[188:191], v[12:15], v[120:123]
v_exp_f32 v234, v234
v_mfma_f32_16x16x32_bf16 v[120:123], v[172:175], v[56:59], v[120:123]
ds_read_b128 v[48:51], v33 offset:3456
v_mfma_f32_16x16x32_bf16 v[120:123], v[180:183], v[204:207], v[120:123]
v_exp_f32 v235, v235
v_mfma_f32_16x16x32_bf16 v[120:123], v[248:251], v[52:55], v[120:123]
v_add_f32 v236, 1.0, v232
v_add_f32 v237, 1.0, v233
v_mfma_f32_16x16x32_bf16 v[120:123], v[152:155], v[84:87], v[120:123]
v_fma_f32 v236, v236, v234, v236
v_fma_f32 v237, v237, v235, v237
s_waitcnt lgkmcnt(1)
v_mfma_f32_16x16x32_bf16 v[120:123], v[160:163], v[164:167], v[120:123]
v_rcp_f32 v236, v236
v_mfma_f32_16x16x32_bf16 v[120:123], v[244:247], v[216:219], v[120:123]
v_rcp_f32 v237, v237
v_mfma_f32_16x16x32_bf16 v[120:123], v[20:23], v[184:187], v[120:123]
v_add_f32 v238, -1.0, v232
v_add_f32 v239, -1.0, v233
v_mfma_f32_16x16x32_bf16 v[120:123], v[4:7], v[140:143], v[120:123]
v_mul_f32 v238, v238, v236
v_mul_f32 v239, v239, v237
v_mfma_f32_16x16x32_bf16 v[120:123], v[16:19], v[24:27], v[120:123]
v_cvt_pk_bf16_f32 v112, v238, v239
v_mfma_f32_16x16x32_bf16 v[120:123], v[68:71], v[156:159], v[120:123]
buffer_store_dword v112, v38, s[36:39], 0 offen offset:0
v_mfma_f32_16x16x32_bf16 v[120:123], v[212:215], v[196:199], v[120:123]
v_mul_f32 v224, s90, v116
v_mul_f32 v225, s90, v117
v_mfma_f32_16x16x32_bf16 v[120:123], v[88:91], v[64:67], v[120:123]
v_mul_f32 v226, s92, v118
v_mul_f32 v227, s92, v119
s_waitcnt lgkmcnt(0)
v_mfma_f32_16x16x32_bf16 v[120:123], v[72:75], v[48:51], v[120:123]
v_min_f32 v224, s94, v224
v_min_f32 v225, s94, v225
v_mfma_f32_16x16x32_bf16 v[124:127], v[208:211], v[92:95], v[124:127]
v_exp_f32 v224, v224
v_mfma_f32_16x16x32_bf16 v[124:127], v[200:203], v[96:99], v[124:127]
v_exp_f32 v225, v225
v_mfma_f32_16x16x32_bf16 v[124:127], v[168:171], v[148:151], v[124:127]
v_exp_f32 v226, v226
v_mfma_f32_16x16x32_bf16 v[124:127], v[136:139], v[12:15], v[124:127]
ds_read_b128 v[176:179], v32 offset:5952
v_mfma_f32_16x16x32_bf16 v[124:127], v[188:191], v[56:59], v[124:127]
v_exp_f32 v227, v227
v_mfma_f32_16x16x32_bf16 v[124:127], v[172:175], v[204:207], v[124:127]
ds_read_b128 v[220:223], v33 offset:3744
v_add_f32 v228, 1.0, v224
v_mfma_f32_16x16x32_bf16 v[124:127], v[180:183], v[52:55], v[124:127]
v_add_f32 v229, 1.0, v225
v_fma_f32 v228, v228, v226, v228
v_mfma_f32_16x16x32_bf16 v[124:127], v[248:251], v[84:87], v[124:127]
v_fma_f32 v229, v229, v227, v229
v_mfma_f32_16x16x32_bf16 v[124:127], v[152:155], v[164:167], v[124:127]
v_rcp_f32 v228, v228
s_waitcnt lgkmcnt(1)
v_mfma_f32_16x16x32_bf16 v[124:127], v[160:163], v[176:179], v[124:127]
v_rcp_f32 v229, v229
v_mfma_f32_16x16x32_bf16 v[124:127], v[244:247], v[184:187], v[124:127]
v_add_f32 v230, -1.0, v224
v_add_f32 v231, -1.0, v225
v_mfma_f32_16x16x32_bf16 v[124:127], v[20:23], v[140:143], v[124:127]
v_mul_f32 v230, v230, v228
v_mul_f32 v231, v231, v229
v_mfma_f32_16x16x32_bf16 v[124:127], v[4:7], v[24:27], v[124:127]
v_cvt_pk_bf16_f32 v116, v230, v231
v_mfma_f32_16x16x32_bf16 v[124:127], v[16:19], v[156:159], v[124:127]
buffer_store_dword v116, v38, s[36:39], 0 offen offset:1152
v_mfma_f32_16x16x32_bf16 v[124:127], v[68:71], v[196:199], v[124:127]
v_mul_f32 v232, s90, v120
v_mul_f32 v233, s90, v121
v_mfma_f32_16x16x32_bf16 v[124:127], v[212:215], v[64:67], v[124:127]
v_mul_f32 v234, s92, v122
v_mul_f32 v235, s92, v123
v_mfma_f32_16x16x32_bf16 v[124:127], v[88:91], v[48:51], v[124:127]
v_min_f32 v232, s94, v232
v_min_f32 v233, s94, v233
s_waitcnt lgkmcnt(0)
v_mfma_f32_16x16x32_bf16 v[124:127], v[72:75], v[220:223], v[124:127]
v_exp_f32 v232, v232
v_mfma_f32_16x16x32_bf16 v[128:131], v[76:79], v[92:95], v[128:131]
v_exp_f32 v233, v233
v_mfma_f32_16x16x32_bf16 v[128:131], v[208:211], v[96:99], v[128:131]
v_exp_f32 v234, v234
v_mfma_f32_16x16x32_bf16 v[128:131], v[200:203], v[148:151], v[128:131]
v_exp_f32 v235, v235
v_mfma_f32_16x16x32_bf16 v[128:131], v[168:171], v[12:15], v[128:131]
v_add_f32 v236, 1.0, v232
v_add_f32 v237, 1.0, v233
v_mfma_f32_16x16x32_bf16 v[128:131], v[136:139], v[56:59], v[128:131]
ds_read_b128 v[252:255], v32 offset:6240
v_fma_f32 v236, v236, v234, v236
v_mfma_f32_16x16x32_bf16 v[128:131], v[188:191], v[204:207], v[128:131]
v_fma_f32 v237, v237, v235, v237
v_mfma_f32_16x16x32_bf16 v[128:131], v[172:175], v[52:55], v[128:131]
ds_read_b128 v[192:195], v33 offset:4032
v_mfma_f32_16x16x32_bf16 v[128:131], v[180:183], v[84:87], v[128:131]
v_rcp_f32 v236, v236
v_mfma_f32_16x16x32_bf16 v[128:131], v[248:251], v[164:167], v[128:131]
v_rcp_f32 v237, v237
v_mfma_f32_16x16x32_bf16 v[128:131], v[152:155], v[176:179], v[128:131]
v_add_f32 v238, -1.0, v232
v_add_f32 v239, -1.0, v233
s_waitcnt lgkmcnt(1)
v_mfma_f32_16x16x32_bf16 v[128:131], v[160:163], v[252:255], v[128:131]
v_mul_f32 v238, v238, v236
v_mul_f32 v239, v239, v237
v_mfma_f32_16x16x32_bf16 v[128:131], v[244:247], v[140:143], v[128:131]
v_cvt_pk_bf16_f32 v120, v238, v239
v_mfma_f32_16x16x32_bf16 v[128:131], v[20:23], v[24:27], v[128:131]
buffer_store_dword v120, v38, s[36:39], 0 offen offset:2304
v_mfma_f32_16x16x32_bf16 v[128:131], v[4:7], v[156:159], v[128:131]
v_mul_f32 v224, s90, v124
v_mul_f32 v225, s90, v125
v_mfma_f32_16x16x32_bf16 v[128:131], v[16:19], v[196:199], v[128:131]
v_mul_f32 v226, s92, v126
v_mul_f32 v227, s92, v127
v_mfma_f32_16x16x32_bf16 v[128:131], v[68:71], v[64:67], v[128:131]
v_min_f32 v224, s94, v224
v_min_f32 v225, s94, v225
v_mfma_f32_16x16x32_bf16 v[128:131], v[212:215], v[48:51], v[128:131]
v_exp_f32 v224, v224
v_mfma_f32_16x16x32_bf16 v[128:131], v[88:91], v[220:223], v[128:131]
v_exp_f32 v225, v225
s_waitcnt lgkmcnt(0)
v_mfma_f32_16x16x32_bf16 v[128:131], v[72:75], v[192:195], v[128:131]
v_exp_f32 v226, v226
v_mfma_f32_16x16x32_bf16 v[132:135], v[80:83], v[92:95], v[132:135]
v_exp_f32 v227, v227
v_mfma_f32_16x16x32_bf16 v[132:135], v[76:79], v[96:99], v[132:135]
v_add_f32 v228, 1.0, v224
v_add_f32 v229, 1.0, v225
v_mfma_f32_16x16x32_bf16 v[132:135], v[208:211], v[148:151], v[132:135]
v_fma_f32 v228, v228, v226, v228
v_fma_f32 v229, v229, v227, v229
v_mfma_f32_16x16x32_bf16 v[132:135], v[200:203], v[12:15], v[132:135]
v_rcp_f32 v228, v228
v_mfma_f32_16x16x32_bf16 v[132:135], v[168:171], v[56:59], v[132:135]
v_rcp_f32 v229, v229
v_mfma_f32_16x16x32_bf16 v[132:135], v[136:139], v[204:207], v[132:135]
ds_read_b128 v[144:147], v32 offset:6528
v_add_f32 v230, -1.0, v224
v_mfma_f32_16x16x32_bf16 v[132:135], v[188:191], v[52:55], v[132:135]
v_add_f32 v231, -1.0, v225
v_mul_f32 v230, v230, v228
v_mfma_f32_16x16x32_bf16 v[132:135], v[172:175], v[84:87], v[132:135]
ds_read_b128 v[100:103], v33 offset:4320
v_mul_f32 v231, v231, v229
v_mfma_f32_16x16x32_bf16 v[132:135], v[180:183], v[164:167], v[132:135]
v_cvt_pk_bf16_f32 v124, v230, v231
v_mfma_f32_16x16x32_bf16 v[132:135], v[248:251], v[176:179], v[132:135]
buffer_store_dword v124, v39, s[36:39], 0 offen offset:0
v_mfma_f32_16x16x32_bf16 v[132:135], v[152:155], v[252:255], v[132:135]
v_mul_f32 v232, s90, v128
v_mul_f32 v233, s90, v129
s_waitcnt lgkmcnt(1)
v_mfma_f32_16x16x32_bf16 v[132:135], v[160:163], v[144:147], v[132:135]
v_mul_f32 v234, s92, v130
v_mul_f32 v235, s92, v131
v_mfma_f32_16x16x32_bf16 v[132:135], v[244:247], v[24:27], v[132:135]
v_min_f32 v232, s94, v232
v_min_f32 v233, s94, v233
v_mfma_f32_16x16x32_bf16 v[132:135], v[20:23], v[156:159], v[132:135]
v_exp_f32 v232, v232
v_mfma_f32_16x16x32_bf16 v[132:135], v[4:7], v[196:199], v[132:135]
v_exp_f32 v233, v233
v_mfma_f32_16x16x32_bf16 v[132:135], v[16:19], v[64:67], v[132:135]
v_exp_f32 v234, v234
v_mfma_f32_16x16x32_bf16 v[132:135], v[68:71], v[48:51], v[132:135]
v_exp_f32 v235, v235
v_mfma_f32_16x16x32_bf16 v[132:135], v[212:215], v[220:223], v[132:135]
v_add_f32 v236, 1.0, v232
v_add_f32 v237, 1.0, v233
v_mfma_f32_16x16x32_bf16 v[132:135], v[88:91], v[192:195], v[132:135]
v_fma_f32 v236, v236, v234, v236
v_fma_f32 v237, v237, v235, v237
s_waitcnt lgkmcnt(0)
v_mfma_f32_16x16x32_bf16 v[132:135], v[72:75], v[100:103], v[132:135]
v_rcp_f32 v236, v236
v_rcp_f32 v237, v237
v_add_f32 v238, -1.0, v232
v_add_f32 v239, -1.0, v233
v_mul_f32 v238, v238, v236
v_mul_f32 v239, v239, v237
v_cvt_pk_bf16_f32 v128, v238, v239
buffer_store_dword v128, v39, s[36:39], 0 offen offset:1152
v_pk_mul_f32 v[224:225], v[132:133], s[90:91]
v_pk_mul_f32 v[226:227], v[134:135], s[92:93]
v_min_f32 v224, s94, v224
v_min_f32 v225, s94, v225
v_exp_f32 v224, v224
v_exp_f32 v225, v225
v_exp_f32 v226, v226
v_exp_f32 v227, v227
v_pk_add_f32 v[228:229], v[224:225], 1.0 op_sel_hi:[1,0]
v_pk_add_f32 v[230:231], v[224:225], -1.0 op_sel_hi:[1,0]
v_pk_fma_f32 v[228:229], v[228:229], v[226:227], v[228:229]
v_rcp_f32 v228, v228
v_rcp_f32 v229, v229
s_nop 0
v_pk_mul_f32 v[230:231], v[230:231], v[228:229]
v_cvt_pk_bf16_f32 v132, v230, v231
buffer_store_dword v132, v39, s[36:39], 0 offen offset:2304
s_endpgm
L_slow1D:
ds_read_b32 v28, v41 offset:16
s_waitcnt lgkmcnt(0)
v_cmp_ne_u32 vcc, 4, v28
s_nop 4
s_cbranch_vccnz L_slow1D
s_branch L_back1D
L_slow1R:
ds_read_b32 v28, v41 offset:20
s_waitcnt lgkmcnt(0)
v_cmp_ne_u32 vcc, 4, v28
s_nop 4
s_cbranch_vccnz L_slow1R
s_branch L_back1R
L_slow1P:
ds_read_b32 v28, v45 offset:24
s_waitcnt lgkmcnt(0)
v_cmp_ne_u32 vcc, 2, v28
s_nop 4
s_cbranch_vccnz L_slow1P
s_branch L_back1P
L_fw10:
buffer_load_dword v44, v40, s[32:35], s97 offen sc1
ds_read_b32 v47, v41 offset:12
s_add_u32 s61, s61, 1
s_waitcnt vmcnt(0) lgkmcnt(0)
v_cmp_ne_u32 vcc, v43, v44
v_readfirstlane_b32 s46, v47
s_nop 3
s_cbranch_vccz L_fb10
s_cmp_lg_u32 s46, 0
s_cbranch_scc1 L_fb10
s_cmp_lg_u32 s61, 3000
s_cbranch_scc1 L_fw10
v_mov_b32 v47, 0x10000
s_mov_b64 exec, 1
ds_add_u32 v41, v47 offset:4
s_mov_b64 exec, -1
s_branch L_fw10
L_fw11:
buffer_load_dword v44, v40, s[32:35], s97 offen sc1
ds_read_b32 v47, v41 offset:12
s_add_u32 s61, s61, 1
s_waitcnt vmcnt(0) lgkmcnt(0)
v_cmp_ne_u32 vcc, v43, v44
v_readfirstlane_b32 s46, v47
s_nop 3
s_cbranch_vccz L_fb11
s_cmp_lg_u32 s46, 0
s_cbranch_scc1 L_fb11
s_cmp_lg_u32 s61, 3000
s_cbranch_scc1 L_fw11
v_mov_b32 v47, 0x10000
s_mov_b64 exec, 1
ds_add_u32 v41, v47 offset:4
s_mov_b64 exec, -1
s_branch L_fw11
L_fw12:
buffer_load_dword v44, v40, s[32:35], s97 offen sc1
ds_read_b32 v47, v41 offset:12
s_add_u32 s61, s61, 1
s_waitcnt vmcnt(0) lgkmcnt(0)
v_cmp_ne_u32 vcc, v43, v44
v_readfirstlane_b32 s46, v47
s_nop 3
s_cbranch_vccz L_fb12
s_cmp_lg_u32 s46, 0
s_cbranch_scc1 L_fb12
s_cmp_lg_u32 s61, 3000
s_cbranch_scc1 L_fw12
v_mov_b32 v47, 0x10000
s_mov_b64 exec, 1
ds_add_u32 v41, v47 offset:4
s_mov_b64 exec, -1
s_branch L_fw12
L_fw13:
buffer_load_dword v44, v40, s[32:35], s97 offen sc1
ds_read_b32 v47, v41 offset:12
s_add_u32 s61, s61, 1
s_waitcnt vmcnt(0) lgkmcnt(0)
v_cmp_ne_u32 vcc, v43, v44
v_readfirstlane_b32 s46, v47
s_nop 3
s_cbranch_vccz L_fb13
s_cmp_lg_u32 s46, 0
s_cbranch_scc1 L_fb13
s_cmp_lg_u32 s61, 3000
s_cbranch_scc1 L_fw13
v_mov_b32 v47, 0x10000
s_mov_b64 exec, 1
ds_add_u32 v41, v47 offset:4
s_mov_b64 exec, -1
s_branch L_fw13
L_fw14:
buffer_load_dword v44, v40, s[32:35], s97 offen sc1
ds_read_b32 v47, v41 offset:12
s_add_u32 s61, s61, 1
s_waitcnt vmcnt(0) lgkmcnt(0)
v_cmp_ne_u32 vcc, v43, v44
v_readfirstlane_b32 s46, v47
s_nop 3
s_cbranch_vccz L_fb14
s_cmp_lg_u32 s46, 0
s_cbranch_scc1 L_fb14
s_cmp_lg_u32 s61, 3000
s_cbranch_scc1 L_fw14
v_mov_b32 v47, 0x10000
s_mov_b64 exec, 1
ds_add_u32 v41, v47 offset:4
s_mov_b64 exec, -1
s_branch L_fw14
L_fw15:
buffer_load_dword v44, v46, s[32:35], s97 offen sc1
ds_read_b32 v47, v41 offset:12
s_add_u32 s61, s61, 1
s_waitcnt vmcnt(0) lgkmcnt(0)
v_cmp_ne_u32 vcc, v43, v44
v_readfirstlane_b32 s46, v47
s_nop 3
s_cbranch_vccz L_fb15
s_cmp_lg_u32 s46, 0
s_cbranch_scc1 L_fb15
s_cmp_lg_u32 s61, 3000
s_cbranch_scc1 L_fw15
v_mov_b32 v47, 0x10000
s_mov_b64 exec, 1
ds_add_u32 v41, v47 offset:4
s_mov_b64 exec, -1
s_branch L_fw15
L_ks10:
ds_read_b32 v47, v41 offset:12
s_add_u32 s47, s96, 0
s_waitcnt lgkmcnt(0)
buffer_load_dwordx4 v[100:103], v34, s[32:35], s47 offen offset:0 sc1
buffer_load_dwordx4 v[104:107], v34, s[32:35], s47 offen offset:1024 sc1
buffer_load_dwordx4 v[116:119], v34, s[32:35], s47 offen offset:2048 sc1
buffer_load_dwordx4 v[120:123], v34, s[32:35], s47 offen offset:3072 sc1
v_readfirstlane_b32 s46, v47
s_add_u32 s61, s61, 1
s_waitcnt vmcnt(0)
s_cmp_lg_u32 s46, 0
s_cbranch_scc1 L_kb10
v_bitop3_b32 v28, v101, v106, v43 bitop3:0x7e
v_bitop3_b32 v29, v117, v122, v43 bitop3:0x7e
v_or_b32 v28, v28, v29
v_cmp_ne_u32 s[48:49], 0, v28
s_nop 2
s_cmp_eq_u64 s[48:49], 0
s_cbranch_scc1 L_kb10
s_cmp_lg_u32 s61, 3000
s_cbranch_scc1 L_ks10
v_mov_b32 v47, 0x10000
s_mov_b64 exec, 1
ds_add_u32 v41, v47 offset:4
s_mov_b64 exec, -1
s_branch L_ks10
L_ks12:
ds_read_b32 v47, v41 offset:12
s_add_u32 s47, s96, 4096
s_waitcnt lgkmcnt(0)
buffer_load_dwordx4 v[108:111], v34, s[32:35], s47 offen offset:0 sc1
buffer_load_dwordx4 v[112:115], v34, s[32:35], s47 offen offset:1024 sc1
buffer_load_dwordx4 v[124:127], v34, s[32:35], s47 offen offset:2048 sc1
buffer_load_dwordx4 v[128:131], v34, s[32:35], s47 offen offset:3072 sc1
v_readfirstlane_b32 s46, v47
s_add_u32 s61, s61, 1
s_waitcnt vmcnt(0)
s_cmp_lg_u32 s46, 0
s_cbranch_scc1 L_kb12
v_bitop3_b32 v28, v109, v114, v43 bitop3:0x7e
v_bitop3_b32 v29, v125, v130, v43 bitop3:0x7e
v_or_b32 v28, v28, v29
v_cmp_ne_u32 s[48:49], 0, v28
s_nop 2
s_cmp_eq_u64 s[48:49], 0
s_cbranch_scc1 L_kb12
s_cmp_lg_u32 s61, 3000
s_cbranch_scc1 L_ks12
v_mov_b32 v47, 0x10000
s_mov_b64 exec, 1
ds_add_u32 v41, v47 offset:4
s_mov_b64 exec, -1
s_branch L_ks12
L_ks14:
ds_read_b32 v47, v41 offset:12
s_add_u32 s47, s96, 8192
s_waitcnt lgkmcnt(0)
buffer_load_dwordx4 v[4:7], v34, s[32:35], s47 offen offset:0 sc1
buffer_load_dwordx4 v[8:11], v34, s[32:35], s47 offen offset:1024 sc1
buffer_load_dwordx4 v[12:15], v34, s[32:35], s47 offen offset:2048 sc1
buffer_load_dwordx4 v[16:19], v34, s[32:35], s47 offen offset:3072 sc1
v_readfirstlane_b32 s46, v47
s_add_u32 s61, s61, 1
s_waitcnt vmcnt(0)
s_cmp_lg_u32 s46, 0
s_cbranch_scc1 L_kb14
v_bitop3_b32 v28, v5, v10, v43 bitop3:0x7e
v_bitop3_b32 v29, v13, v18, v43 bitop3:0x7e
v_or_b32 v28, v28, v29
v_cmp_ne_u32 s[48:49], 0, v28
s_nop 2
s_cmp_eq_u64 s[48:49], 0
s_cbranch_scc1 L_kb14
s_cmp_lg_u32 s61, 3000
s_cbranch_scc1 L_ks14
v_mov_b32 v47, 0x10000
s_mov_b64 exec, 1
ds_add_u32 v41, v47 offset:4
s_mov_b64 exec, -1
s_branch L_ks14
L_ks16:
ds_read_b32 v47, v41 offset:12
s_add_u32 s47, s96, 12288
s_waitcnt lgkmcnt(0)
buffer_load_dwordx4 v[20:23], v34, s[32:35], s47 offen offset:0 sc1
buffer_load_dwordx4 v[24:27], v34, s[32:35], s47 offen offset:1024 sc1
buffer_load_dwordx4 v[48:51], v34, s[32:35], s47 offen offset:2048 sc1
buffer_load_dwordx4 v[52:55], v34, s[32:35], s47 offen offset:3072 sc1
v_readfirstlane_b32 s46, v47
s_add_u32 s61, s61, 1
s_waitcnt vmcnt(0)
s_cmp_lg_u32 s46, 0
s_cbranch_scc1 L_kb16
v_bitop3_b32 v28, v21, v26, v43 bitop3:0x7e
v_bitop3_b32 v29, v49, v54, v43 bitop3:0x7e
v_or_b32 v28, v28, v29
v_cmp_ne_u32 s[48:49], 0, v28
s_nop 2
s_cmp_eq_u64 s[48:49], 0
s_cbranch_scc1 L_kb16
s_cmp_lg_u32 s61, 3000
s_cbranch_scc1 L_ks16
v_mov_b32 v47, 0x10000
s_mov_b64 exec, 1
ds_add_u32 v41, v47 offset:4
s_mov_b64 exec, -1
s_branch L_ks16
L_ks18:
ds_read_b32 v47, v41 offset:12
s_add_u32 s47, s96, 16384
s_waitcnt lgkmcnt(0)
buffer_load_dwordx4 v[108:111], v34, s[32:35], s47 offen offset:0 sc1
buffer_load_dwordx4 v[112:115], v34, s[32:35], s47 offen offset:1024 sc1
buffer_load_dwordx4 v[124:127], v34, s[32:35], s47 offen offset:2048 sc1
buffer_load_dwordx4 v[128:131], v34, s[32:35], s47 offen offset:3072 sc1
v_readfirstlane_b32 s46, v47
s_add_u32 s61, s61, 1
s_waitcnt vmcnt(0)
s_cmp_lg_u32 s46, 0
s_cbranch_scc1 L_kb18
v_bitop3_b32 v28, v109, v114, v43 bitop3:0x7e
v_bitop3_b32 v29, v125, v130, v43 bitop3:0x7e
v_or_b32 v28, v28, v29
v_cmp_ne_u32 s[48:49], 0, v28
s_nop 2
s_cmp_eq_u64 s[48:49], 0
s_cbranch_scc1 L_kb18
s_cmp_lg_u32 s61, 3000
s_cbranch_scc1 L_ks18
v_mov_b32 v47, 0x10000
s_mov_b64 exec, 1
ds_add_u32 v41, v47 offset:4
s_mov_b64 exec, -1
s_branch L_ks18
L_ks110:
ds_read_b32 v47, v41 offset:12
s_add_u32 s47, s96, 20480
s_waitcnt lgkmcnt(0)
buffer_load_dwordx4 v[168:171], v34, s[32:35], s47 offen offset:0 sc1
buffer_load_dwordx4 v[172:175], v34, s[32:35], s47 offen offset:1024 sc1
buffer_load_dwordx4 v[184:187], v34, s[32:35], s47 offen offset:2048 sc1
buffer_load_dwordx4 v[188:191], v34, s[32:35], s47 offen offset:3072 sc1
v_readfirstlane_b32 s46, v47
s_add_u32 s61, s61, 1
s_waitcnt vmcnt(0)
s_cmp_lg_u32 s46, 0
s_cbranch_scc1 L_kb110
v_bitop3_b32 v28, v169, v174, v43 bitop3:0x7e
v_bitop3_b32 v29, v185, v190, v43 bitop3:0x7e
v_or_b32 v28, v28, v29
v_cmp_ne_u32 s[48:49], 0, v28
s_nop 2
s_cmp_eq_u64 s[48:49], 0
s_cbranch_scc1 L_kb110
s_cmp_lg_u32 s61, 3000
s_cbranch_scc1 L_ks110
v_mov_b32 v47, 0x10000
s_mov_b64 exec, 1
ds_add_u32 v41, v47 offset:4
s_mov_b64 exec, -1
s_branch L_ks110
L_ks112:
ds_read_b32 v47, v41 offset:12
s_add_u32 s47, s96, 24576
s_waitcnt lgkmcnt(0)
buffer_load_dwordx4 v[192:195], v34, s[32:35], s47 offen offset:0 sc1
buffer_load_dwordx4 v[196:199], v34, s[32:35], s47 offen offset:1024 sc1
buffer_load_dwordx4 v[200:203], v34, s[32:35], s47 offen offset:2048 sc1
buffer_load_dwordx4 v[204:207], v34, s[32:35], s47 offen offset:3072 sc1
v_readfirstlane_b32 s46, v47
s_add_u32 s61, s61, 1
s_waitcnt vmcnt(0)
s_cmp_lg_u32 s46, 0
s_cbranch_scc1 L_kb112
v_bitop3_b32 v28, v193, v198, v43 bitop3:0x7e
v_bitop3_b32 v29, v201, v206, v43 bitop3:0x7e
v_or_b32 v28, v28, v29
v_cmp_ne_u32 s[48:49], 0, v28
s_nop 2
s_cmp_eq_u64 s[48:49], 0
s_cbranch_scc1 L_kb112
s_cmp_lg_u32 s61, 3000
s_cbranch_scc1 L_ks112
v_mov_b32 v47, 0x10000
s_mov_b64 exec, 1
ds_add_u32 v41, v47 offset:4
s_mov_b64 exec, -1
s_branch L_ks112
L_ks114:
ds_read_b32 v47, v41 offset:12
s_add_u32 s47, s96, 28672
s_waitcnt lgkmcnt(0)
buffer_load_dwordx4 v[208:211], v34, s[32:35], s47 offen offset:0 sc1
buffer_load_dwordx4 v[212:215], v34, s[32:35], s47 offen offset:1024 sc1
buffer_load_dwordx4 v[124:127], v34, s[32:35], s47 offen offset:2048 sc1
buffer_load_dwordx4 v[128:131], v34, s[32:35], s47 offen offset:3072 sc1
v_readfirstlane_b32 s46, v47
s_add_u32 s61, s61, 1
s_waitcnt vmcnt(0)
s_cmp_lg_u32 s46, 0
s_cbranch_scc1 L_kb114
v_bitop3_b32 v28, v209, v214, v43 bitop3:0x7e
v_bitop3_b32 v29, v125, v130, v43 bitop3:0x7e
v_or_b32 v28, v28, v29
v_cmp_ne_u32 s[48:49], 0, v28
s_nop 2
s_cmp_eq_u64 s[48:49], 0
s_cbranch_scc1 L_kb114
s_cmp_lg_u32 s61, 3000
s_cbranch_scc1 L_ks114
v_mov_b32 v47, 0x10000
s_mov_b64 exec, 1
ds_add_u32 v41, v47 offset:4
s_mov_b64 exec, -1
s_branch L_ks114
L_codeend:
.section .rodata,"a"
.p2align 6
.amdhsa_kernel standalone__autoregressive_conv_wavernn__speech_kernel
  .amdhsa_next_free_vgpr 256
  .amdhsa_next_free_sgpr 102
  .amdhsa_accum_offset 256
  .amdhsa_group_segment_fixed_size 0
  .amdhsa_kernarg_size 40
  .amdhsa_user_sgpr_count 2
  .amdhsa_user_sgpr_kernarg_segment_ptr 1
  .amdhsa_system_sgpr_workgroup_id_x 1
.end_amdhsa_kernel
```
